```python
import torch

def _softmax(x, axis=-1):
    return torch.softmax(x, dim=axis)
def _gelu(x):
    return torch.nn.functional.gelu(x, approximate="tanh")
def _silu(x):
    return torch.nn.functional.silu(x)
def _sigmoid(x):
    return torch.sigmoid(x)
def _layernorm(x, axis=-1, eps=1e-5):
    m = x.mean(dim=axis, keepdim=True)
    v = x.var(dim=axis, keepdim=True, unbiased=False)
    return (x - m) / torch.sqrt(v + eps)
def _scatter_add(tgt, idx, src, axis=0):
    return tgt.clone().index_add_(axis, idx, src)
def _segment_sum(src, seg, n):
    out = torch.zeros((n,) + src.shape[1:], dtype=src.dtype)
    return out.index_add_(0, seg, src)
def _pad(x, pw):
    flat = tuple(v for pair in reversed(pw) for v in pair)
    return torch.nn.functional.pad(x, flat)

kernel_name = 'sequential_preLN__mha_block__mixer_token_mlp__prompt'

def setup_inputs():

    _w = (lambda a: (lambda t: t.to(torch.bfloat16) if t.is_floating_point() else t)(torch.as_tensor(a)))
    def _A_setup():
        B, S, D, H = 1, 2048, 640, 32
        return {
            "x": _w((lambda *s: torch.randn(*s, dtype=torch.bfloat16) * 0.05)(B, S, D)),
            "wqkv": _w((lambda *s: torch.randn(*s, dtype=torch.bfloat16) * 0.05)(D, 3 * D)),
            "wo": _w((lambda *s: torch.randn(*s, dtype=torch.bfloat16) * 0.05)(D, D)),
        }
    _A_in = _A_setup()

    def _B_setup():
        B, S, D, F = 1, 2048, 640, 1536
        return {
            "x": _w((lambda *s: torch.randn(*s, dtype=torch.bfloat16) * 0.05)(B, S, D)),
            "w1": _w((lambda *s: torch.randn(*s, dtype=torch.bfloat16) * 1.6)(S, F) * (S ** -0.5)),
            "b1": _w((lambda *s: torch.randn(*s, dtype=torch.bfloat16) * 1.6)(F) * 0.02),
            "w2": _w((lambda *s: torch.randn(*s, dtype=torch.bfloat16) * 0.2)(F, S) * (F ** -0.5)),
            "b2": _w((lambda *s: torch.randn(*s, dtype=torch.bfloat16) * 0.2)(S) * 0.02),
        }
    _B_in = _B_setup()

    return {
        "A_x": _A_in["x"],
        "A_wqkv": _A_in["wqkv"],
        "A_wo": _A_in["wo"],
        "B_x": _B_in["x"],
        "B_w1": _B_in["w1"],
        "B_b1": _B_in["b1"],
        "B_w2": _B_in["w2"],
        "B_b2": _B_in["b2"],
    }

def reference(A_x, A_wqkv, A_wo, B_x, B_w1, B_b1, B_w2, B_b2):
    def _A_ref(x, wqkv, wo):
        B, S, D = x.shape
        H = 32
        Dh = D // H
        qkv = (lambda x, *d: x.permute(*d))((x @ wqkv).reshape(B, S, 3, H, Dh), 2, 0, 3, 1, 4)
        q, k, v = qkv[0], qkv[1], qkv[2]
        scores = torch.einsum("bhqd,bhkd->bhqk", q, k) * (Dh ** -0.5)
        p = _softmax(scores, axis=-1)
        o = torch.einsum("bhqk,bhkd->bhqd", p, v)
        return (lambda x, *d: x.permute(*d))(o, 0, 2, 1, 3).reshape(B, S, D) @ wo

    def _B_ref(x, w1, b1, w2, b2):
        B, S, D = x.shape
        h = _layernorm(x, axis=-1)
        u = torch.einsum("bsd,sf->bdf", h, w1) + b1
        u = _gelu(u)
        y = torch.einsum("bdf,fs->bds", u, w2) + b2
        return (lambda x, *d: x.permute(*d))(y, 0, 2, 1)

    x = A_x
    h = x + _A_ref(_layernorm(x, axis=-1), A_wqkv, A_wo)
    h2 = h + _B_ref(_layernorm(h, axis=-1), B_w1, B_b1, B_w2, B_b2)
    return h2
```

```asm
; @launch grid=(256,1,1) block=(512,1,1) lds=163840
.amdgcn_target "amdgcn-amd-amdhsa--gfx950"
.text
.globl sequential_preLN__mha_block__mixer_token_mlp__prompt_kernel
.p2align 8
.type sequential_preLN__mha_block__mixer_token_mlp__prompt_kernel,@function
sequential_preLN__mha_block__mixer_token_mlp__prompt_kernel:
    s_cmp_ge_u32 s2, 256
    s_cbranch_scc1 L_end
    s_load_dwordx4 s[4:7], s[0:1], 0
    s_load_dwordx2 s[12:13], s[0:1], 80
    s_load_dwordx2 s[40:41], s[0:1], 16
    s_load_dwordx2 s[44:45], s[0:1], 72
    v_cmp_gt_u32 vcc, 16, v0
    s_and_saveexec_b64 s[20:21], vcc
    s_cbranch_execz L_a_nct
    s_lshr_b32 s26, s2, 3
    s_lshl_b32 s26, s26, 4
    s_getpc_b64 s[38:39]
L_pc0:
    s_add_u32 s38, s38, L_a_nct-L_pc0
    s_addc_u32 s39, s39, 0
    v_add_u32 v4, s26, v0
    v_add_u32 v4, 0, v4
    v_lshlrev_b32 v4, 7, v4
    v_min_u32 v4, L_last-L_a_nct-4, v4
    v_mov_b32 v5, s39
    v_add_co_u32 v4, vcc, s38, v4
    s_nop 1
    v_addc_co_u32 v5, vcc, 0, v5, vcc
    global_load_dword v255, v[4:5], off
L_a_nct:
    s_mov_b64 exec, -1
    v_lshrrev_b32 v2, 6, v0
    v_and_b32 v1, 63, v0
    v_readfirstlane_b32 s18, v2
    s_and_b32 s20, s2, 7
    s_lshr_b32 s21, s2, 3
    s_lshr_b32 s22, s20, 1
    s_lshl_b32 s22, s22, 2
    s_and_b32 s23, s21, 3
    s_add_u32 s22, s22, s23
    s_lshl_b32 s16, s22, 7
    s_lshr_b32 s23, s21, 2
    s_and_b32 s24, s20, 1
    s_lshl_b32 s24, s24, 3
    s_add_u32 s19, s23, s24
    s_lshl_b32 s17, s19, 7
    s_add_u32 s35, s22, s19
    s_mul_i32 s36, s35, 26
    s_lshr_b32 s36, s36, 8
    s_mul_i32 s36, s36, 10
    s_sub_u32 s35, s35, s36
    s_cmp_eq_u32 s19, 15
    s_cbranch_scc1 L_a_spare
    s_cmp_lt_u32 s18, 4
    s_cbranch_scc1 L_a_compute
    s_sub_u32 s25, s18, 4
    v_lshrrev_b32 v2, 3, v1
    s_lshl_b32 s26, s25, 5
    s_add_u32 s26, s26, s16
    v_add_u32 v2, s26, v2
    v_mul_u32_u24 v2, 1280, v2
    v_lshrrev_b32 v4, 4, v1
    v_and_b32 v7, 7, v1
    v_xor_b32 v6, v4, v7
    v_lshl_add_u32 v64, v6, 4, v2
    v_xor_b32 v65, 64, v64
    v_add_u32 v65, 9216, v65
    s_lshl_b32 s26, s25, 4
    v_add_u32 v5, s26, v4
    v_mul_u32_u24 v3, 3840, v5
    v_and_b32 v6, 15, v1
    v_lshlrev_b32 v7, 1, v4
    v_xor_b32 v6, v6, v7
    v_lshl_add_u32 v3, v6, 4, v3
    s_lshl_b32 s26, s17, 1
    v_add_u32 v68, s26, v3
    v_xor_b32 v70, 128, v68
    v_add_u32 v66, 18432, v64
    v_add_u32 v67, 18432, v65
    v_add_u32 v69, 14336, v68
    v_add_u32 v70, 28672, v70
    v_add_u32 v71, 14336, v70
    s_lshl_b32 s30, s25, 12
    s_mov_b32 s31, s30
    s_mul_i32 s36, s35, 256
    s_lshr_b32 s36, s36, 8
    s_mul_i32 s36, s36, 1
    s_sub_u32 s37, s35, s36
    s_lshl_b32 s28, s36, 7
    s_mul_i32 s29, s36, 245760
    s_mov_b32 s33, 0
    s_waitcnt lgkmcnt(0)
    s_mov_b32 s8, s6
    s_mov_b32 s9, s7
    s_mov_b32 s6, 2621440
    s_mov_b32 s7, 0x00020000
    s_mov_b32 s10, 2457600
    s_mov_b32 s11, 0x00020000
    s_setprio 3
    s_mov_b32 m0, s30
    s_add_u32 s32, s30, 16384
    buffer_load_dwordx4 v64, s[4:7], s28 offen offset:0 lds
    buffer_load_dwordx4 v65, s[4:7], s28 offen offset:1024 lds
    buffer_load_dwordx4 v66, s[4:7], s28 offen offset:2048 lds
    buffer_load_dwordx4 v67, s[4:7], s28 offen offset:3072 lds
    s_mov_b32 m0, s32
    s_add_u32 s28, s28, 128
    buffer_load_dwordx4 v68, s[8:11], s29 offen offset:0 lds
    buffer_load_dwordx4 v69, s[8:11], s29 offen offset:1024 lds
    buffer_load_dwordx4 v70, s[8:11], s29 offen offset:2048 lds
    buffer_load_dwordx4 v71, s[8:11], s29 offen offset:3072 lds
    s_add_u32 s29, s29, 245760
    s_cmp_eq_u32 s28, 1280
    s_cselect_b32 s28, 0, s28
    s_cselect_b32 s29, 0, s29
    s_add_u32 s30, s30, 32768
    s_cmp_ge_u32 s30, 163840
    s_cselect_b32 s30, s31, s30
    s_mov_b32 s14, 32505856
    s_mov_b32 s15, 0x00020000
    s_mov_b32 s46, 256
    s_mov_b32 s47, 0x00020000
    v_and_b32 v10, 31, v1
    v_lshrrev_b32 v11, 5, v1
    s_lshl_b32 s26, s25, 5
    s_lshl_b32 s27, s25, 1
    v_add_u32 v4, s26, v10
    v_lshlrev_b32 v4, 7, v4
    v_lshrrev_b32 v5, 1, v10
    v_and_b32 v5, 7, v5
    v_xor_b32 v5, v5, v11
    v_lshl_add_u32 v12, v5, 4, v4
    v_xor_b32 v13, 32, v12
    v_xor_b32 v14, 64, v12
    v_xor_b32 v15, 96, v12
    v_bfe_u32 v4, v1, 2, 2
    v_lshl_add_u32 v5, v11, 3, v4
    v_lshlrev_b32 v5, 8, v5
    v_bfe_u32 v6, v1, 4, 1
    v_add_u32 v6, s27, v6
    v_lshl_add_u32 v4, v11, 2, v4
    v_xor_b32 v6, v6, v4
    v_lshl_add_u32 v5, v6, 5, v5
    v_and_b32 v6, 3, v1
    v_lshl_add_u32 v5, v6, 3, v5
    v_add_u32 v16, 16384, v5
    v_mov_b32 v24, 0x3f803f80
    v_mov_b32 v26, 0
    v_mov_b32 v27, 0
    v_mov_b32 v28, 0
    v_mov_b32 v29, 0
    v_mov_b32 v30, 0
    v_mov_b32 v31, 0
    v_mov_b32 v22, 0
    v_add_u32 v8, s26, v10
    v_lshlrev_b32 v18, 4, v8
    v_lshlrev_b32 v19, 3, v8
    s_mul_i32 s48, s22, 20480
    s_add_u32 s48, s48, 16252928
    s_mul_i32 s49, s19, 10240
    s_add_u32 s49, s49, 16580608
    s_lshl_b32 s50, s35, 11
    s_add_u32 s50, s50, s48
    s_lshl_b32 s51, s35, 10
    s_add_u32 s51, s51, s49
    v_lshlrev_b32 v5, 2, v8
    v_add_u32 v5, 32768, v5
    v_lshlrev_b32 v6, 3, v8
    v_add_u32 v6, 32768, v6
    v_mov_b32 v4, 35840
    s_mov_b32 s33, 32768
    s_lshl_b32 s36, s37, 15
    v_add_u32 v12, s36, v12
    v_add_u32 v13, s36, v13
    v_add_u32 v14, s36, v14
    v_add_u32 v15, s36, v15
    v_add_u32 v16, s36, v16
    s_mov_b32 m0, s30
    s_add_u32 s32, s30, 16384
    buffer_load_dwordx4 v64, s[4:7], s28 offen offset:0 lds
    buffer_load_dwordx4 v65, s[4:7], s28 offen offset:1024 lds
    buffer_load_dwordx4 v66, s[4:7], s28 offen offset:2048 lds
    buffer_load_dwordx4 v67, s[4:7], s28 offen offset:3072 lds
    s_mov_b32 m0, s32
    s_add_u32 s28, s28, 128
    buffer_load_dwordx4 v68, s[8:11], s29 offen offset:0 lds
    buffer_load_dwordx4 v69, s[8:11], s29 offen offset:1024 lds
    buffer_load_dwordx4 v70, s[8:11], s29 offen offset:2048 lds
    buffer_load_dwordx4 v71, s[8:11], s29 offen offset:3072 lds
    s_add_u32 s29, s29, 245760
    s_cmp_eq_u32 s28, 1280
    s_cselect_b32 s28, 0, s28
    s_cselect_b32 s29, 0, s29
    s_add_u32 s30, s30, 32768
    s_cmp_ge_u32 s30, 163840
    s_cselect_b32 s30, s31, s30
    s_mov_b32 m0, s30
    s_add_u32 s32, s30, 16384
    buffer_load_dwordx4 v64, s[4:7], s28 offen offset:0 lds
    buffer_load_dwordx4 v65, s[4:7], s28 offen offset:1024 lds
    buffer_load_dwordx4 v66, s[4:7], s28 offen offset:2048 lds
    buffer_load_dwordx4 v67, s[4:7], s28 offen offset:3072 lds
    s_mov_b32 m0, s32
    s_add_u32 s28, s28, 128
    buffer_load_dwordx4 v68, s[8:11], s29 offen offset:0 lds
    buffer_load_dwordx4 v69, s[8:11], s29 offen offset:1024 lds
    buffer_load_dwordx4 v70, s[8:11], s29 offen offset:2048 lds
    buffer_load_dwordx4 v71, s[8:11], s29 offen offset:3072 lds
    s_add_u32 s29, s29, 245760
    s_cmp_eq_u32 s28, 1280
    s_cselect_b32 s28, 0, s28
    s_cselect_b32 s29, 0, s29
    s_add_u32 s30, s30, 32768
    s_cmp_ge_u32 s30, 163840
    s_cselect_b32 s30, s31, s30
    s_waitcnt vmcnt(16)
    s_waitcnt lgkmcnt(0)
    s_barrier
    s_cmp_lg_u32 s37, 0
    s_cbranch_scc1 L_a_ns0
    ds_read_b128 v[32:35], v12
    ds_read_b128 v[36:39], v13
    ds_read_b128 v[40:43], v14
    ds_read_b128 v[44:47], v15
    ds_read_b64_tr_b16 v[48:49], v16 offset:0
    ds_read_b64_tr_b16 v[50:51], v16 offset:1024
    ds_read_b64_tr_b16 v[52:53], v16 offset:4096
    ds_read_b64_tr_b16 v[54:55], v16 offset:5120
    ds_read_b64_tr_b16 v[56:57], v16 offset:8192
    ds_read_b64_tr_b16 v[58:59], v16 offset:9216
    ds_read_b64_tr_b16 v[60:61], v16 offset:12288
    ds_read_b64_tr_b16 v[62:63], v16 offset:13312
L_a_ns0:
    buffer_load_dword v23, v22, s[44:47], 0 offen sc1
    s_mov_b32 m0, s30
    s_add_u32 s32, s30, 16384
    buffer_load_dwordx4 v64, s[4:7], s28 offen offset:0 lds
    buffer_load_dwordx4 v65, s[4:7], s28 offen offset:1024 lds
    buffer_load_dwordx4 v66, s[4:7], s28 offen offset:2048 lds
    buffer_load_dwordx4 v67, s[4:7], s28 offen offset:3072 lds
    s_mov_b32 m0, s32
    s_add_u32 s28, s28, 128
    buffer_load_dwordx4 v68, s[8:11], s29 offen offset:0 lds
    buffer_load_dwordx4 v69, s[8:11], s29 offen offset:1024 lds
    buffer_load_dwordx4 v70, s[8:11], s29 offen offset:2048 lds
    buffer_load_dwordx4 v71, s[8:11], s29 offen offset:3072 lds
    s_add_u32 s29, s29, 245760
    s_cmp_eq_u32 s28, 1280
    s_cselect_b32 s28, 0, s28
    s_cselect_b32 s29, 0, s29
    s_add_u32 s30, s30, 32768
    s_cmp_ge_u32 s30, 163840
    s_cselect_b32 s30, s31, s30
    s_waitcnt vmcnt(17)
    s_waitcnt lgkmcnt(0)
    s_barrier
    s_waitcnt lgkmcnt(0)
    v_dot2c_f32_bf16 v26, v32, v24
    v_dot2c_f32_bf16 v27, v32, v32
    v_dot2c_f32_bf16 v28, v33, v24
    v_dot2c_f32_bf16 v29, v33, v33
    v_dot2c_f32_bf16 v26, v34, v24
    v_dot2c_f32_bf16 v27, v34, v34
    v_dot2c_f32_bf16 v28, v35, v24
    v_dot2c_f32_bf16 v29, v35, v35
    v_dot2c_f32_bf16 v26, v36, v24
    v_dot2c_f32_bf16 v27, v36, v36
    v_dot2c_f32_bf16 v28, v37, v24
    v_dot2c_f32_bf16 v29, v37, v37
    v_dot2c_f32_bf16 v26, v38, v24
    v_dot2c_f32_bf16 v27, v38, v38
    v_dot2c_f32_bf16 v28, v39, v24
    v_dot2c_f32_bf16 v29, v39, v39
    v_dot2c_f32_bf16 v26, v40, v24
    v_dot2c_f32_bf16 v27, v40, v40
    v_dot2c_f32_bf16 v28, v41, v24
    v_dot2c_f32_bf16 v29, v41, v41
    v_dot2c_f32_bf16 v26, v42, v24
    v_dot2c_f32_bf16 v27, v42, v42
    v_dot2c_f32_bf16 v28, v43, v24
    v_dot2c_f32_bf16 v29, v43, v43
    v_dot2c_f32_bf16 v26, v44, v24
    v_dot2c_f32_bf16 v27, v44, v44
    v_dot2c_f32_bf16 v28, v45, v24
    v_dot2c_f32_bf16 v29, v45, v45
    v_dot2c_f32_bf16 v26, v46, v24
    v_dot2c_f32_bf16 v27, v46, v46
    v_dot2c_f32_bf16 v28, v47, v24
    v_dot2c_f32_bf16 v29, v47, v47
    v_dot2c_f32_bf16 v30, v48, v24
    v_dot2c_f32_bf16 v31, v49, v24
    v_dot2c_f32_bf16 v30, v50, v24
    v_dot2c_f32_bf16 v31, v51, v24
    v_dot2c_f32_bf16 v30, v52, v24
    v_dot2c_f32_bf16 v31, v53, v24
    v_dot2c_f32_bf16 v30, v54, v24
    v_dot2c_f32_bf16 v31, v55, v24
    v_dot2c_f32_bf16 v30, v56, v24
    v_dot2c_f32_bf16 v31, v57, v24
    v_dot2c_f32_bf16 v30, v58, v24
    v_dot2c_f32_bf16 v31, v59, v24
    v_dot2c_f32_bf16 v30, v60, v24
    v_dot2c_f32_bf16 v31, v61, v24
    v_dot2c_f32_bf16 v30, v62, v24
    v_dot2c_f32_bf16 v31, v63, v24
    v_pk_add_f32 v[26:27], v[26:27], v[28:29]
    s_nop 2
    v_add_f32 v30, v30, v31
    v_mov_b32 v28, v26
    v_mov_b32 v29, v27
    v_mov_b32 v31, v30
    s_nop 1
    v_permlane32_swap_b32 v26, v28
    v_permlane32_swap_b32 v27, v29
    v_permlane32_swap_b32 v30, v31
    s_nop 1
    v_pk_add_f32 v[26:27], v[26:27], v[28:29]
    v_add_f32 v30, v30, v31
    s_waitcnt vmcnt(8)
    v_cmp_eq_u32 vcc, 0, v23
    s_cbranch_vccnz L_a_tw
L_a_tgot:
    v_mov_b32 v28, v23
    v_mov_b32 v29, v23
    v_mov_b32 v31, v23
    s_mov_b32 exec_hi, 0
    buffer_store_dwordx4 v[26:29], v18, s[12:15], s50 offen sc0 sc1
    buffer_store_dwordx2 v[30:31], v19, s[12:15], s51 offen sc0 sc1
    s_lshl_b32 s36, s19, 4
    s_add_u32 s36, s36, s22
    s_lshl_b32 s36, s36, 7
    s_add_u32 s36, s36, 16875520
    s_cmp_eq_u32 s25, 0
    s_cselect_b32 s36, s36, 0x80000000
    v_lshlrev_b32 v21, 2, v1
    buffer_store_dword v22, v21, s[12:15], s36 offen sc0 sc1
    s_mov_b32 exec_hi, -1
    v_mul_u32_u24 v21, 10240, v11
    v_add_u32 v18, v18, v21
    v_lshrrev_b32 v21, 1, v21
    v_add_u32 v19, v19, v21
    s_add_u32 s50, s48, 4096
    s_add_u32 s51, s48, 8192
    s_add_u32 s52, s49, 4096
    s_barrier
    s_mov_b32 m0, s30
    s_add_u32 s32, s30, 16384
    buffer_load_dwordx4 v64, s[4:7], s28 offen offset:0 lds
    buffer_load_dwordx4 v65, s[4:7], s28 offen offset:1024 lds
    buffer_load_dwordx4 v66, s[4:7], s28 offen offset:2048 lds
    buffer_load_dwordx4 v67, s[4:7], s28 offen offset:3072 lds
    s_mov_b32 m0, s32
    s_add_u32 s28, s28, 128
    buffer_load_dwordx4 v68, s[8:11], s29 offen offset:0 lds
    buffer_load_dwordx4 v69, s[8:11], s29 offen offset:1024 lds
    buffer_load_dwordx4 v70, s[8:11], s29 offen offset:2048 lds
    buffer_load_dwordx4 v71, s[8:11], s29 offen offset:3072 lds
    s_add_u32 s29, s29, 245760
    s_cmp_eq_u32 s28, 1280
    s_cselect_b32 s28, 0, s28
    s_cselect_b32 s29, 0, s29
    s_add_u32 s30, s30, 32768
    s_cmp_ge_u32 s30, 163840
    s_cselect_b32 s30, s31, s30
    s_waitcnt vmcnt(11)
    s_barrier
    s_mov_b32 m0, s30
    s_add_u32 s32, s30, 16384
    buffer_load_dwordx4 v64, s[4:7], s28 offen offset:0 lds
    buffer_load_dwordx4 v65, s[4:7], s28 offen offset:1024 lds
    buffer_load_dwordx4 v66, s[4:7], s28 offen offset:2048 lds
    buffer_load_dwordx4 v67, s[4:7], s28 offen offset:3072 lds
    s_mov_b32 m0, s32
    s_add_u32 s28, s28, 128
    buffer_load_dwordx4 v68, s[8:11], s29 offen offset:0 lds
    buffer_load_dwordx4 v69, s[8:11], s29 offen offset:1024 lds
    buffer_load_dwordx4 v70, s[8:11], s29 offen offset:2048 lds
    buffer_load_dwordx4 v71, s[8:11], s29 offen offset:3072 lds
    s_add_u32 s29, s29, 245760
    s_cmp_eq_u32 s28, 1280
    s_cselect_b32 s28, 0, s28
    s_cselect_b32 s29, 0, s29
    s_add_u32 s30, s30, 32768
    s_cmp_ge_u32 s30, 163840
    s_cselect_b32 s30, s31, s30
    s_waitcnt vmcnt(8)
    s_barrier
    s_mov_b32 m0, s30
    s_add_u32 s32, s30, 16384
    buffer_load_dwordx4 v64, s[4:7], s28 offen offset:0 lds
    buffer_load_dwordx4 v65, s[4:7], s28 offen offset:1024 lds
    buffer_load_dwordx4 v66, s[4:7], s28 offen offset:2048 lds
    buffer_load_dwordx4 v67, s[4:7], s28 offen offset:3072 lds
    s_mov_b32 m0, s32
    s_add_u32 s28, s28, 128
    buffer_load_dwordx4 v68, s[8:11], s29 offen offset:0 lds
    buffer_load_dwordx4 v69, s[8:11], s29 offen offset:1024 lds
    buffer_load_dwordx4 v70, s[8:11], s29 offen offset:2048 lds
    buffer_load_dwordx4 v71, s[8:11], s29 offen offset:3072 lds
    s_add_u32 s29, s29, 245760
    s_cmp_eq_u32 s28, 1280
    s_cselect_b32 s28, 0, s28
    s_cselect_b32 s29, 0, s29
    s_add_u32 s30, s30, 32768
    s_cmp_ge_u32 s30, 163840
    s_cselect_b32 s30, s31, s30
    s_waitcnt vmcnt(8)
    s_barrier
    s_mov_b32 m0, s30
    s_add_u32 s32, s30, 16384
    buffer_load_dwordx4 v64, s[4:7], s28 offen offset:0 lds
    buffer_load_dwordx4 v65, s[4:7], s28 offen offset:1024 lds
    buffer_load_dwordx4 v66, s[4:7], s28 offen offset:2048 lds
    buffer_load_dwordx4 v67, s[4:7], s28 offen offset:3072 lds
    s_mov_b32 m0, s32
    s_add_u32 s28, s28, 128
    buffer_load_dwordx4 v68, s[8:11], s29 offen offset:0 lds
    buffer_load_dwordx4 v69, s[8:11], s29 offen offset:1024 lds
    buffer_load_dwordx4 v70, s[8:11], s29 offen offset:2048 lds
    buffer_load_dwordx4 v71, s[8:11], s29 offen offset:3072 lds
    s_add_u32 s29, s29, 245760
    s_cmp_eq_u32 s28, 1280
    s_cselect_b32 s28, 0, s28
    s_cselect_b32 s29, 0, s29
    s_add_u32 s30, s30, 32768
    s_cmp_ge_u32 s30, 163840
    s_cselect_b32 s30, s31, s30
    s_waitcnt vmcnt(8)
    s_barrier
    s_mov_b32 m0, s30
    s_add_u32 s32, s30, 16384
    buffer_load_dwordx4 v64, s[4:7], s28 offen offset:0 lds
    buffer_load_dwordx4 v65, s[4:7], s28 offen offset:1024 lds
    buffer_load_dwordx4 v66, s[4:7], s28 offen offset:2048 lds
    buffer_load_dwordx4 v67, s[4:7], s28 offen offset:3072 lds
    s_mov_b32 m0, s32
    s_add_u32 s28, s28, 128
    buffer_load_dwordx4 v68, s[8:11], s29 offen offset:0 lds
    buffer_load_dwordx4 v69, s[8:11], s29 offen offset:1024 lds
    buffer_load_dwordx4 v70, s[8:11], s29 offen offset:2048 lds
    buffer_load_dwordx4 v71, s[8:11], s29 offen offset:3072 lds
    s_add_u32 s29, s29, 245760
    s_cmp_eq_u32 s28, 1280
    s_cselect_b32 s28, 0, s28
    s_cselect_b32 s29, 0, s29
    s_add_u32 s30, s30, 32768
    s_cmp_ge_u32 s30, 163840
    s_cselect_b32 s30, s31, s30
    s_waitcnt vmcnt(8)
    s_barrier
    s_mov_b32 m0, s30
    s_add_u32 s32, s30, 16384
    buffer_load_dwordx4 v64, s[4:7], s28 offen offset:0 lds
    buffer_load_dwordx4 v65, s[4:7], s28 offen offset:1024 lds
    buffer_load_dwordx4 v66, s[4:7], s28 offen offset:2048 lds
    buffer_load_dwordx4 v67, s[4:7], s28 offen offset:3072 lds
    s_mov_b32 m0, s32
    s_add_u32 s28, s28, 128
    buffer_load_dwordx4 v68, s[8:11], s29 offen offset:0 lds
    buffer_load_dwordx4 v69, s[8:11], s29 offen offset:1024 lds
    buffer_load_dwordx4 v70, s[8:11], s29 offen offset:2048 lds
    buffer_load_dwordx4 v71, s[8:11], s29 offen offset:3072 lds
    s_add_u32 s29, s29, 245760
    s_cmp_eq_u32 s28, 1280
    s_cselect_b32 s28, 0, s28
    s_cselect_b32 s29, 0, s29
    s_add_u32 s30, s30, 32768
    s_cmp_ge_u32 s30, 163840
    s_cselect_b32 s30, s31, s30
    s_waitcnt vmcnt(8)
    s_barrier
    buffer_load_dwordx4 v[32:35], v18, s[12:15], s48 offen offset:0 sc1
    buffer_load_dwordx4 v[36:39], v18, s[12:15], s48 offen offset:2048 sc1
    buffer_load_dwordx4 v[40:43], v18, s[12:15], s50 offen offset:0 sc1
    buffer_load_dwordx4 v[44:47], v18, s[12:15], s50 offen offset:2048 sc1
    buffer_load_dwordx4 v[48:51], v18, s[12:15], s51 offen offset:0 sc1
    buffer_load_dwordx2 v[52:53], v19, s[12:15], s49 offen offset:0 sc1
    buffer_load_dwordx2 v[54:55], v19, s[12:15], s49 offen offset:1024 sc1
    buffer_load_dwordx2 v[56:57], v19, s[12:15], s49 offen offset:2048 sc1
    buffer_load_dwordx2 v[58:59], v19, s[12:15], s49 offen offset:3072 sc1
    buffer_load_dwordx2 v[60:61], v19, s[12:15], s52 offen offset:0 sc1
    s_waitcnt vmcnt(10)
    s_barrier
    s_waitcnt vmcnt(0)
L_a_poll:
    v_or3_b32 v20, v34, v38, v42
    v_or3_b32 v21, v46, v50, v53
    v_or3_b32 v20, v20, v55, v57
    v_or3_b32 v21, v21, v59, v61
    v_bitop3_b32 v24, v34, v38, v42 bitop3:0x80
    v_bitop3_b32 v25, v46, v50, v53 bitop3:0x80
    v_bitop3_b32 v24, v24, v55, v57 bitop3:0x80
    v_bitop3_b32 v25, v25, v59, v61 bitop3:0x80
    v_or3_b32 v20, v20, v21, v23
    v_bitop3_b32 v24, v24, v25, v23 bitop3:0x80
    v_cmp_ne_u32 vcc, v20, v24
    s_cbranch_vccnz L_a_gw
L_a_got:
    v_pk_add_f32 v[32:33], v[32:33], v[36:37]
    v_pk_add_f32 v[40:41], v[40:41], v[44:45]
    v_add_f32 v52, v52, v54
    v_add_f32 v56, v56, v58
    v_pk_add_f32 v[32:33], v[32:33], v[48:49]
    v_add_f32 v52, v52, v60
    v_pk_add_f32 v[26:27], v[32:33], v[40:41]
    v_add_f32 v30, v52, v56
    v_mov_b32 v28, v26
    v_mov_b32 v29, v27
    v_mov_b32 v31, v30
    s_nop 1
    v_permlane32_swap_b32 v26, v28
    v_permlane32_swap_b32 v27, v29
    v_permlane32_swap_b32 v30, v31
    s_nop 1
    v_pk_add_f32 v[26:27], v[26:27], v[28:29]
    v_add_f32 v30, v30, v31
    v_mul_f32 v26, 0xbacccccd, v26
    v_mul_f32 v28, 0x3acccccd, v27
    v_fma_f32 v28, -v26, v26, v28
    v_max_f32 v28, 0, v28
    v_add_f32 v28, 0x3727c5ac, v28
    v_rsq_f32 v27, v28
    s_cmp_lt_u32 s19, 5
    s_cselect_b32 s27, 0x3ea52b5c, 1.0
    v_mul_f32 v27, s27, v27
    ds_write_b32 v5, v27
    ds_write_b32 v5, v26 offset:512
    ds_write_b32 v5, v30 offset:1024
    ds_write_b64 v6, v[26:27] offset:2048
    ds_write2_b32 v4, v22, v22 offset0:0 offset1:1
    s_waitcnt lgkmcnt(0)
    s_barrier
    s_branch L_adone
L_a_tw:
    buffer_load_dword v23, v22, s[44:47], 0 offen sc1
    s_sub_u32 s33, s33, 1
    s_waitcnt vmcnt(0)
    v_cmp_eq_u32 vcc, 0, v23
    s_cmp_lt_i32 s33, 1
    s_cbranch_scc1 L_a_tgot
    s_cbranch_vccnz L_a_tw
    s_branch L_a_tgot
L_a_gw:
    s_sub_u32 s33, s33, 1
    s_cmp_lt_i32 s33, 1
    s_cbranch_scc1 L_a_got
    s_sleep 4
    buffer_load_dwordx4 v[32:35], v18, s[12:15], s48 offen offset:0 sc1
    buffer_load_dwordx4 v[36:39], v18, s[12:15], s48 offen offset:2048 sc1
    buffer_load_dwordx4 v[40:43], v18, s[12:15], s50 offen offset:0 sc1
    buffer_load_dwordx4 v[44:47], v18, s[12:15], s50 offen offset:2048 sc1
    buffer_load_dwordx4 v[48:51], v18, s[12:15], s51 offen offset:0 sc1
    buffer_load_dwordx2 v[52:53], v19, s[12:15], s49 offen offset:0 sc1
    buffer_load_dwordx2 v[54:55], v19, s[12:15], s49 offen offset:1024 sc1
    buffer_load_dwordx2 v[56:57], v19, s[12:15], s49 offen offset:2048 sc1
    buffer_load_dwordx2 v[58:59], v19, s[12:15], s49 offen offset:3072 sc1
    buffer_load_dwordx2 v[60:61], v19, s[12:15], s52 offen offset:0 sc1
    s_waitcnt vmcnt(0)
    s_branch L_a_poll
L_a_spare:
    v_bfe_u32 v4, v1, 3, 2
    v_bfe_u32 v5, v1, 5, 1
    v_mul_u32_u24 v5, 8, v5
    v_add_u32 v4, v4, v5
    v_mul_u32_u24 v2, 1280, v4
    v_bfe_u32 v4, v1, 4, 1
    v_lshlrev_b32 v4, 2, v4
    v_and_b32 v5, 7, v1
    v_xor_b32 v4, v4, v5
    v_lshl_add_u32 v2, v4, 4, v2
    v_bfe_u32 v4, v1, 3, 2
    v_bfe_u32 v5, v1, 5, 1
    v_mul_u32_u24 v5, 80, v5
    v_add_u32 v4, v4, v5
    v_mul_u32_u24 v6, 1280, v4
    v_bfe_u32 v4, v1, 4, 1
    v_lshlrev_b32 v4, 2, v4
    v_and_b32 v5, 7, v1
    v_xor_b32 v4, v4, v5
    v_lshl_add_u32 v6, v4, 4, v6
    v_bfe_u32 v4, v1, 2, 2
    v_lshlrev_b32 v3, 7, v4
    v_lshrrev_b32 v5, 4, v1
    v_lshlrev_b32 v5, 1, v5
    v_bfe_u32 v4, v1, 1, 1
    v_add_u32 v5, v5, v4
    v_bfe_u32 v4, v1, 3, 1
    v_lshlrev_b32 v4, 2, v4
    v_xor_b32 v5, v5, v4
    v_lshl_add_u32 v3, v5, 4, v3
    v_and_b32 v4, 1, v1
    v_lshl_add_u32 v3, v4, 3, v3
    s_mul_i32 s23, s18, 5120
    s_add_u32 s23, s23, 49152
    v_add_u32 v3, s23, v3
    s_mov_b32 s37, s18
    s_waitcnt lgkmcnt(0)
    s_mov_b32 s14, 32505856
    s_mov_b32 s15, 0x00020000
    s_mov_b32 s42, 819200
    s_mov_b32 s43, 0x00020000
    s_mov_b32 s46, 256
    s_mov_b32 s47, 0x00020000
    v_mov_b32 v40, 0
    v_mov_b32 v41, 0
    v_mov_b32 v42, 0
    v_mov_b32 v43, 0
    v_mov_b32 v8, 35840
    ds_write2_b32 v8, v40, v40 offset0:0 offset1:1
L_a_spl:
    v_lshrrev_b32 v4, 4, v1
    s_lshl_b32 s20, s37, 2
    v_add_u32 v4, s20, v4
    v_mul_u32_u24 v5, 52, v4
    v_lshrrev_b32 v5, 8, v5
    s_mov_b32 s21, 199680
    v_lshlrev_b32 v4, 10, v4
    v_mad_u32_u24 v4, v5, s21, v4
    v_and_b32 v5, 15, v1
    v_lshl_add_u32 v4, v5, 4, v4
    s_mul_i32 s24, s22, 5
    s_lshl_b32 s25, s37, 7
    s_add_u32 s26, s24, 0
    s_lshr_b32 s27, s26, 2
    s_and_b32 s36, s26, 3
    s_lshr_b32 s28, s26, 1
    s_mul_i32 s28, s28, 20
    s_and_b32 s29, s26, 1
    s_lshl_b32 s29, s29, 2
    s_add_u32 s28, s28, s29
    s_sub_u32 s29, s27, 16
    s_lshl_b32 s29, s29, 3
    s_add_u32 s29, s29, s36
    s_mul_i32 s29, s29, 20
    s_add_u32 s29, s29, 16
    s_lshr_b32 s38, s27, 2
    s_add_u32 s38, s38, s27
    s_sub_u32 s39, s27, 16
    s_mul_i32 s39, s39, 5
    s_add_u32 s39, s39, 4
    s_cmp_lt_u32 s26, 64
    s_cselect_b32 s28, s28, s29
    s_cselect_b32 s27, s38, s39
    s_cselect_b64 vcc, -1, 0
    s_mul_i32 s28, s28, 1280
    s_add_u32 s28, s28, s25
    v_cndmask_b32 v7, v6, v2, vcc
    s_add_u32 m0, s23, 0
    s_mul_i32 s27, s27, 5120
    buffer_load_dwordx4 v7, s[40:43], s28 offen lds
    s_lshl_b32 s36, s36, 8
    s_add_u32 s27, s27, s36
    s_add_u32 s30, s27, 29753344
    s_add_u32 s26, s24, 1
    s_lshr_b32 s27, s26, 2
    s_and_b32 s36, s26, 3
    s_lshr_b32 s28, s26, 1
    s_mul_i32 s28, s28, 20
    s_and_b32 s29, s26, 1
    s_lshl_b32 s29, s29, 2
    s_add_u32 s28, s28, s29
    s_sub_u32 s29, s27, 16
    s_lshl_b32 s29, s29, 3
    s_add_u32 s29, s29, s36
    s_mul_i32 s29, s29, 20
    s_add_u32 s29, s29, 16
    s_lshr_b32 s38, s27, 2
    s_add_u32 s38, s38, s27
    s_sub_u32 s39, s27, 16
    s_mul_i32 s39, s39, 5
    s_add_u32 s39, s39, 4
    s_cmp_lt_u32 s26, 64
    s_cselect_b32 s28, s28, s29
    s_cselect_b32 s27, s38, s39
    s_cselect_b64 vcc, -1, 0
    s_mul_i32 s28, s28, 1280
    s_add_u32 s28, s28, s25
    v_cndmask_b32 v7, v6, v2, vcc
    s_add_u32 m0, s23, 1024
    s_mul_i32 s27, s27, 5120
    buffer_load_dwordx4 v7, s[40:43], s28 offen lds
    s_lshl_b32 s36, s36, 8
    s_add_u32 s27, s27, s36
    s_add_u32 s31, s27, 29753344
    s_add_u32 s26, s24, 2
    s_lshr_b32 s27, s26, 2
    s_and_b32 s36, s26, 3
    s_lshr_b32 s28, s26, 1
    s_mul_i32 s28, s28, 20
    s_and_b32 s29, s26, 1
    s_lshl_b32 s29, s29, 2
    s_add_u32 s28, s28, s29
    s_sub_u32 s29, s27, 16
    s_lshl_b32 s29, s29, 3
    s_add_u32 s29, s29, s36
    s_mul_i32 s29, s29, 20
    s_add_u32 s29, s29, 16
    s_lshr_b32 s38, s27, 2
    s_add_u32 s38, s38, s27
    s_sub_u32 s39, s27, 16
    s_mul_i32 s39, s39, 5
    s_add_u32 s39, s39, 4
    s_cmp_lt_u32 s26, 64
    s_cselect_b32 s28, s28, s29
    s_cselect_b32 s27, s38, s39
    s_cselect_b64 vcc, -1, 0
    s_mul_i32 s28, s28, 1280
    s_add_u32 s28, s28, s25
    v_cndmask_b32 v7, v6, v2, vcc
    s_add_u32 m0, s23, 2048
    s_mul_i32 s27, s27, 5120
    buffer_load_dwordx4 v7, s[40:43], s28 offen lds
    s_lshl_b32 s36, s36, 8
    s_add_u32 s27, s27, s36
    s_add_u32 s32, s27, 29753344
    s_add_u32 s26, s24, 3
    s_lshr_b32 s27, s26, 2
    s_and_b32 s36, s26, 3
    s_lshr_b32 s28, s26, 1
    s_mul_i32 s28, s28, 20
    s_and_b32 s29, s26, 1
    s_lshl_b32 s29, s29, 2
    s_add_u32 s28, s28, s29
    s_sub_u32 s29, s27, 16
    s_lshl_b32 s29, s29, 3
    s_add_u32 s29, s29, s36
    s_mul_i32 s29, s29, 20
    s_add_u32 s29, s29, 16
    s_lshr_b32 s38, s27, 2
    s_add_u32 s38, s38, s27
    s_sub_u32 s39, s27, 16
    s_mul_i32 s39, s39, 5
    s_add_u32 s39, s39, 4
    s_cmp_lt_u32 s26, 64
    s_cselect_b32 s28, s28, s29
    s_cselect_b32 s27, s38, s39
    s_cselect_b64 vcc, -1, 0
    s_mul_i32 s28, s28, 1280
    s_add_u32 s28, s28, s25
    v_cndmask_b32 v7, v6, v2, vcc
    s_add_u32 m0, s23, 3072
    s_mul_i32 s27, s27, 5120
    buffer_load_dwordx4 v7, s[40:43], s28 offen lds
    s_lshl_b32 s36, s36, 8
    s_add_u32 s27, s27, s36
    s_add_u32 s33, s27, 29753344
    s_add_u32 s26, s24, 4
    s_lshr_b32 s27, s26, 2
    s_and_b32 s36, s26, 3
    s_lshr_b32 s28, s26, 1
    s_mul_i32 s28, s28, 20
    s_and_b32 s29, s26, 1
    s_lshl_b32 s29, s29, 2
    s_add_u32 s28, s28, s29
    s_sub_u32 s29, s27, 16
    s_lshl_b32 s29, s29, 3
    s_add_u32 s29, s29, s36
    s_mul_i32 s29, s29, 20
    s_add_u32 s29, s29, 16
    s_lshr_b32 s38, s27, 2
    s_add_u32 s38, s38, s27
    s_sub_u32 s39, s27, 16
    s_mul_i32 s39, s39, 5
    s_add_u32 s39, s39, 4
    s_cmp_lt_u32 s26, 64
    s_cselect_b32 s28, s28, s29
    s_cselect_b32 s27, s38, s39
    s_cselect_b64 vcc, -1, 0
    s_mul_i32 s28, s28, 1280
    s_add_u32 s28, s28, s25
    v_cndmask_b32 v7, v6, v2, vcc
    s_add_u32 m0, s23, 4096
    s_mul_i32 s27, s27, 5120
    buffer_load_dwordx4 v7, s[40:43], s28 offen lds
    s_lshl_b32 s36, s36, 8
    s_add_u32 s27, s27, s36
    s_add_u32 s34, s27, 29753344
    s_waitcnt vmcnt(0)
    ds_read_b64_tr_b16 v[16:17], v3 offset:0
    ds_read_b64_tr_b16 v[18:19], v3 offset:512
    ds_read_b64_tr_b16 v[20:21], v3 offset:1024
    ds_read_b64_tr_b16 v[22:23], v3 offset:1536
    ds_read_b64_tr_b16 v[24:25], v3 offset:2048
    ds_read_b64_tr_b16 v[26:27], v3 offset:2560
    ds_read_b64_tr_b16 v[28:29], v3 offset:3072
    ds_read_b64_tr_b16 v[30:31], v3 offset:3584
    ds_read_b64_tr_b16 v[32:33], v3 offset:4096
    ds_read_b64_tr_b16 v[34:35], v3 offset:4608
    s_waitcnt lgkmcnt(0)
    buffer_store_dwordx4 v[16:19], v4, s[12:15], s30 offen sc0 sc1
    s_add_u32 s38, s30, 102400
    buffer_store_dwordx4 v[16:19], v4, s[12:15], s38 offen sc0 sc1
    buffer_store_dwordx4 v[20:23], v4, s[12:15], s31 offen sc0 sc1
    s_add_u32 s38, s31, 102400
    buffer_store_dwordx4 v[20:23], v4, s[12:15], s38 offen sc0 sc1
    buffer_store_dwordx4 v[24:27], v4, s[12:15], s32 offen sc0 sc1
    s_add_u32 s38, s32, 102400
    buffer_store_dwordx4 v[24:27], v4, s[12:15], s38 offen sc0 sc1
    buffer_store_dwordx4 v[28:31], v4, s[12:15], s33 offen sc0 sc1
    s_add_u32 s38, s33, 102400
    buffer_store_dwordx4 v[28:31], v4, s[12:15], s38 offen sc0 sc1
    buffer_store_dwordx4 v[32:35], v4, s[12:15], s34 offen sc0 sc1
    s_add_u32 s38, s34, 102400
    buffer_store_dwordx4 v[32:35], v4, s[12:15], s38 offen sc0 sc1
    s_add_u32 s37, s37, 8
    s_cmp_lt_u32 s37, 10
    s_cbranch_scc1 L_a_spl
    s_waitcnt vmcnt(0)
    s_barrier
    s_branch L_adone
L_a_compute:
    v_and_b32 v10, 31, v1
    v_lshrrev_b32 v11, 5, v1
    s_waitcnt lgkmcnt(0)
    s_mov_b32 s14, 32505856
    s_mov_b32 s15, 0x00020000
    s_mov_b32 s46, 256
    s_mov_b32 s47, 0x00020000
    s_cmp_lg_u32 s18, 0
    s_cbranch_scc1 L_a_notag
    s_cmp_lg_u32 s2, 0
    s_cbranch_scc1 L_a_notag
    v_mov_b32 v22, 0
    s_memrealtime s[36:37]
    s_waitcnt lgkmcnt(0)
    s_lshl_b32 s36, s36, 2
    s_or_b32 s36, s36, 1
    v_mov_b32 v23, s36
    s_mov_b64 exec, 1
    buffer_store_dword v23, v22, s[44:47], 0 offen sc0 sc1
    s_mov_b64 exec, -1
L_a_notag:
    v_mov_b32 v40, 0
    v_mov_b32 v41, 0
    v_mov_b32 v42, 0
    v_mov_b32 v43, 0
    s_load_dwordx2 s[60:61], s[0:1], 32
    s_load_dwordx2 s[64:65], s[0:1], 48
    s_load_dwordx2 s[68:69], s[0:1], 0
    s_load_dwordx2 s[8:9], s[0:1], 40
    s_load_dwordx2 s[34:35], s[0:1], 56
    s_lshl_b32 s58, s19, 4
    s_add_u32 s58, s58, s22
    s_lshl_b32 s58, s58, 7
    s_add_u32 s58, s58, 16875520
    s_mul_i32 s50, s18, 3072
    s_mov_b32 s4, s44
    s_mov_b32 s5, s45
    s_mov_b32 s6, 256
    s_mov_b32 s7, 0x00020000
    s_waitcnt lgkmcnt(0)
    s_mov_b32 s62, 6291456
    s_mov_b32 s63, 0x00020000
    s_mov_b32 s66, 6291456
    s_mov_b32 s67, 0x00020000
    s_mov_b32 s70, 2621440
    s_mov_b32 s71, 0x00020000
    v_bfe_u32 v236, v1, 3, 2
    v_bfe_u32 v237, v1, 5, 1
    v_mul_u32_u24 v237, 16, v237
    v_add_u32 v236, v236, v237
    v_mul_u32_u24 v190, 3072, v236
    v_bfe_u32 v236, v1, 4, 1
    v_lshlrev_b32 v236, 2, v236
    v_and_b32 v237, 7, v1
    v_xor_b32 v236, v236, v237
    v_lshl_add_u32 v190, v236, 4, v190
    v_bfe_u32 v236, v1, 3, 2
    v_bfe_u32 v237, v1, 5, 1
    v_mul_u32_u24 v237, 16, v237
    v_add_u32 v236, v236, v237
    v_mul_u32_u24 v191, 4096, v236
    v_bfe_u32 v236, v1, 4, 1
    v_lshlrev_b32 v236, 2, v236
    v_and_b32 v237, 7, v1
    v_xor_b32 v236, v236, v237
    v_lshl_add_u32 v191, v236, 4, v191
    v_bfe_u32 v236, v1, 2, 2
    v_lshlrev_b32 v192, 7, v236
    v_lshrrev_b32 v237, 4, v1
    v_lshlrev_b32 v237, 1, v237
    v_bfe_u32 v236, v1, 1, 1
    v_add_u32 v237, v237, v236
    v_bfe_u32 v236, v1, 3, 1
    v_lshlrev_b32 v236, 2, v236
    v_xor_b32 v237, v237, v236
    v_lshl_add_u32 v192, v237, 4, v192
    v_and_b32 v236, 1, v1
    v_lshl_add_u32 v192, v236, 3, v192
    s_add_u32 s75, s50, 104448
    s_lshl_b32 s54, s18, 12
    s_add_u32 s54, s54, 129024
    v_add_u32 v196, s75, v192
    v_add_u32 v192, s54, v192
    v_lshrrev_b32 v236, 4, v1
    v_and_b32 v237, 15, v1
    v_lshlrev_b32 v238, 4, v237
    v_lshl_add_u32 v193, v236, 16, v238
    v_mul_u32_u24 v254, 49152, v236
    v_add_u32 v254, v254, v238
    v_mul_u32_u24 v195, 1280, v237
    v_lshl_add_u32 v195, v236, 3, v195
    s_lshr_b32 s26, s2, 2
    s_and_b32 s27, s2, 3
    s_mul_i32 s72, s26, 98304
    s_mul_i32 s28, s27, 12288
    s_add_u32 s72, s72, s28
    s_mul_i32 s28, s18, 384
    s_add_u32 s72, s72, s28
    s_mul_i32 s78, s18, 786432
    s_lshl_b32 s28, s2, 8
    s_add_u32 s78, s78, s28
    s_add_u32 s78, s78, 16908288
    s_lshl_b32 s26, s2, 3
    s_add_u32 s26, s26, s18
    s_and_b32 s27, s26, 31
    s_lshr_b32 s26, s26, 5
    s_mul_i32 s26, s26, 3
    s_mul_i32 s77, s27, 196608
    s_lshl_b32 s28, s26, 8
    s_add_u32 s77, s77, s28
    s_add_u32 s77, s77, 23199744
    s_lshl_b32 s27, s27, 7
    s_lshr_b32 s28, s26, 2
    s_lshl_b32 s73, s28, 17
    s_and_b32 s28, s26, 3
    s_lshl_b32 s28, s28, 14
    s_add_u32 s73, s73, s28
    s_add_u32 s73, s73, s27
    s_add_u32 s26, s26, 1
    s_lshr_b32 s28, s26, 2
    s_lshl_b32 s74, s28, 17
    s_and_b32 s28, s26, 3
    s_lshl_b32 s28, s28, 14
    s_add_u32 s74, s74, s28
    s_add_u32 s74, s74, s27
    s_add_u32 s26, s26, 1
    s_lshr_b32 s28, s26, 2
    s_lshl_b32 s76, s28, 17
    s_and_b32 s28, s26, 3
    s_lshl_b32 s28, s28, 14
    s_add_u32 s76, s76, s28
    s_add_u32 s76, s76, s27
    s_add_u32 s26, s26, 1
    s_lshr_b32 s21, s2, 3
    s_and_b32 s26, s2, 7
    s_lshl_b32 s26, s26, 2
    s_lshr_b32 s22, s21, 3
    s_add_u32 s26, s26, s22
    s_and_b32 s27, s21, 7
    s_bfe_u32 s29, s2, 0x20001
    s_add_u32 s29, s29, 1
    s_and_b32 s29, s29, 3
    s_mul_i32 s79, s27, 204800
    s_mul_i32 s28, s29, 25600
    s_add_u32 s79, s79, s28
    s_add_u32 s79, s79, 29753344
    s_lshl_b32 s29, s29, 3
    v_add_u32 v245, s29, v1
    v_and_b32 v245, 31, v245
    v_lshlrev_b32 v245, 7, v245
    s_lshr_b32 s28, s26, 2
    s_lshl_b32 s28, s28, 12
    s_add_u32 s28, s28, 16842752
    v_add_u32 v245, s28, v245
    s_lshl_b32 s28, s18, 12
    s_add_u32 s53, s79, s28
    s_add_u32 s53, s53, 73728
    s_add_u32 s79, s79, s50
    s_mul_i32 s28, s27, 5
    s_add_u32 s28, s28, s18
    s_mul_i32 s28, s28, 65536
    s_lshl_b32 s29, s26, 11
    s_add_u32 s28, s28, s29
    s_add_u32 s28, s28, 10485760
    s_cmp_lt_u32 s18, 5
    s_cselect_b32 s80, s28, 2147483648
    s_lshl_b32 s28, s26, 2
    s_and_b32 s29, s18, 3
    s_add_u32 s28, s28, s29
    s_lshl_b32 s28, s28, 11
    s_lshl_b32 s29, s27, 8
    s_add_u32 s28, s28, s29
    s_add_u32 s28, s28, 15990784
    s_lshl_b32 s29, s2, 7
    s_mul_i32 s59, s18, 32768
    s_add_u32 s59, s59, s29
    s_add_u32 s59, s59, 16744448
    s_cmp_ge_u32 s18, 4
    s_cselect_b32 s59, s28, s59
    s_cmp_eq_u32 s18, 2
    s_cselect_b32 s59, 2147483648, s59
    s_lshl_b32 s28, s26, 2
    s_and_b32 s29, s18, 3
    s_add_u32 s28, s28, s29
    s_mul_i32 s28, s28, 20480
    s_mul_i32 s29, s27, 160
    s_add_u32 s28, s28, s29
    s_cmp_ge_u32 s18, 4
    s_cselect_b32 s82, s28, 2147483648
    s_mov_b32 s10, 3072
    s_mov_b32 s11, 0x00020000
    v_lshlrev_b32 v246, 6, v1
    s_cmp_eq_u32 s18, 6
    s_cselect_b32 s8, s34, s8
    s_cselect_b32 s9, s35, s9
    s_cselect_b32 s10, 4096, s10
    s_mul_i32 s26, s21, 43
    s_lshr_b32 s26, s26, 8
    s_mul_i32 s27, s26, 6
    s_sub_u32 s27, s21, s27
    s_and_b32 s22, s2, 1
    s_mul_i32 s22, s22, 5
    s_add_u32 s26, s26, s22
    s_bfe_u32 s22, s2, 0x20001
    s_mul_i32 s22, s22, 6
    s_add_u32 s27, s27, s22
    s_mov_b32 s48, 0
    s_lshl_b32 s28, s27, 1
    s_and_b32 s29, s18, 1
    s_add_u32 s28, s28, s29
    s_lshl_b32 s28, s28, 17
    s_and_b32 s29, s18, 2
    s_lshl_b32 s29, s29, 10
    s_add_u32 s28, s28, s29
    s_add_u32 s45, s28, 16908288
    s_cmp_lt_u32 s18, 4
    s_cselect_b32 s28, 28672, 0
    s_cselect_b32 s29, 0, 46080
    s_cselect_b32 s46, 1024, 0
    s_cselect_b32 s47, 0, 3072
    s_add_u32 s48, s48, s28
    s_add_u32 s48, s48, s29
    s_and_b32 s48, s48, 0xffff
    s_add_u32 s44, s45, s48
    s_add_u32 s46, s46, s47
    s_sub_u32 s47, 4096, s46
    s_lshl_b32 s26, s26, 2
    s_lshr_b32 s28, s18, 1
    s_add_u32 s26, s26, s28
    s_mul_i32 s26, s26, 48
    s_lshl_b32 s27, s27, 1
    s_add_u32 s26, s26, s27
    s_and_b32 s28, s18, 1
    s_add_u32 s26, s26, s28
    s_lshl_b32 s26, s26, 10
    s_add_u32 s26, s26, 13107200
    s_cmp_lt_u32 s21, 30
    s_cselect_b32 s81, s26, 2147483648
    s_lshl_b32 s26, s2, 2
    s_add_u32 s26, s26, 16809984
    s_cmp_eq_u32 s18, 0
    s_cselect_b32 s83, s26, 2147483648
    v_mov_b32 v248, -1
    v_mov_b32 v249, -1
    v_mov_b32 v250, -1
    v_mov_b32 v251, -1
    s_lshr_b32 s26, s2, 3
    s_lshl_b32 s26, s26, 3
    s_getpc_b64 s[36:37]
L_pc1:
    s_add_u32 s36, s36, L_merge-L_pc1
    s_addc_u32 s37, s37, 0
    v_add_u32 v252, s26, v1
    v_add_u32 v252, 0, v252
    v_lshlrev_b32 v252, 7, v252
    v_min_u32 v252, L_end-L_merge-4, v252
    v_mov_b32 v253, s37
    v_add_co_u32 v252, vcc, s36, v252
    s_nop 1
    v_addc_co_u32 v253, vcc, 0, v253, vcc
    s_lshr_b32 s25, s18, 1
    s_and_b32 s26, s18, 1
    v_and_b32 v6, 15, v1
    v_lshrrev_b32 v7, 4, v1
    s_lshl_b32 s27, s25, 13
    v_lshl_add_u32 v4, v6, 7, s27
    v_lshrrev_b32 v5, 1, v6
    v_xor_b32 v5, v5, v7
    v_lshl_add_u32 v12, v5, 4, v4
    v_xor_b32 v13, 64, v12
    v_bfe_u32 v4, v1, 2, 2
    v_lshl_add_u32 v5, v7, 3, v4
    v_lshlrev_b32 v5, 8, v5
    v_bfe_u32 v4, v1, 2, 3
    s_lshl_b32 s27, s26, 2
    v_xor_b32 v4, s27, v4
    v_lshl_add_u32 v5, v4, 5, v5
    v_and_b32 v4, 3, v1
    v_lshl_add_u32 v5, v4, 3, v5
    v_add_u32 v14, 16384, v5
    v_xor_b32 v15, 32, v14
    v_xor_b32 v16, 64, v14
    v_xor_b32 v17, 96, v14
    v_mov_b32 v96, 0
    v_mov_b32 v97, 0
    v_mov_b32 v98, 0
    v_mov_b32 v99, 0
    v_mov_b32 v100, 0
    v_mov_b32 v101, 0
    v_mov_b32 v102, 0
    v_mov_b32 v103, 0
    v_mov_b32 v104, 0
    v_mov_b32 v105, 0
    v_mov_b32 v106, 0
    v_mov_b32 v107, 0
    v_mov_b32 v108, 0
    v_mov_b32 v109, 0
    v_mov_b32 v110, 0
    v_mov_b32 v111, 0
    v_mov_b32 v112, 0
    v_mov_b32 v113, 0
    v_mov_b32 v114, 0
    v_mov_b32 v115, 0
    v_mov_b32 v116, 0
    v_mov_b32 v117, 0
    v_mov_b32 v118, 0
    v_mov_b32 v119, 0
    v_mov_b32 v120, 0
    v_mov_b32 v121, 0
    v_mov_b32 v122, 0
    v_mov_b32 v123, 0
    v_mov_b32 v124, 0
    v_mov_b32 v125, 0
    v_mov_b32 v126, 0
    v_mov_b32 v127, 0
    v_mov_b32 v128, 0
    v_mov_b32 v129, 0
    v_mov_b32 v130, 0
    v_mov_b32 v131, 0
    v_mov_b32 v132, 0
    v_mov_b32 v133, 0
    v_mov_b32 v134, 0
    v_mov_b32 v135, 0
    v_mov_b32 v136, 0
    v_mov_b32 v137, 0
    v_mov_b32 v138, 0
    v_mov_b32 v139, 0
    v_mov_b32 v140, 0
    v_mov_b32 v141, 0
    v_mov_b32 v142, 0
    v_mov_b32 v143, 0
    v_mov_b32 v144, 0
    v_mov_b32 v145, 0
    v_mov_b32 v146, 0
    v_mov_b32 v147, 0
    v_mov_b32 v148, 0
    v_mov_b32 v149, 0
    v_mov_b32 v150, 0
    v_mov_b32 v151, 0
    v_mov_b32 v152, 0
    v_mov_b32 v153, 0
    v_mov_b32 v154, 0
    v_mov_b32 v155, 0
    v_mov_b32 v156, 0
    v_mov_b32 v157, 0
    v_mov_b32 v158, 0
    v_mov_b32 v159, 0
    v_add_u32 v18, 65536, v12
    v_add_u32 v24, 131072, v12
    v_add_u32 v19, 65536, v13
    v_add_u32 v25, 131072, v13
    v_add_u32 v20, 65536, v14
    v_add_u32 v26, 131072, v14
    v_add_u32 v21, 65536, v15
    v_add_u32 v27, 131072, v15
    v_add_u32 v22, 65536, v16
    v_add_u32 v28, 131072, v16
    v_add_u32 v23, 65536, v17
    v_add_u32 v29, 131072, v17
    s_mov_b32 s33, 0
    s_barrier
    ds_read_b128 v[32:35], v12 offset:0
    ds_read_b64_tr_b16 v[48:49], v14 offset:0
    ds_read_b64_tr_b16 v[50:51], v14 offset:1024
    ds_read_b128 v[36:39], v12 offset:2048
    ds_read_b64_tr_b16 v[52:53], v15 offset:0
    ds_read_b64_tr_b16 v[54:55], v15 offset:1024
    ds_read_b128 v[40:43], v12 offset:4096
    ds_read_b128 v[44:47], v12 offset:6144
    ds_read_b64_tr_b16 v[56:57], v16 offset:0
    ds_read_b64_tr_b16 v[58:59], v16 offset:1024
    ds_read_b64_tr_b16 v[60:61], v17 offset:0
    ds_read_b64_tr_b16 v[62:63], v17 offset:1024
    s_cmp_ge_u32 s19, 10
    s_cbranch_scc1 L_a_cloopV
L_a_cloopQ:
    s_waitcnt lgkmcnt(4)
    v_mfma_f32_16x16x32_bf16 v[96:99], v[48:51], v[32:35], v[96:99]
    v_mfma_f32_16x16x32_bf16 v[112:115], v[48:51], v[36:39], v[112:115]
    ds_read_b128 v[64:67], v13 offset:0
    v_mfma_f32_16x16x32_bf16 v[100:103], v[52:55], v[32:35], v[100:103]
    ds_read_b64_tr_b16 v[80:81], v14 offset:8192
    v_mfma_f32_16x16x32_bf16 v[116:119], v[52:55], v[36:39], v[116:119]
    ds_read_b64_tr_b16 v[82:83], v14 offset:9216
    v_mfma_f32_16x16x32_bf16 v[128:131], v[48:51], v[40:43], v[128:131]
    ds_read_b128 v[68:71], v13 offset:2048
    v_mfma_f32_16x16x32_bf16 v[132:135], v[52:55], v[40:43], v[132:135]
    ds_read_b64_tr_b16 v[84:85], v15 offset:8192
    v_mfma_f32_16x16x32_bf16 v[144:147], v[48:51], v[44:47], v[144:147]
    ds_read_b64_tr_b16 v[86:87], v15 offset:9216
    v_mfma_f32_16x16x32_bf16 v[148:151], v[52:55], v[44:47], v[148:151]
    s_waitcnt lgkmcnt(6)
    v_mfma_f32_16x16x32_bf16 v[104:107], v[56:59], v[32:35], v[104:107]
    ds_read_b128 v[72:75], v13 offset:4096
    v_mfma_f32_16x16x32_bf16 v[120:123], v[56:59], v[36:39], v[120:123]
    ds_read_b128 v[76:79], v13 offset:6144
    v_mfma_f32_16x16x32_bf16 v[136:139], v[56:59], v[40:43], v[136:139]
    ds_read_b64_tr_b16 v[88:89], v16 offset:8192
    v_mfma_f32_16x16x32_bf16 v[152:155], v[56:59], v[44:47], v[152:155]
    ds_read_b64_tr_b16 v[90:91], v16 offset:9216
    v_mfma_f32_16x16x32_bf16 v[108:111], v[60:63], v[32:35], v[108:111]
    ds_read_b64_tr_b16 v[92:93], v17 offset:8192
    v_mfma_f32_16x16x32_bf16 v[124:127], v[60:63], v[36:39], v[124:127]
    ds_read_b64_tr_b16 v[94:95], v17 offset:9216
    v_mfma_f32_16x16x32_bf16 v[140:143], v[60:63], v[40:43], v[140:143]
    v_mfma_f32_16x16x32_bf16 v[156:159], v[60:63], v[44:47], v[156:159]
    s_waitcnt lgkmcnt(4)
    v_mfma_f32_16x16x32_bf16 v[96:99], v[80:83], v[64:67], v[96:99]
    s_barrier
    v_mfma_f32_16x16x32_bf16 v[112:115], v[80:83], v[68:71], v[112:115]
    ds_read_b128 v[32:35], v12 offset:32768
    v_mfma_f32_16x16x32_bf16 v[100:103], v[84:87], v[64:67], v[100:103]
    ds_read_b64_tr_b16 v[48:49], v14 offset:32768
    v_mfma_f32_16x16x32_bf16 v[116:119], v[84:87], v[68:71], v[116:119]
    ds_read_b64_tr_b16 v[50:51], v14 offset:33792
    v_mfma_f32_16x16x32_bf16 v[128:131], v[80:83], v[72:75], v[128:131]
    ds_read_b128 v[36:39], v12 offset:34816
    v_mfma_f32_16x16x32_bf16 v[132:135], v[84:87], v[72:75], v[132:135]
    ds_read_b64_tr_b16 v[52:53], v15 offset:32768
    v_mfma_f32_16x16x32_bf16 v[144:147], v[80:83], v[76:79], v[144:147]
    ds_read_b64_tr_b16 v[54:55], v15 offset:33792
    v_mfma_f32_16x16x32_bf16 v[148:151], v[84:87], v[76:79], v[148:151]
    s_waitcnt lgkmcnt(6)
    v_mfma_f32_16x16x32_bf16 v[104:107], v[88:91], v[64:67], v[104:107]
    ds_read_b128 v[40:43], v12 offset:36864
    v_mfma_f32_16x16x32_bf16 v[120:123], v[88:91], v[68:71], v[120:123]
    ds_read_b128 v[44:47], v12 offset:38912
    v_mfma_f32_16x16x32_bf16 v[136:139], v[88:91], v[72:75], v[136:139]
    ds_read_b64_tr_b16 v[56:57], v16 offset:32768
    v_mfma_f32_16x16x32_bf16 v[152:155], v[88:91], v[76:79], v[152:155]
    ds_read_b64_tr_b16 v[58:59], v16 offset:33792
    v_mfma_f32_16x16x32_bf16 v[108:111], v[92:95], v[64:67], v[108:111]
    ds_read_b64_tr_b16 v[60:61], v17 offset:32768
    v_mfma_f32_16x16x32_bf16 v[124:127], v[92:95], v[68:71], v[124:127]
    ds_read_b64_tr_b16 v[62:63], v17 offset:33792
    v_mfma_f32_16x16x32_bf16 v[140:143], v[92:95], v[72:75], v[140:143]
    v_mfma_f32_16x16x32_bf16 v[156:159], v[92:95], v[76:79], v[156:159]
    s_waitcnt lgkmcnt(4)
    v_mfma_f32_16x16x32_bf16 v[96:99], v[48:51], v[32:35], v[96:99]
    v_mfma_f32_16x16x32_bf16 v[112:115], v[48:51], v[36:39], v[112:115]
    ds_read_b128 v[64:67], v13 offset:32768
    v_mfma_f32_16x16x32_bf16 v[100:103], v[52:55], v[32:35], v[100:103]
    ds_read_b64_tr_b16 v[80:81], v14 offset:40960
    v_mfma_f32_16x16x32_bf16 v[116:119], v[52:55], v[36:39], v[116:119]
    ds_read_b64_tr_b16 v[82:83], v14 offset:41984
    v_mfma_f32_16x16x32_bf16 v[128:131], v[48:51], v[40:43], v[128:131]
    ds_read_b128 v[68:71], v13 offset:34816
    v_mfma_f32_16x16x32_bf16 v[132:135], v[52:55], v[40:43], v[132:135]
    ds_read_b64_tr_b16 v[84:85], v15 offset:40960
    v_mfma_f32_16x16x32_bf16 v[144:147], v[48:51], v[44:47], v[144:147]
    ds_read_b64_tr_b16 v[86:87], v15 offset:41984
    v_mfma_f32_16x16x32_bf16 v[148:151], v[52:55], v[44:47], v[148:151]
    s_waitcnt lgkmcnt(6)
    v_mfma_f32_16x16x32_bf16 v[104:107], v[56:59], v[32:35], v[104:107]
    ds_read_b128 v[72:75], v13 offset:36864
    v_mfma_f32_16x16x32_bf16 v[120:123], v[56:59], v[36:39], v[120:123]
    ds_read_b128 v[76:79], v13 offset:38912
    v_mfma_f32_16x16x32_bf16 v[136:139], v[56:59], v[40:43], v[136:139]
    ds_read_b64_tr_b16 v[88:89], v16 offset:40960
    v_mfma_f32_16x16x32_bf16 v[152:155], v[56:59], v[44:47], v[152:155]
    ds_read_b64_tr_b16 v[90:91], v16 offset:41984
    v_mfma_f32_16x16x32_bf16 v[108:111], v[60:63], v[32:35], v[108:111]
    ds_read_b64_tr_b16 v[92:93], v17 offset:40960
    v_mfma_f32_16x16x32_bf16 v[124:127], v[60:63], v[36:39], v[124:127]
    ds_read_b64_tr_b16 v[94:95], v17 offset:41984
    v_mfma_f32_16x16x32_bf16 v[140:143], v[60:63], v[40:43], v[140:143]
    v_mfma_f32_16x16x32_bf16 v[156:159], v[60:63], v[44:47], v[156:159]
    s_waitcnt lgkmcnt(4)
    v_mfma_f32_16x16x32_bf16 v[96:99], v[80:83], v[64:67], v[96:99]
    s_barrier
    v_mfma_f32_16x16x32_bf16 v[112:115], v[80:83], v[68:71], v[112:115]
    ds_read_b128 v[32:35], v18 offset:0
    v_mfma_f32_16x16x32_bf16 v[100:103], v[84:87], v[64:67], v[100:103]
    ds_read_b64_tr_b16 v[48:49], v20 offset:0
    v_mfma_f32_16x16x32_bf16 v[116:119], v[84:87], v[68:71], v[116:119]
    ds_read_b64_tr_b16 v[50:51], v20 offset:1024
    v_mfma_f32_16x16x32_bf16 v[128:131], v[80:83], v[72:75], v[128:131]
    ds_read_b128 v[36:39], v18 offset:2048
    v_mfma_f32_16x16x32_bf16 v[132:135], v[84:87], v[72:75], v[132:135]
    ds_read_b64_tr_b16 v[52:53], v21 offset:0
    v_mfma_f32_16x16x32_bf16 v[144:147], v[80:83], v[76:79], v[144:147]
    ds_read_b64_tr_b16 v[54:55], v21 offset:1024
    v_mfma_f32_16x16x32_bf16 v[148:151], v[84:87], v[76:79], v[148:151]
    s_waitcnt lgkmcnt(6)
    v_mfma_f32_16x16x32_bf16 v[104:107], v[88:91], v[64:67], v[104:107]
    ds_read_b128 v[40:43], v18 offset:4096
    v_mfma_f32_16x16x32_bf16 v[120:123], v[88:91], v[68:71], v[120:123]
    ds_read_b128 v[44:47], v18 offset:6144
    v_mfma_f32_16x16x32_bf16 v[136:139], v[88:91], v[72:75], v[136:139]
    ds_read_b64_tr_b16 v[56:57], v22 offset:0
    v_mfma_f32_16x16x32_bf16 v[152:155], v[88:91], v[76:79], v[152:155]
    ds_read_b64_tr_b16 v[58:59], v22 offset:1024
    v_mfma_f32_16x16x32_bf16 v[108:111], v[92:95], v[64:67], v[108:111]
    ds_read_b64_tr_b16 v[60:61], v23 offset:0
    v_mfma_f32_16x16x32_bf16 v[124:127], v[92:95], v[68:71], v[124:127]
    ds_read_b64_tr_b16 v[62:63], v23 offset:1024
    v_mfma_f32_16x16x32_bf16 v[140:143], v[92:95], v[72:75], v[140:143]
    v_mfma_f32_16x16x32_bf16 v[156:159], v[92:95], v[76:79], v[156:159]
    s_waitcnt lgkmcnt(4)
    v_mfma_f32_16x16x32_bf16 v[96:99], v[48:51], v[32:35], v[96:99]
    v_mfma_f32_16x16x32_bf16 v[112:115], v[48:51], v[36:39], v[112:115]
    ds_read_b128 v[64:67], v19 offset:0
    v_mfma_f32_16x16x32_bf16 v[100:103], v[52:55], v[32:35], v[100:103]
    ds_read_b64_tr_b16 v[80:81], v20 offset:8192
    v_mfma_f32_16x16x32_bf16 v[116:119], v[52:55], v[36:39], v[116:119]
    ds_read_b64_tr_b16 v[82:83], v20 offset:9216
    v_mfma_f32_16x16x32_bf16 v[128:131], v[48:51], v[40:43], v[128:131]
    ds_read_b128 v[68:71], v19 offset:2048
    v_mfma_f32_16x16x32_bf16 v[132:135], v[52:55], v[40:43], v[132:135]
    ds_read_b64_tr_b16 v[84:85], v21 offset:8192
    v_mfma_f32_16x16x32_bf16 v[144:147], v[48:51], v[44:47], v[144:147]
    ds_read_b64_tr_b16 v[86:87], v21 offset:9216
    v_mfma_f32_16x16x32_bf16 v[148:151], v[52:55], v[44:47], v[148:151]
    s_waitcnt lgkmcnt(6)
    v_mfma_f32_16x16x32_bf16 v[104:107], v[56:59], v[32:35], v[104:107]
    ds_read_b128 v[72:75], v19 offset:4096
    v_mfma_f32_16x16x32_bf16 v[120:123], v[56:59], v[36:39], v[120:123]
    ds_read_b128 v[76:79], v19 offset:6144
    v_mfma_f32_16x16x32_bf16 v[136:139], v[56:59], v[40:43], v[136:139]
    ds_read_b64_tr_b16 v[88:89], v22 offset:8192
    v_mfma_f32_16x16x32_bf16 v[152:155], v[56:59], v[44:47], v[152:155]
    ds_read_b64_tr_b16 v[90:91], v22 offset:9216
    v_mfma_f32_16x16x32_bf16 v[108:111], v[60:63], v[32:35], v[108:111]
    ds_read_b64_tr_b16 v[92:93], v23 offset:8192
    v_mfma_f32_16x16x32_bf16 v[124:127], v[60:63], v[36:39], v[124:127]
    ds_read_b64_tr_b16 v[94:95], v23 offset:9216
    v_mfma_f32_16x16x32_bf16 v[140:143], v[60:63], v[40:43], v[140:143]
    v_mfma_f32_16x16x32_bf16 v[156:159], v[60:63], v[44:47], v[156:159]
    s_waitcnt lgkmcnt(4)
    v_mfma_f32_16x16x32_bf16 v[96:99], v[80:83], v[64:67], v[96:99]
    s_barrier
    v_mfma_f32_16x16x32_bf16 v[112:115], v[80:83], v[68:71], v[112:115]
    ds_read_b128 v[32:35], v18 offset:32768
    v_mfma_f32_16x16x32_bf16 v[100:103], v[84:87], v[64:67], v[100:103]
    ds_read_b64_tr_b16 v[48:49], v20 offset:32768
    v_mfma_f32_16x16x32_bf16 v[116:119], v[84:87], v[68:71], v[116:119]
    ds_read_b64_tr_b16 v[50:51], v20 offset:33792
    v_mfma_f32_16x16x32_bf16 v[128:131], v[80:83], v[72:75], v[128:131]
    ds_read_b128 v[36:39], v18 offset:34816
    v_mfma_f32_16x16x32_bf16 v[132:135], v[84:87], v[72:75], v[132:135]
    ds_read_b64_tr_b16 v[52:53], v21 offset:32768
    v_mfma_f32_16x16x32_bf16 v[144:147], v[80:83], v[76:79], v[144:147]
    ds_read_b64_tr_b16 v[54:55], v21 offset:33792
    v_mfma_f32_16x16x32_bf16 v[148:151], v[84:87], v[76:79], v[148:151]
    s_waitcnt lgkmcnt(6)
    v_mfma_f32_16x16x32_bf16 v[104:107], v[88:91], v[64:67], v[104:107]
    ds_read_b128 v[40:43], v18 offset:36864
    v_mfma_f32_16x16x32_bf16 v[120:123], v[88:91], v[68:71], v[120:123]
    ds_read_b128 v[44:47], v18 offset:38912
    v_mfma_f32_16x16x32_bf16 v[136:139], v[88:91], v[72:75], v[136:139]
    ds_read_b64_tr_b16 v[56:57], v22 offset:32768
    v_mfma_f32_16x16x32_bf16 v[152:155], v[88:91], v[76:79], v[152:155]
    ds_read_b64_tr_b16 v[58:59], v22 offset:33792
    v_mfma_f32_16x16x32_bf16 v[108:111], v[92:95], v[64:67], v[108:111]
    ds_read_b64_tr_b16 v[60:61], v23 offset:32768
    v_mfma_f32_16x16x32_bf16 v[124:127], v[92:95], v[68:71], v[124:127]
    ds_read_b64_tr_b16 v[62:63], v23 offset:33792
    v_mfma_f32_16x16x32_bf16 v[140:143], v[92:95], v[72:75], v[140:143]
    v_mfma_f32_16x16x32_bf16 v[156:159], v[92:95], v[76:79], v[156:159]
    s_waitcnt lgkmcnt(4)
    v_mfma_f32_16x16x32_bf16 v[96:99], v[48:51], v[32:35], v[96:99]
    v_mfma_f32_16x16x32_bf16 v[112:115], v[48:51], v[36:39], v[112:115]
    ds_read_b128 v[64:67], v19 offset:32768
    v_mfma_f32_16x16x32_bf16 v[100:103], v[52:55], v[32:35], v[100:103]
    ds_read_b64_tr_b16 v[80:81], v20 offset:40960
    v_mfma_f32_16x16x32_bf16 v[116:119], v[52:55], v[36:39], v[116:119]
    ds_read_b64_tr_b16 v[82:83], v20 offset:41984
    v_mfma_f32_16x16x32_bf16 v[128:131], v[48:51], v[40:43], v[128:131]
    ds_read_b128 v[68:71], v19 offset:34816
    v_mfma_f32_16x16x32_bf16 v[132:135], v[52:55], v[40:43], v[132:135]
    ds_read_b64_tr_b16 v[84:85], v21 offset:40960
    v_mfma_f32_16x16x32_bf16 v[144:147], v[48:51], v[44:47], v[144:147]
    ds_read_b64_tr_b16 v[86:87], v21 offset:41984
    v_mfma_f32_16x16x32_bf16 v[148:151], v[52:55], v[44:47], v[148:151]
    s_waitcnt lgkmcnt(6)
    v_mfma_f32_16x16x32_bf16 v[104:107], v[56:59], v[32:35], v[104:107]
    ds_read_b128 v[72:75], v19 offset:36864
    v_mfma_f32_16x16x32_bf16 v[120:123], v[56:59], v[36:39], v[120:123]
    ds_read_b128 v[76:79], v19 offset:38912
    v_mfma_f32_16x16x32_bf16 v[136:139], v[56:59], v[40:43], v[136:139]
    ds_read_b64_tr_b16 v[88:89], v22 offset:40960
    v_mfma_f32_16x16x32_bf16 v[152:155], v[56:59], v[44:47], v[152:155]
    ds_read_b64_tr_b16 v[90:91], v22 offset:41984
    v_mfma_f32_16x16x32_bf16 v[108:111], v[60:63], v[32:35], v[108:111]
    ds_read_b64_tr_b16 v[92:93], v23 offset:40960
    v_mfma_f32_16x16x32_bf16 v[124:127], v[60:63], v[36:39], v[124:127]
    ds_read_b64_tr_b16 v[94:95], v23 offset:41984
    v_mfma_f32_16x16x32_bf16 v[140:143], v[60:63], v[40:43], v[140:143]
    v_mfma_f32_16x16x32_bf16 v[156:159], v[60:63], v[44:47], v[156:159]
    s_waitcnt lgkmcnt(4)
    v_mfma_f32_16x16x32_bf16 v[96:99], v[80:83], v[64:67], v[96:99]
    s_barrier
    v_mfma_f32_16x16x32_bf16 v[112:115], v[80:83], v[68:71], v[112:115]
    ds_read_b128 v[32:35], v24 offset:0
    v_mfma_f32_16x16x32_bf16 v[100:103], v[84:87], v[64:67], v[100:103]
    ds_read_b64_tr_b16 v[48:49], v26 offset:0
    v_mfma_f32_16x16x32_bf16 v[116:119], v[84:87], v[68:71], v[116:119]
    ds_read_b64_tr_b16 v[50:51], v26 offset:1024
    v_mfma_f32_16x16x32_bf16 v[128:131], v[80:83], v[72:75], v[128:131]
    ds_read_b128 v[36:39], v24 offset:2048
    v_mfma_f32_16x16x32_bf16 v[132:135], v[84:87], v[72:75], v[132:135]
    ds_read_b64_tr_b16 v[52:53], v27 offset:0
    v_mfma_f32_16x16x32_bf16 v[144:147], v[80:83], v[76:79], v[144:147]
    ds_read_b64_tr_b16 v[54:55], v27 offset:1024
    v_mfma_f32_16x16x32_bf16 v[148:151], v[84:87], v[76:79], v[148:151]
    s_waitcnt lgkmcnt(6)
    v_mfma_f32_16x16x32_bf16 v[104:107], v[88:91], v[64:67], v[104:107]
    ds_read_b128 v[40:43], v24 offset:4096
    v_mfma_f32_16x16x32_bf16 v[120:123], v[88:91], v[68:71], v[120:123]
    ds_read_b128 v[44:47], v24 offset:6144
    v_mfma_f32_16x16x32_bf16 v[136:139], v[88:91], v[72:75], v[136:139]
    ds_read_b64_tr_b16 v[56:57], v28 offset:0
    v_mfma_f32_16x16x32_bf16 v[152:155], v[88:91], v[76:79], v[152:155]
    ds_read_b64_tr_b16 v[58:59], v28 offset:1024
    v_mfma_f32_16x16x32_bf16 v[108:111], v[92:95], v[64:67], v[108:111]
    ds_read_b64_tr_b16 v[60:61], v29 offset:0
    v_mfma_f32_16x16x32_bf16 v[124:127], v[92:95], v[68:71], v[124:127]
    ds_read_b64_tr_b16 v[62:63], v29 offset:1024
    v_mfma_f32_16x16x32_bf16 v[140:143], v[92:95], v[72:75], v[140:143]
    v_mfma_f32_16x16x32_bf16 v[156:159], v[92:95], v[76:79], v[156:159]
    s_waitcnt lgkmcnt(4)
    v_mfma_f32_16x16x32_bf16 v[96:99], v[48:51], v[32:35], v[96:99]
    v_mfma_f32_16x16x32_bf16 v[112:115], v[48:51], v[36:39], v[112:115]
    ds_read_b128 v[64:67], v25 offset:0
    v_mfma_f32_16x16x32_bf16 v[100:103], v[52:55], v[32:35], v[100:103]
    ds_read_b64_tr_b16 v[80:81], v26 offset:8192
    v_mfma_f32_16x16x32_bf16 v[116:119], v[52:55], v[36:39], v[116:119]
    ds_read_b64_tr_b16 v[82:83], v26 offset:9216
    v_mfma_f32_16x16x32_bf16 v[128:131], v[48:51], v[40:43], v[128:131]
    ds_read_b128 v[68:71], v25 offset:2048
    v_mfma_f32_16x16x32_bf16 v[132:135], v[52:55], v[40:43], v[132:135]
    ds_read_b64_tr_b16 v[84:85], v27 offset:8192
    v_mfma_f32_16x16x32_bf16 v[144:147], v[48:51], v[44:47], v[144:147]
    ds_read_b64_tr_b16 v[86:87], v27 offset:9216
    v_mfma_f32_16x16x32_bf16 v[148:151], v[52:55], v[44:47], v[148:151]
    s_waitcnt lgkmcnt(6)
    v_mfma_f32_16x16x32_bf16 v[104:107], v[56:59], v[32:35], v[104:107]
    ds_read_b128 v[72:75], v25 offset:4096
    v_mfma_f32_16x16x32_bf16 v[120:123], v[56:59], v[36:39], v[120:123]
    ds_read_b128 v[76:79], v25 offset:6144
    v_mfma_f32_16x16x32_bf16 v[136:139], v[56:59], v[40:43], v[136:139]
    ds_read_b64_tr_b16 v[88:89], v28 offset:8192
    v_mfma_f32_16x16x32_bf16 v[152:155], v[56:59], v[44:47], v[152:155]
    ds_read_b64_tr_b16 v[90:91], v28 offset:9216
    v_mfma_f32_16x16x32_bf16 v[108:111], v[60:63], v[32:35], v[108:111]
    ds_read_b64_tr_b16 v[92:93], v29 offset:8192
    v_mfma_f32_16x16x32_bf16 v[124:127], v[60:63], v[36:39], v[124:127]
    ds_read_b64_tr_b16 v[94:95], v29 offset:9216
    v_mfma_f32_16x16x32_bf16 v[140:143], v[60:63], v[40:43], v[140:143]
    s_add_u32 s33, s33, 1
    s_cmp_lt_u32 s33, 2
    v_mfma_f32_16x16x32_bf16 v[156:159], v[60:63], v[44:47], v[156:159]
    s_waitcnt lgkmcnt(4)
    v_mfma_f32_16x16x32_bf16 v[96:99], v[80:83], v[64:67], v[96:99]
    s_cbranch_scc0 L_a_nb0
    s_barrier
L_a_nb0:
    v_mfma_f32_16x16x32_bf16 v[112:115], v[80:83], v[68:71], v[112:115]
    ds_read_b128 v[32:35], v12 offset:0
    v_mfma_f32_16x16x32_bf16 v[100:103], v[84:87], v[64:67], v[100:103]
    ds_read_b64_tr_b16 v[48:49], v14 offset:0
    v_mfma_f32_16x16x32_bf16 v[116:119], v[84:87], v[68:71], v[116:119]
    ds_read_b64_tr_b16 v[50:51], v14 offset:1024
    v_mfma_f32_16x16x32_bf16 v[128:131], v[80:83], v[72:75], v[128:131]
    ds_read_b128 v[36:39], v12 offset:2048
    v_mfma_f32_16x16x32_bf16 v[132:135], v[84:87], v[72:75], v[132:135]
    ds_read_b64_tr_b16 v[52:53], v15 offset:0
    v_mfma_f32_16x16x32_bf16 v[144:147], v[80:83], v[76:79], v[144:147]
    ds_read_b64_tr_b16 v[54:55], v15 offset:1024
    v_mfma_f32_16x16x32_bf16 v[148:151], v[84:87], v[76:79], v[148:151]
    s_waitcnt lgkmcnt(6)
    v_mfma_f32_16x16x32_bf16 v[104:107], v[88:91], v[64:67], v[104:107]
    ds_read_b128 v[40:43], v12 offset:4096
    v_mfma_f32_16x16x32_bf16 v[120:123], v[88:91], v[68:71], v[120:123]
    ds_read_b128 v[44:47], v12 offset:6144
    v_mfma_f32_16x16x32_bf16 v[136:139], v[88:91], v[72:75], v[136:139]
    ds_read_b64_tr_b16 v[56:57], v16 offset:0
    v_mfma_f32_16x16x32_bf16 v[152:155], v[88:91], v[76:79], v[152:155]
    ds_read_b64_tr_b16 v[58:59], v16 offset:1024
    v_mfma_f32_16x16x32_bf16 v[108:111], v[92:95], v[64:67], v[108:111]
    ds_read_b64_tr_b16 v[60:61], v17 offset:0
    v_mfma_f32_16x16x32_bf16 v[124:127], v[92:95], v[68:71], v[124:127]
    ds_read_b64_tr_b16 v[62:63], v17 offset:1024
    v_mfma_f32_16x16x32_bf16 v[140:143], v[92:95], v[72:75], v[140:143]
    v_mfma_f32_16x16x32_bf16 v[156:159], v[92:95], v[76:79], v[156:159]
    s_cbranch_scc1 L_a_cloopQ
    s_waitcnt lgkmcnt(0)
    s_barrier
    s_lshl_b32 s27, s26, 8
    s_add_u32 s27, s27, 33792
    v_lshl_add_u32 v4, v7, 4, s27
    s_lshl_b32 s27, s25, 9
    s_add_u32 s27, s27, 34816
    v_lshl_add_u32 v5, v6, 3, s27
    ds_read_b64 v[48:49], v5 offset:0
    ds_read_b64 v[50:51], v5 offset:128
    ds_read_b64 v[52:53], v5 offset:256
    ds_read_b64 v[54:55], v5 offset:384
    ds_read_b128 v[32:35], v4 offset:0
    ds_read_b128 v[36:39], v4 offset:64
    ds_read_b128 v[40:43], v4 offset:128
    ds_read_b128 v[44:47], v4 offset:192
    s_lshl_b32 s27, s25, 6
    s_add_u32 s27, s27, s16
    v_add_u32 v8, s27, v10
    v_lshlrev_b32 v8, 4, v8
    v_lshl_add_u32 v8, v11, 15, v8
    s_lshl_b32 s27, s19, 4
    s_lshl_b32 s28, s26, 3
    s_add_u32 s27, s27, s28
    s_lshl_b32 s27, s27, 15
    s_add_u32 s28, s27, 0
    s_waitcnt lgkmcnt(3)
    v_pk_fma_f32 v[96:97], v[32:33], v[48:49], v[96:97] op_sel_hi:[1,0,1]
    v_pk_fma_f32 v[98:99], v[34:35], v[48:49], v[98:99] op_sel_hi:[1,0,1]
    v_pk_fma_f32 v[112:113], v[32:33], v[50:51], v[112:113] op_sel_hi:[1,0,1]
    v_pk_fma_f32 v[114:115], v[34:35], v[50:51], v[114:115] op_sel_hi:[1,0,1]
    v_pk_mul_f32 v[96:97], v[96:97], v[48:49] op_sel:[0,1] op_sel_hi:[1,1]
    v_pk_mul_f32 v[98:99], v[98:99], v[48:49] op_sel:[0,1] op_sel_hi:[1,1]
    v_pk_mul_f32 v[112:113], v[112:113], v[50:51] op_sel:[0,1] op_sel_hi:[1,1]
    v_pk_mul_f32 v[114:115], v[114:115], v[50:51] op_sel:[0,1] op_sel_hi:[1,1]
    v_cvt_pk_bf16_f32 v56, v96, v97
    v_cvt_pk_bf16_f32 v58, v112, v113
    v_cvt_pk_bf16_f32 v57, v98, v99
    v_cvt_pk_bf16_f32 v59, v114, v115
    s_nop 0
    v_permlane16_swap_b32 v56, v58
    v_permlane16_swap_b32 v57, v59
    buffer_store_dwordx4 v[56:59], v8, s[12:15], s28 offen offset:0 sc0 sc1
    v_pk_fma_f32 v[128:129], v[32:33], v[52:53], v[128:129] op_sel_hi:[1,0,1]
    v_pk_fma_f32 v[130:131], v[34:35], v[52:53], v[130:131] op_sel_hi:[1,0,1]
    v_pk_fma_f32 v[144:145], v[32:33], v[54:55], v[144:145] op_sel_hi:[1,0,1]
    v_pk_fma_f32 v[146:147], v[34:35], v[54:55], v[146:147] op_sel_hi:[1,0,1]
    v_pk_mul_f32 v[128:129], v[128:129], v[52:53] op_sel:[0,1] op_sel_hi:[1,1]
    v_pk_mul_f32 v[130:131], v[130:131], v[52:53] op_sel:[0,1] op_sel_hi:[1,1]
    v_pk_mul_f32 v[144:145], v[144:145], v[54:55] op_sel:[0,1] op_sel_hi:[1,1]
    v_pk_mul_f32 v[146:147], v[146:147], v[54:55] op_sel:[0,1] op_sel_hi:[1,1]
    v_cvt_pk_bf16_f32 v60, v128, v129
    v_cvt_pk_bf16_f32 v62, v144, v145
    v_cvt_pk_bf16_f32 v61, v130, v131
    v_cvt_pk_bf16_f32 v63, v146, v147
    s_nop 0
    v_permlane16_swap_b32 v60, v62
    v_permlane16_swap_b32 v61, v63
    buffer_store_dwordx4 v[60:63], v8, s[12:15], s28 offen offset:512 sc0 sc1
    s_add_u32 s28, s27, 65536
    s_waitcnt lgkmcnt(2)
    v_pk_fma_f32 v[100:101], v[36:37], v[48:49], v[100:101] op_sel_hi:[1,0,1]
    v_pk_fma_f32 v[102:103], v[38:39], v[48:49], v[102:103] op_sel_hi:[1,0,1]
    v_pk_fma_f32 v[116:117], v[36:37], v[50:51], v[116:117] op_sel_hi:[1,0,1]
    v_pk_fma_f32 v[118:119], v[38:39], v[50:51], v[118:119] op_sel_hi:[1,0,1]
    v_pk_mul_f32 v[100:101], v[100:101], v[48:49] op_sel:[0,1] op_sel_hi:[1,1]
    v_pk_mul_f32 v[102:103], v[102:103], v[48:49] op_sel:[0,1] op_sel_hi:[1,1]
    v_pk_mul_f32 v[116:117], v[116:117], v[50:51] op_sel:[0,1] op_sel_hi:[1,1]
    v_pk_mul_f32 v[118:119], v[118:119], v[50:51] op_sel:[0,1] op_sel_hi:[1,1]
    v_cvt_pk_bf16_f32 v64, v100, v101
    v_cvt_pk_bf16_f32 v66, v116, v117
    v_cvt_pk_bf16_f32 v65, v102, v103
    v_cvt_pk_bf16_f32 v67, v118, v119
    s_nop 0
    v_permlane16_swap_b32 v64, v66
    v_permlane16_swap_b32 v65, v67
    buffer_store_dwordx4 v[64:67], v8, s[12:15], s28 offen offset:0 sc0 sc1
    v_pk_fma_f32 v[132:133], v[36:37], v[52:53], v[132:133] op_sel_hi:[1,0,1]
    v_pk_fma_f32 v[134:135], v[38:39], v[52:53], v[134:135] op_sel_hi:[1,0,1]
    v_pk_fma_f32 v[148:149], v[36:37], v[54:55], v[148:149] op_sel_hi:[1,0,1]
    v_pk_fma_f32 v[150:151], v[38:39], v[54:55], v[150:151] op_sel_hi:[1,0,1]
    v_pk_mul_f32 v[132:133], v[132:133], v[52:53] op_sel:[0,1] op_sel_hi:[1,1]
    v_pk_mul_f32 v[134:135], v[134:135], v[52:53] op_sel:[0,1] op_sel_hi:[1,1]
    v_pk_mul_f32 v[148:149], v[148:149], v[54:55] op_sel:[0,1] op_sel_hi:[1,1]
    v_pk_mul_f32 v[150:151], v[150:151], v[54:55] op_sel:[0,1] op_sel_hi:[1,1]
    v_cvt_pk_bf16_f32 v56, v132, v133
    v_cvt_pk_bf16_f32 v58, v148, v149
    v_cvt_pk_bf16_f32 v57, v134, v135
    v_cvt_pk_bf16_f32 v59, v150, v151
    s_nop 0
    v_permlane16_swap_b32 v56, v58
    v_permlane16_swap_b32 v57, v59
    buffer_store_dwordx4 v[56:59], v8, s[12:15], s28 offen offset:512 sc0 sc1
    s_add_u32 s28, s27, 131072
    s_waitcnt lgkmcnt(1)
    v_pk_fma_f32 v[104:105], v[40:41], v[48:49], v[104:105] op_sel_hi:[1,0,1]
    v_pk_fma_f32 v[106:107], v[42:43], v[48:49], v[106:107] op_sel_hi:[1,0,1]
    v_pk_fma_f32 v[120:121], v[40:41], v[50:51], v[120:121] op_sel_hi:[1,0,1]
    v_pk_fma_f32 v[122:123], v[42:43], v[50:51], v[122:123] op_sel_hi:[1,0,1]
    v_pk_mul_f32 v[104:105], v[104:105], v[48:49] op_sel:[0,1] op_sel_hi:[1,1]
    v_pk_mul_f32 v[106:107], v[106:107], v[48:49] op_sel:[0,1] op_sel_hi:[1,1]
    v_pk_mul_f32 v[120:121], v[120:121], v[50:51] op_sel:[0,1] op_sel_hi:[1,1]
    v_pk_mul_f32 v[122:123], v[122:123], v[50:51] op_sel:[0,1] op_sel_hi:[1,1]
    v_cvt_pk_bf16_f32 v60, v104, v105
    v_cvt_pk_bf16_f32 v62, v120, v121
    v_cvt_pk_bf16_f32 v61, v106, v107
    v_cvt_pk_bf16_f32 v63, v122, v123
    s_nop 0
    v_permlane16_swap_b32 v60, v62
    v_permlane16_swap_b32 v61, v63
    buffer_store_dwordx4 v[60:63], v8, s[12:15], s28 offen offset:0 sc0 sc1
    v_pk_fma_f32 v[136:137], v[40:41], v[52:53], v[136:137] op_sel_hi:[1,0,1]
    v_pk_fma_f32 v[138:139], v[42:43], v[52:53], v[138:139] op_sel_hi:[1,0,1]
    v_pk_fma_f32 v[152:153], v[40:41], v[54:55], v[152:153] op_sel_hi:[1,0,1]
    v_pk_fma_f32 v[154:155], v[42:43], v[54:55], v[154:155] op_sel_hi:[1,0,1]
    v_pk_mul_f32 v[136:137], v[136:137], v[52:53] op_sel:[0,1] op_sel_hi:[1,1]
    v_pk_mul_f32 v[138:139], v[138:139], v[52:53] op_sel:[0,1] op_sel_hi:[1,1]
    v_pk_mul_f32 v[152:153], v[152:153], v[54:55] op_sel:[0,1] op_sel_hi:[1,1]
    v_pk_mul_f32 v[154:155], v[154:155], v[54:55] op_sel:[0,1] op_sel_hi:[1,1]
    v_cvt_pk_bf16_f32 v64, v136, v137
    v_cvt_pk_bf16_f32 v66, v152, v153
    v_cvt_pk_bf16_f32 v65, v138, v139
    v_cvt_pk_bf16_f32 v67, v154, v155
    s_nop 0
    v_permlane16_swap_b32 v64, v66
    v_permlane16_swap_b32 v65, v67
    buffer_store_dwordx4 v[64:67], v8, s[12:15], s28 offen offset:512 sc0 sc1
    s_add_u32 s28, s27, 196608
    s_waitcnt lgkmcnt(0)
    v_pk_fma_f32 v[108:109], v[44:45], v[48:49], v[108:109] op_sel_hi:[1,0,1]
    v_pk_fma_f32 v[110:111], v[46:47], v[48:49], v[110:111] op_sel_hi:[1,0,1]
    v_pk_fma_f32 v[124:125], v[44:45], v[50:51], v[124:125] op_sel_hi:[1,0,1]
    v_pk_fma_f32 v[126:127], v[46:47], v[50:51], v[126:127] op_sel_hi:[1,0,1]
    v_pk_mul_f32 v[108:109], v[108:109], v[48:49] op_sel:[0,1] op_sel_hi:[1,1]
    v_pk_mul_f32 v[110:111], v[110:111], v[48:49] op_sel:[0,1] op_sel_hi:[1,1]
    v_pk_mul_f32 v[124:125], v[124:125], v[50:51] op_sel:[0,1] op_sel_hi:[1,1]
    v_pk_mul_f32 v[126:127], v[126:127], v[50:51] op_sel:[0,1] op_sel_hi:[1,1]
    v_cvt_pk_bf16_f32 v56, v108, v109
    v_cvt_pk_bf16_f32 v58, v124, v125
    v_cvt_pk_bf16_f32 v57, v110, v111
    v_cvt_pk_bf16_f32 v59, v126, v127
    s_nop 0
    v_permlane16_swap_b32 v56, v58
    v_permlane16_swap_b32 v57, v59
    buffer_store_dwordx4 v[56:59], v8, s[12:15], s28 offen offset:0 sc0 sc1
    v_pk_fma_f32 v[140:141], v[44:45], v[52:53], v[140:141] op_sel_hi:[1,0,1]
    v_pk_fma_f32 v[142:143], v[46:47], v[52:53], v[142:143] op_sel_hi:[1,0,1]
    v_pk_fma_f32 v[156:157], v[44:45], v[54:55], v[156:157] op_sel_hi:[1,0,1]
    v_pk_fma_f32 v[158:159], v[46:47], v[54:55], v[158:159] op_sel_hi:[1,0,1]
    v_pk_mul_f32 v[140:141], v[140:141], v[52:53] op_sel:[0,1] op_sel_hi:[1,1]
    v_pk_mul_f32 v[142:143], v[142:143], v[52:53] op_sel:[0,1] op_sel_hi:[1,1]
    v_pk_mul_f32 v[156:157], v[156:157], v[54:55] op_sel:[0,1] op_sel_hi:[1,1]
    v_pk_mul_f32 v[158:159], v[158:159], v[54:55] op_sel:[0,1] op_sel_hi:[1,1]
    v_cvt_pk_bf16_f32 v60, v140, v141
    v_cvt_pk_bf16_f32 v62, v156, v157
    v_cvt_pk_bf16_f32 v61, v142, v143
    v_cvt_pk_bf16_f32 v63, v158, v159
    s_nop 0
    v_permlane16_swap_b32 v60, v62
    v_permlane16_swap_b32 v61, v63
    buffer_store_dwordx4 v[60:63], v8, s[12:15], s28 offen offset:512 sc0 sc1
    s_branch L_afront
L_a_cloopV:
    s_waitcnt lgkmcnt(4)
    v_mfma_f32_16x16x32_bf16 v[96:99], v[32:35], v[48:51], v[96:99]
    v_mfma_f32_16x16x32_bf16 v[112:115], v[36:39], v[48:51], v[112:115]
    ds_read_b128 v[64:67], v13 offset:0
    v_mfma_f32_16x16x32_bf16 v[100:103], v[32:35], v[52:55], v[100:103]
    ds_read_b64_tr_b16 v[80:81], v14 offset:8192
    v_mfma_f32_16x16x32_bf16 v[116:119], v[36:39], v[52:55], v[116:119]
    ds_read_b64_tr_b16 v[82:83], v14 offset:9216
    v_mfma_f32_16x16x32_bf16 v[128:131], v[40:43], v[48:51], v[128:131]
    ds_read_b128 v[68:71], v13 offset:2048
    v_mfma_f32_16x16x32_bf16 v[132:135], v[40:43], v[52:55], v[132:135]
    ds_read_b64_tr_b16 v[84:85], v15 offset:8192
    v_mfma_f32_16x16x32_bf16 v[144:147], v[44:47], v[48:51], v[144:147]
    ds_read_b64_tr_b16 v[86:87], v15 offset:9216
    v_mfma_f32_16x16x32_bf16 v[148:151], v[44:47], v[52:55], v[148:151]
    s_waitcnt lgkmcnt(6)
    v_mfma_f32_16x16x32_bf16 v[104:107], v[32:35], v[56:59], v[104:107]
    ds_read_b128 v[72:75], v13 offset:4096
    v_mfma_f32_16x16x32_bf16 v[120:123], v[36:39], v[56:59], v[120:123]
    ds_read_b128 v[76:79], v13 offset:6144
    v_mfma_f32_16x16x32_bf16 v[136:139], v[40:43], v[56:59], v[136:139]
    ds_read_b64_tr_b16 v[88:89], v16 offset:8192
    v_mfma_f32_16x16x32_bf16 v[152:155], v[44:47], v[56:59], v[152:155]
    ds_read_b64_tr_b16 v[90:91], v16 offset:9216
    v_mfma_f32_16x16x32_bf16 v[108:111], v[32:35], v[60:63], v[108:111]
    ds_read_b64_tr_b16 v[92:93], v17 offset:8192
    v_mfma_f32_16x16x32_bf16 v[124:127], v[36:39], v[60:63], v[124:127]
    ds_read_b64_tr_b16 v[94:95], v17 offset:9216
    v_mfma_f32_16x16x32_bf16 v[140:143], v[40:43], v[60:63], v[140:143]
    v_mfma_f32_16x16x32_bf16 v[156:159], v[44:47], v[60:63], v[156:159]
    s_waitcnt lgkmcnt(4)
    v_mfma_f32_16x16x32_bf16 v[96:99], v[64:67], v[80:83], v[96:99]
    s_barrier
    v_mfma_f32_16x16x32_bf16 v[112:115], v[68:71], v[80:83], v[112:115]
    ds_read_b128 v[32:35], v12 offset:32768
    v_mfma_f32_16x16x32_bf16 v[100:103], v[64:67], v[84:87], v[100:103]
    ds_read_b64_tr_b16 v[48:49], v14 offset:32768
    v_mfma_f32_16x16x32_bf16 v[116:119], v[68:71], v[84:87], v[116:119]
    ds_read_b64_tr_b16 v[50:51], v14 offset:33792
    v_mfma_f32_16x16x32_bf16 v[128:131], v[72:75], v[80:83], v[128:131]
    ds_read_b128 v[36:39], v12 offset:34816
    v_mfma_f32_16x16x32_bf16 v[132:135], v[72:75], v[84:87], v[132:135]
    ds_read_b64_tr_b16 v[52:53], v15 offset:32768
    v_mfma_f32_16x16x32_bf16 v[144:147], v[76:79], v[80:83], v[144:147]
    ds_read_b64_tr_b16 v[54:55], v15 offset:33792
    v_mfma_f32_16x16x32_bf16 v[148:151], v[76:79], v[84:87], v[148:151]
    s_waitcnt lgkmcnt(6)
    v_mfma_f32_16x16x32_bf16 v[104:107], v[64:67], v[88:91], v[104:107]
    ds_read_b128 v[40:43], v12 offset:36864
    v_mfma_f32_16x16x32_bf16 v[120:123], v[68:71], v[88:91], v[120:123]
    ds_read_b128 v[44:47], v12 offset:38912
    v_mfma_f32_16x16x32_bf16 v[136:139], v[72:75], v[88:91], v[136:139]
    ds_read_b64_tr_b16 v[56:57], v16 offset:32768
    v_mfma_f32_16x16x32_bf16 v[152:155], v[76:79], v[88:91], v[152:155]
    ds_read_b64_tr_b16 v[58:59], v16 offset:33792
    v_mfma_f32_16x16x32_bf16 v[108:111], v[64:67], v[92:95], v[108:111]
    ds_read_b64_tr_b16 v[60:61], v17 offset:32768
    v_mfma_f32_16x16x32_bf16 v[124:127], v[68:71], v[92:95], v[124:127]
    ds_read_b64_tr_b16 v[62:63], v17 offset:33792
    v_mfma_f32_16x16x32_bf16 v[140:143], v[72:75], v[92:95], v[140:143]
    v_mfma_f32_16x16x32_bf16 v[156:159], v[76:79], v[92:95], v[156:159]
    s_waitcnt lgkmcnt(4)
    v_mfma_f32_16x16x32_bf16 v[96:99], v[32:35], v[48:51], v[96:99]
    v_mfma_f32_16x16x32_bf16 v[112:115], v[36:39], v[48:51], v[112:115]
    ds_read_b128 v[64:67], v13 offset:32768
    v_mfma_f32_16x16x32_bf16 v[100:103], v[32:35], v[52:55], v[100:103]
    ds_read_b64_tr_b16 v[80:81], v14 offset:40960
    v_mfma_f32_16x16x32_bf16 v[116:119], v[36:39], v[52:55], v[116:119]
    ds_read_b64_tr_b16 v[82:83], v14 offset:41984
    v_mfma_f32_16x16x32_bf16 v[128:131], v[40:43], v[48:51], v[128:131]
    ds_read_b128 v[68:71], v13 offset:34816
    v_mfma_f32_16x16x32_bf16 v[132:135], v[40:43], v[52:55], v[132:135]
    ds_read_b64_tr_b16 v[84:85], v15 offset:40960
    v_mfma_f32_16x16x32_bf16 v[144:147], v[44:47], v[48:51], v[144:147]
    ds_read_b64_tr_b16 v[86:87], v15 offset:41984
    v_mfma_f32_16x16x32_bf16 v[148:151], v[44:47], v[52:55], v[148:151]
    s_waitcnt lgkmcnt(6)
    v_mfma_f32_16x16x32_bf16 v[104:107], v[32:35], v[56:59], v[104:107]
    ds_read_b128 v[72:75], v13 offset:36864
    v_mfma_f32_16x16x32_bf16 v[120:123], v[36:39], v[56:59], v[120:123]
    ds_read_b128 v[76:79], v13 offset:38912
    v_mfma_f32_16x16x32_bf16 v[136:139], v[40:43], v[56:59], v[136:139]
    ds_read_b64_tr_b16 v[88:89], v16 offset:40960
    v_mfma_f32_16x16x32_bf16 v[152:155], v[44:47], v[56:59], v[152:155]
    ds_read_b64_tr_b16 v[90:91], v16 offset:41984
    v_mfma_f32_16x16x32_bf16 v[108:111], v[32:35], v[60:63], v[108:111]
    ds_read_b64_tr_b16 v[92:93], v17 offset:40960
    v_mfma_f32_16x16x32_bf16 v[124:127], v[36:39], v[60:63], v[124:127]
    ds_read_b64_tr_b16 v[94:95], v17 offset:41984
    v_mfma_f32_16x16x32_bf16 v[140:143], v[40:43], v[60:63], v[140:143]
    v_mfma_f32_16x16x32_bf16 v[156:159], v[44:47], v[60:63], v[156:159]
    s_waitcnt lgkmcnt(4)
    v_mfma_f32_16x16x32_bf16 v[96:99], v[64:67], v[80:83], v[96:99]
    s_barrier
    v_mfma_f32_16x16x32_bf16 v[112:115], v[68:71], v[80:83], v[112:115]
    ds_read_b128 v[32:35], v18 offset:0
    v_mfma_f32_16x16x32_bf16 v[100:103], v[64:67], v[84:87], v[100:103]
    ds_read_b64_tr_b16 v[48:49], v20 offset:0
    v_mfma_f32_16x16x32_bf16 v[116:119], v[68:71], v[84:87], v[116:119]
    ds_read_b64_tr_b16 v[50:51], v20 offset:1024
    v_mfma_f32_16x16x32_bf16 v[128:131], v[72:75], v[80:83], v[128:131]
    ds_read_b128 v[36:39], v18 offset:2048
    v_mfma_f32_16x16x32_bf16 v[132:135], v[72:75], v[84:87], v[132:135]
    ds_read_b64_tr_b16 v[52:53], v21 offset:0
    v_mfma_f32_16x16x32_bf16 v[144:147], v[76:79], v[80:83], v[144:147]
    ds_read_b64_tr_b16 v[54:55], v21 offset:1024
    v_mfma_f32_16x16x32_bf16 v[148:151], v[76:79], v[84:87], v[148:151]
    s_waitcnt lgkmcnt(6)
    v_mfma_f32_16x16x32_bf16 v[104:107], v[64:67], v[88:91], v[104:107]
    ds_read_b128 v[40:43], v18 offset:4096
    v_mfma_f32_16x16x32_bf16 v[120:123], v[68:71], v[88:91], v[120:123]
    ds_read_b128 v[44:47], v18 offset:6144
    v_mfma_f32_16x16x32_bf16 v[136:139], v[72:75], v[88:91], v[136:139]
    ds_read_b64_tr_b16 v[56:57], v22 offset:0
    v_mfma_f32_16x16x32_bf16 v[152:155], v[76:79], v[88:91], v[152:155]
    ds_read_b64_tr_b16 v[58:59], v22 offset:1024
    v_mfma_f32_16x16x32_bf16 v[108:111], v[64:67], v[92:95], v[108:111]
    ds_read_b64_tr_b16 v[60:61], v23 offset:0
    v_mfma_f32_16x16x32_bf16 v[124:127], v[68:71], v[92:95], v[124:127]
    ds_read_b64_tr_b16 v[62:63], v23 offset:1024
    v_mfma_f32_16x16x32_bf16 v[140:143], v[72:75], v[92:95], v[140:143]
    v_mfma_f32_16x16x32_bf16 v[156:159], v[76:79], v[92:95], v[156:159]
    s_waitcnt lgkmcnt(4)
    v_mfma_f32_16x16x32_bf16 v[96:99], v[32:35], v[48:51], v[96:99]
    v_mfma_f32_16x16x32_bf16 v[112:115], v[36:39], v[48:51], v[112:115]
    ds_read_b128 v[64:67], v19 offset:0
    v_mfma_f32_16x16x32_bf16 v[100:103], v[32:35], v[52:55], v[100:103]
    ds_read_b64_tr_b16 v[80:81], v20 offset:8192
    v_mfma_f32_16x16x32_bf16 v[116:119], v[36:39], v[52:55], v[116:119]
    ds_read_b64_tr_b16 v[82:83], v20 offset:9216
    v_mfma_f32_16x16x32_bf16 v[128:131], v[40:43], v[48:51], v[128:131]
    ds_read_b128 v[68:71], v19 offset:2048
    v_mfma_f32_16x16x32_bf16 v[132:135], v[40:43], v[52:55], v[132:135]
    ds_read_b64_tr_b16 v[84:85], v21 offset:8192
    v_mfma_f32_16x16x32_bf16 v[144:147], v[44:47], v[48:51], v[144:147]
    ds_read_b64_tr_b16 v[86:87], v21 offset:9216
    v_mfma_f32_16x16x32_bf16 v[148:151], v[44:47], v[52:55], v[148:151]
    s_waitcnt lgkmcnt(6)
    v_mfma_f32_16x16x32_bf16 v[104:107], v[32:35], v[56:59], v[104:107]
    ds_read_b128 v[72:75], v19 offset:4096
    v_mfma_f32_16x16x32_bf16 v[120:123], v[36:39], v[56:59], v[120:123]
    ds_read_b128 v[76:79], v19 offset:6144
    v_mfma_f32_16x16x32_bf16 v[136:139], v[40:43], v[56:59], v[136:139]
    ds_read_b64_tr_b16 v[88:89], v22 offset:8192
    v_mfma_f32_16x16x32_bf16 v[152:155], v[44:47], v[56:59], v[152:155]
    ds_read_b64_tr_b16 v[90:91], v22 offset:9216
    v_mfma_f32_16x16x32_bf16 v[108:111], v[32:35], v[60:63], v[108:111]
    ds_read_b64_tr_b16 v[92:93], v23 offset:8192
    v_mfma_f32_16x16x32_bf16 v[124:127], v[36:39], v[60:63], v[124:127]
    ds_read_b64_tr_b16 v[94:95], v23 offset:9216
    v_mfma_f32_16x16x32_bf16 v[140:143], v[40:43], v[60:63], v[140:143]
    v_mfma_f32_16x16x32_bf16 v[156:159], v[44:47], v[60:63], v[156:159]
    s_waitcnt lgkmcnt(4)
    v_mfma_f32_16x16x32_bf16 v[96:99], v[64:67], v[80:83], v[96:99]
    s_barrier
    v_mfma_f32_16x16x32_bf16 v[112:115], v[68:71], v[80:83], v[112:115]
    ds_read_b128 v[32:35], v18 offset:32768
    v_mfma_f32_16x16x32_bf16 v[100:103], v[64:67], v[84:87], v[100:103]
    ds_read_b64_tr_b16 v[48:49], v20 offset:32768
    v_mfma_f32_16x16x32_bf16 v[116:119], v[68:71], v[84:87], v[116:119]
    ds_read_b64_tr_b16 v[50:51], v20 offset:33792
    v_mfma_f32_16x16x32_bf16 v[128:131], v[72:75], v[80:83], v[128:131]
    ds_read_b128 v[36:39], v18 offset:34816
    v_mfma_f32_16x16x32_bf16 v[132:135], v[72:75], v[84:87], v[132:135]
    ds_read_b64_tr_b16 v[52:53], v21 offset:32768
    v_mfma_f32_16x16x32_bf16 v[144:147], v[76:79], v[80:83], v[144:147]
    ds_read_b64_tr_b16 v[54:55], v21 offset:33792
    v_mfma_f32_16x16x32_bf16 v[148:151], v[76:79], v[84:87], v[148:151]
    s_waitcnt lgkmcnt(6)
    v_mfma_f32_16x16x32_bf16 v[104:107], v[64:67], v[88:91], v[104:107]
    ds_read_b128 v[40:43], v18 offset:36864
    v_mfma_f32_16x16x32_bf16 v[120:123], v[68:71], v[88:91], v[120:123]
    ds_read_b128 v[44:47], v18 offset:38912
    v_mfma_f32_16x16x32_bf16 v[136:139], v[72:75], v[88:91], v[136:139]
    ds_read_b64_tr_b16 v[56:57], v22 offset:32768
    v_mfma_f32_16x16x32_bf16 v[152:155], v[76:79], v[88:91], v[152:155]
    ds_read_b64_tr_b16 v[58:59], v22 offset:33792
    v_mfma_f32_16x16x32_bf16 v[108:111], v[64:67], v[92:95], v[108:111]
    ds_read_b64_tr_b16 v[60:61], v23 offset:32768
    v_mfma_f32_16x16x32_bf16 v[124:127], v[68:71], v[92:95], v[124:127]
    ds_read_b64_tr_b16 v[62:63], v23 offset:33792
    v_mfma_f32_16x16x32_bf16 v[140:143], v[72:75], v[92:95], v[140:143]
    v_mfma_f32_16x16x32_bf16 v[156:159], v[76:79], v[92:95], v[156:159]
    s_waitcnt lgkmcnt(4)
    v_mfma_f32_16x16x32_bf16 v[96:99], v[32:35], v[48:51], v[96:99]
    v_mfma_f32_16x16x32_bf16 v[112:115], v[36:39], v[48:51], v[112:115]
    ds_read_b128 v[64:67], v19 offset:32768
    v_mfma_f32_16x16x32_bf16 v[100:103], v[32:35], v[52:55], v[100:103]
    ds_read_b64_tr_b16 v[80:81], v20 offset:40960
    v_mfma_f32_16x16x32_bf16 v[116:119], v[36:39], v[52:55], v[116:119]
    ds_read_b64_tr_b16 v[82:83], v20 offset:41984
    v_mfma_f32_16x16x32_bf16 v[128:131], v[40:43], v[48:51], v[128:131]
    ds_read_b128 v[68:71], v19 offset:34816
    v_mfma_f32_16x16x32_bf16 v[132:135], v[40:43], v[52:55], v[132:135]
    ds_read_b64_tr_b16 v[84:85], v21 offset:40960
    v_mfma_f32_16x16x32_bf16 v[144:147], v[44:47], v[48:51], v[144:147]
    ds_read_b64_tr_b16 v[86:87], v21 offset:41984
    v_mfma_f32_16x16x32_bf16 v[148:151], v[44:47], v[52:55], v[148:151]
    s_waitcnt lgkmcnt(6)
    v_mfma_f32_16x16x32_bf16 v[104:107], v[32:35], v[56:59], v[104:107]
    ds_read_b128 v[72:75], v19 offset:36864
    v_mfma_f32_16x16x32_bf16 v[120:123], v[36:39], v[56:59], v[120:123]
    ds_read_b128 v[76:79], v19 offset:38912
    v_mfma_f32_16x16x32_bf16 v[136:139], v[40:43], v[56:59], v[136:139]
    ds_read_b64_tr_b16 v[88:89], v22 offset:40960
    v_mfma_f32_16x16x32_bf16 v[152:155], v[44:47], v[56:59], v[152:155]
    ds_read_b64_tr_b16 v[90:91], v22 offset:41984
    v_mfma_f32_16x16x32_bf16 v[108:111], v[32:35], v[60:63], v[108:111]
    ds_read_b64_tr_b16 v[92:93], v23 offset:40960
    v_mfma_f32_16x16x32_bf16 v[124:127], v[36:39], v[60:63], v[124:127]
    ds_read_b64_tr_b16 v[94:95], v23 offset:41984
    v_mfma_f32_16x16x32_bf16 v[140:143], v[40:43], v[60:63], v[140:143]
    v_mfma_f32_16x16x32_bf16 v[156:159], v[44:47], v[60:63], v[156:159]
    s_waitcnt lgkmcnt(4)
    v_mfma_f32_16x16x32_bf16 v[96:99], v[64:67], v[80:83], v[96:99]
    s_barrier
    v_mfma_f32_16x16x32_bf16 v[112:115], v[68:71], v[80:83], v[112:115]
    ds_read_b128 v[32:35], v24 offset:0
    v_mfma_f32_16x16x32_bf16 v[100:103], v[64:67], v[84:87], v[100:103]
    ds_read_b64_tr_b16 v[48:49], v26 offset:0
    v_mfma_f32_16x16x32_bf16 v[116:119], v[68:71], v[84:87], v[116:119]
    ds_read_b64_tr_b16 v[50:51], v26 offset:1024
    v_mfma_f32_16x16x32_bf16 v[128:131], v[72:75], v[80:83], v[128:131]
    ds_read_b128 v[36:39], v24 offset:2048
    v_mfma_f32_16x16x32_bf16 v[132:135], v[72:75], v[84:87], v[132:135]
    ds_read_b64_tr_b16 v[52:53], v27 offset:0
    v_mfma_f32_16x16x32_bf16 v[144:147], v[76:79], v[80:83], v[144:147]
    ds_read_b64_tr_b16 v[54:55], v27 offset:1024
    v_mfma_f32_16x16x32_bf16 v[148:151], v[76:79], v[84:87], v[148:151]
    s_waitcnt lgkmcnt(6)
    v_mfma_f32_16x16x32_bf16 v[104:107], v[64:67], v[88:91], v[104:107]
    ds_read_b128 v[40:43], v24 offset:4096
    v_mfma_f32_16x16x32_bf16 v[120:123], v[68:71], v[88:91], v[120:123]
    ds_read_b128 v[44:47], v24 offset:6144
    v_mfma_f32_16x16x32_bf16 v[136:139], v[72:75], v[88:91], v[136:139]
    ds_read_b64_tr_b16 v[56:57], v28 offset:0
    v_mfma_f32_16x16x32_bf16 v[152:155], v[76:79], v[88:91], v[152:155]
    ds_read_b64_tr_b16 v[58:59], v28 offset:1024
    v_mfma_f32_16x16x32_bf16 v[108:111], v[64:67], v[92:95], v[108:111]
    ds_read_b64_tr_b16 v[60:61], v29 offset:0
    v_mfma_f32_16x16x32_bf16 v[124:127], v[68:71], v[92:95], v[124:127]
    ds_read_b64_tr_b16 v[62:63], v29 offset:1024
    v_mfma_f32_16x16x32_bf16 v[140:143], v[72:75], v[92:95], v[140:143]
    v_mfma_f32_16x16x32_bf16 v[156:159], v[76:79], v[92:95], v[156:159]
    s_waitcnt lgkmcnt(4)
    v_mfma_f32_16x16x32_bf16 v[96:99], v[32:35], v[48:51], v[96:99]
    v_mfma_f32_16x16x32_bf16 v[112:115], v[36:39], v[48:51], v[112:115]
    ds_read_b128 v[64:67], v25 offset:0
    v_mfma_f32_16x16x32_bf16 v[100:103], v[32:35], v[52:55], v[100:103]
    ds_read_b64_tr_b16 v[80:81], v26 offset:8192
    v_mfma_f32_16x16x32_bf16 v[116:119], v[36:39], v[52:55], v[116:119]
    ds_read_b64_tr_b16 v[82:83], v26 offset:9216
    v_mfma_f32_16x16x32_bf16 v[128:131], v[40:43], v[48:51], v[128:131]
    ds_read_b128 v[68:71], v25 offset:2048
    v_mfma_f32_16x16x32_bf16 v[132:135], v[40:43], v[52:55], v[132:135]
    ds_read_b64_tr_b16 v[84:85], v27 offset:8192
    v_mfma_f32_16x16x32_bf16 v[144:147], v[44:47], v[48:51], v[144:147]
    ds_read_b64_tr_b16 v[86:87], v27 offset:9216
    v_mfma_f32_16x16x32_bf16 v[148:151], v[44:47], v[52:55], v[148:151]
    s_waitcnt lgkmcnt(6)
    v_mfma_f32_16x16x32_bf16 v[104:107], v[32:35], v[56:59], v[104:107]
    ds_read_b128 v[72:75], v25 offset:4096
    v_mfma_f32_16x16x32_bf16 v[120:123], v[36:39], v[56:59], v[120:123]
    ds_read_b128 v[76:79], v25 offset:6144
    v_mfma_f32_16x16x32_bf16 v[136:139], v[40:43], v[56:59], v[136:139]
    ds_read_b64_tr_b16 v[88:89], v28 offset:8192
    v_mfma_f32_16x16x32_bf16 v[152:155], v[44:47], v[56:59], v[152:155]
    ds_read_b64_tr_b16 v[90:91], v28 offset:9216
    v_mfma_f32_16x16x32_bf16 v[108:111], v[32:35], v[60:63], v[108:111]
    ds_read_b64_tr_b16 v[92:93], v29 offset:8192
    v_mfma_f32_16x16x32_bf16 v[124:127], v[36:39], v[60:63], v[124:127]
    ds_read_b64_tr_b16 v[94:95], v29 offset:9216
    v_mfma_f32_16x16x32_bf16 v[140:143], v[40:43], v[60:63], v[140:143]
    s_add_u32 s33, s33, 1
    s_cmp_lt_u32 s33, 2
    v_mfma_f32_16x16x32_bf16 v[156:159], v[44:47], v[60:63], v[156:159]
    s_waitcnt lgkmcnt(4)
    v_mfma_f32_16x16x32_bf16 v[96:99], v[64:67], v[80:83], v[96:99]
    s_cbranch_scc0 L_a_nb1
    s_barrier
L_a_nb1:
    v_mfma_f32_16x16x32_bf16 v[112:115], v[68:71], v[80:83], v[112:115]
    ds_read_b128 v[32:35], v12 offset:0
    v_mfma_f32_16x16x32_bf16 v[100:103], v[64:67], v[84:87], v[100:103]
    ds_read_b64_tr_b16 v[48:49], v14 offset:0
    v_mfma_f32_16x16x32_bf16 v[116:119], v[68:71], v[84:87], v[116:119]
    ds_read_b64_tr_b16 v[50:51], v14 offset:1024
    v_mfma_f32_16x16x32_bf16 v[128:131], v[72:75], v[80:83], v[128:131]
    ds_read_b128 v[36:39], v12 offset:2048
    v_mfma_f32_16x16x32_bf16 v[132:135], v[72:75], v[84:87], v[132:135]
    ds_read_b64_tr_b16 v[52:53], v15 offset:0
    v_mfma_f32_16x16x32_bf16 v[144:147], v[76:79], v[80:83], v[144:147]
    ds_read_b64_tr_b16 v[54:55], v15 offset:1024
    v_mfma_f32_16x16x32_bf16 v[148:151], v[76:79], v[84:87], v[148:151]
    s_waitcnt lgkmcnt(6)
    v_mfma_f32_16x16x32_bf16 v[104:107], v[64:67], v[88:91], v[104:107]
    ds_read_b128 v[40:43], v12 offset:4096
    v_mfma_f32_16x16x32_bf16 v[120:123], v[68:71], v[88:91], v[120:123]
    ds_read_b128 v[44:47], v12 offset:6144
    v_mfma_f32_16x16x32_bf16 v[136:139], v[72:75], v[88:91], v[136:139]
    ds_read_b64_tr_b16 v[56:57], v16 offset:0
    v_mfma_f32_16x16x32_bf16 v[152:155], v[76:79], v[88:91], v[152:155]
    ds_read_b64_tr_b16 v[58:59], v16 offset:1024
    v_mfma_f32_16x16x32_bf16 v[108:111], v[64:67], v[92:95], v[108:111]
    ds_read_b64_tr_b16 v[60:61], v17 offset:0
    v_mfma_f32_16x16x32_bf16 v[124:127], v[68:71], v[92:95], v[124:127]
    ds_read_b64_tr_b16 v[62:63], v17 offset:1024
    v_mfma_f32_16x16x32_bf16 v[140:143], v[72:75], v[92:95], v[140:143]
    v_mfma_f32_16x16x32_bf16 v[156:159], v[76:79], v[92:95], v[156:159]
    s_cbranch_scc1 L_a_cloopV
    s_waitcnt lgkmcnt(0)
    s_barrier
    s_lshl_b32 s27, s25, 8
    s_add_u32 s27, s27, 32768
    v_lshl_add_u32 v4, v7, 4, s27
    s_lshl_b32 s27, s26, 8
    s_add_u32 s27, s27, 33792
    v_lshl_add_u32 v5, v6, 2, s27
    ds_read_b32 v64, v5 offset:0
    ds_read_b32 v66, v5 offset:64
    ds_read_b32 v68, v5 offset:128
    ds_read_b32 v70, v5 offset:192
    ds_read_b128 v[32:35], v4 offset:0
    ds_read_b128 v[36:39], v4 offset:512
    ds_read_b128 v[40:43], v4 offset:64
    ds_read_b128 v[44:47], v4 offset:576
    ds_read_b128 v[48:51], v4 offset:128
    ds_read_b128 v[52:55], v4 offset:640
    ds_read_b128 v[56:59], v4 offset:192
    ds_read_b128 v[60:63], v4 offset:704
    s_lshl_b32 s27, s26, 6
    s_add_u32 s27, s27, s17
    s_sub_u32 s27, s27, 1280
    v_add_u32 v8, s27, v10
    v_mul_u32_u24 v9, 320, v11
    v_add_u32 v9, 5242880, v9
    s_mov_b32 s28, 81920
    v_mul_u32_u24 v12, 3277, v8
    v_lshrrev_b32 v12, 16, v12
    v_mul_u32_u24 v13, 20, v12
    v_sub_u32 v13, v8, v13
    v_lshl_add_u32 v13, v13, 4, v9
    v_mad_u32_u24 v18, v12, s28, v13
    v_add_u32 v8, 32, v8
    v_mul_u32_u24 v12, 3277, v8
    v_lshrrev_b32 v12, 16, v12
    v_mul_u32_u24 v13, 20, v12
    v_sub_u32 v13, v8, v13
    v_lshl_add_u32 v13, v13, 4, v9
    v_mad_u32_u24 v19, v12, s28, v13
    s_lshr_b32 s27, s16, 5
    s_lshl_b32 s28, s25, 1
    s_add_u32 s27, s27, s28
    s_mul_i32 s27, s27, 1280
    s_waitcnt lgkmcnt(6)
    v_pk_fma_f32 v[96:97], v[36:37], v[64:65], v[96:97] op_sel_hi:[1,0,1]
    v_pk_fma_f32 v[98:99], v[38:39], v[64:65], v[98:99] op_sel_hi:[1,0,1]
    v_pk_fma_f32 v[100:101], v[36:37], v[66:67], v[100:101] op_sel_hi:[1,0,1]
    v_pk_fma_f32 v[102:103], v[38:39], v[66:67], v[102:103] op_sel_hi:[1,0,1]
    v_pk_mul_f32 v[96:97], v[96:97], v[32:33]
    v_pk_mul_f32 v[98:99], v[98:99], v[34:35]
    v_pk_mul_f32 v[100:101], v[100:101], v[32:33]
    v_pk_mul_f32 v[102:103], v[102:103], v[34:35]
    v_cvt_pk_bf16_f32 v72, v96, v97
    v_cvt_pk_bf16_f32 v74, v100, v101
    v_cvt_pk_bf16_f32 v73, v98, v99
    v_cvt_pk_bf16_f32 v75, v102, v103
    s_nop 0
    v_permlane16_swap_b32 v72, v74
    v_permlane16_swap_b32 v73, v75
    buffer_store_dwordx4 v[72:75], v18, s[12:15], s27 offen offset:0 sc0 sc1
    v_pk_fma_f32 v[104:105], v[36:37], v[68:69], v[104:105] op_sel_hi:[1,0,1]
    v_pk_fma_f32 v[106:107], v[38:39], v[68:69], v[106:107] op_sel_hi:[1,0,1]
    v_pk_fma_f32 v[108:109], v[36:37], v[70:71], v[108:109] op_sel_hi:[1,0,1]
    v_pk_fma_f32 v[110:111], v[38:39], v[70:71], v[110:111] op_sel_hi:[1,0,1]
    v_pk_mul_f32 v[104:105], v[104:105], v[32:33]
    v_pk_mul_f32 v[106:107], v[106:107], v[34:35]
    v_pk_mul_f32 v[108:109], v[108:109], v[32:33]
    v_pk_mul_f32 v[110:111], v[110:111], v[34:35]
    v_cvt_pk_bf16_f32 v76, v104, v105
    v_cvt_pk_bf16_f32 v78, v108, v109
    v_cvt_pk_bf16_f32 v77, v106, v107
    v_cvt_pk_bf16_f32 v79, v110, v111
    s_nop 0
    v_permlane16_swap_b32 v76, v78
    v_permlane16_swap_b32 v77, v79
    buffer_store_dwordx4 v[76:79], v19, s[12:15], s27 offen offset:0 sc0 sc1
    s_waitcnt lgkmcnt(4)
    v_pk_fma_f32 v[112:113], v[44:45], v[64:65], v[112:113] op_sel_hi:[1,0,1]
    v_pk_fma_f32 v[114:115], v[46:47], v[64:65], v[114:115] op_sel_hi:[1,0,1]
    v_pk_fma_f32 v[116:117], v[44:45], v[66:67], v[116:117] op_sel_hi:[1,0,1]
    v_pk_fma_f32 v[118:119], v[46:47], v[66:67], v[118:119] op_sel_hi:[1,0,1]
    v_pk_mul_f32 v[112:113], v[112:113], v[40:41]
    v_pk_mul_f32 v[114:115], v[114:115], v[42:43]
    v_pk_mul_f32 v[116:117], v[116:117], v[40:41]
    v_pk_mul_f32 v[118:119], v[118:119], v[42:43]
    v_cvt_pk_bf16_f32 v80, v112, v113
    v_cvt_pk_bf16_f32 v82, v116, v117
    v_cvt_pk_bf16_f32 v81, v114, v115
    v_cvt_pk_bf16_f32 v83, v118, v119
    s_nop 0
    v_permlane16_swap_b32 v80, v82
    v_permlane16_swap_b32 v81, v83
    buffer_store_dwordx4 v[80:83], v18, s[12:15], s27 offen offset:640 sc0 sc1
    v_pk_fma_f32 v[120:121], v[44:45], v[68:69], v[120:121] op_sel_hi:[1,0,1]
    v_pk_fma_f32 v[122:123], v[46:47], v[68:69], v[122:123] op_sel_hi:[1,0,1]
    v_pk_fma_f32 v[124:125], v[44:45], v[70:71], v[124:125] op_sel_hi:[1,0,1]
    v_pk_fma_f32 v[126:127], v[46:47], v[70:71], v[126:127] op_sel_hi:[1,0,1]
    v_pk_mul_f32 v[120:121], v[120:121], v[40:41]
    v_pk_mul_f32 v[122:123], v[122:123], v[42:43]
    v_pk_mul_f32 v[124:125], v[124:125], v[40:41]
    v_pk_mul_f32 v[126:127], v[126:127], v[42:43]
    v_cvt_pk_bf16_f32 v72, v120, v121
    v_cvt_pk_bf16_f32 v74, v124, v125
    v_cvt_pk_bf16_f32 v73, v122, v123
    v_cvt_pk_bf16_f32 v75, v126, v127
    s_nop 0
    v_permlane16_swap_b32 v72, v74
    v_permlane16_swap_b32 v73, v75
    buffer_store_dwordx4 v[72:75], v19, s[12:15], s27 offen offset:640 sc0 sc1
    s_waitcnt lgkmcnt(2)
    v_pk_fma_f32 v[128:129], v[52:53], v[64:65], v[128:129] op_sel_hi:[1,0,1]
    v_pk_fma_f32 v[130:131], v[54:55], v[64:65], v[130:131] op_sel_hi:[1,0,1]
    v_pk_fma_f32 v[132:133], v[52:53], v[66:67], v[132:133] op_sel_hi:[1,0,1]
    v_pk_fma_f32 v[134:135], v[54:55], v[66:67], v[134:135] op_sel_hi:[1,0,1]
    v_pk_mul_f32 v[128:129], v[128:129], v[48:49]
    v_pk_mul_f32 v[130:131], v[130:131], v[50:51]
    v_pk_mul_f32 v[132:133], v[132:133], v[48:49]
    v_pk_mul_f32 v[134:135], v[134:135], v[50:51]
    v_cvt_pk_bf16_f32 v76, v128, v129
    v_cvt_pk_bf16_f32 v78, v132, v133
    v_cvt_pk_bf16_f32 v77, v130, v131
    v_cvt_pk_bf16_f32 v79, v134, v135
    s_nop 0
    v_permlane16_swap_b32 v76, v78
    v_permlane16_swap_b32 v77, v79
    buffer_store_dwordx4 v[76:79], v18, s[12:15], s27 offen offset:1280 sc0 sc1
    v_pk_fma_f32 v[136:137], v[52:53], v[68:69], v[136:137] op_sel_hi:[1,0,1]
    v_pk_fma_f32 v[138:139], v[54:55], v[68:69], v[138:139] op_sel_hi:[1,0,1]
    v_pk_fma_f32 v[140:141], v[52:53], v[70:71], v[140:141] op_sel_hi:[1,0,1]
    v_pk_fma_f32 v[142:143], v[54:55], v[70:71], v[142:143] op_sel_hi:[1,0,1]
    v_pk_mul_f32 v[136:137], v[136:137], v[48:49]
    v_pk_mul_f32 v[138:139], v[138:139], v[50:51]
    v_pk_mul_f32 v[140:141], v[140:141], v[48:49]
    v_pk_mul_f32 v[142:143], v[142:143], v[50:51]
    v_cvt_pk_bf16_f32 v80, v136, v137
    v_cvt_pk_bf16_f32 v82, v140, v141
    v_cvt_pk_bf16_f32 v81, v138, v139
    v_cvt_pk_bf16_f32 v83, v142, v143
    s_nop 0
    v_permlane16_swap_b32 v80, v82
    v_permlane16_swap_b32 v81, v83
    buffer_store_dwordx4 v[80:83], v19, s[12:15], s27 offen offset:1280 sc0 sc1
    s_waitcnt lgkmcnt(0)
    v_pk_fma_f32 v[144:145], v[60:61], v[64:65], v[144:145] op_sel_hi:[1,0,1]
    v_pk_fma_f32 v[146:147], v[62:63], v[64:65], v[146:147] op_sel_hi:[1,0,1]
    v_pk_fma_f32 v[148:149], v[60:61], v[66:67], v[148:149] op_sel_hi:[1,0,1]
    v_pk_fma_f32 v[150:151], v[62:63], v[66:67], v[150:151] op_sel_hi:[1,0,1]
    v_pk_mul_f32 v[144:145], v[144:145], v[56:57]
    v_pk_mul_f32 v[146:147], v[146:147], v[58:59]
    v_pk_mul_f32 v[148:149], v[148:149], v[56:57]
    v_pk_mul_f32 v[150:151], v[150:151], v[58:59]
    v_cvt_pk_bf16_f32 v72, v144, v145
    v_cvt_pk_bf16_f32 v74, v148, v149
    v_cvt_pk_bf16_f32 v73, v146, v147
    v_cvt_pk_bf16_f32 v75, v150, v151
    s_nop 0
    v_permlane16_swap_b32 v72, v74
    v_permlane16_swap_b32 v73, v75
    buffer_store_dwordx4 v[72:75], v18, s[12:15], s27 offen offset:1920 sc0 sc1
    v_pk_fma_f32 v[152:153], v[60:61], v[68:69], v[152:153] op_sel_hi:[1,0,1]
    v_pk_fma_f32 v[154:155], v[62:63], v[68:69], v[154:155] op_sel_hi:[1,0,1]
    v_pk_fma_f32 v[156:157], v[60:61], v[70:71], v[156:157] op_sel_hi:[1,0,1]
    v_pk_fma_f32 v[158:159], v[62:63], v[70:71], v[158:159] op_sel_hi:[1,0,1]
    v_pk_mul_f32 v[152:153], v[152:153], v[56:57]
    v_pk_mul_f32 v[154:155], v[154:155], v[58:59]
    v_pk_mul_f32 v[156:157], v[156:157], v[56:57]
    v_pk_mul_f32 v[158:159], v[158:159], v[58:59]
    v_cvt_pk_bf16_f32 v76, v152, v153
    v_cvt_pk_bf16_f32 v78, v156, v157
    v_cvt_pk_bf16_f32 v77, v154, v155
    v_cvt_pk_bf16_f32 v79, v158, v159
    s_nop 0
    v_permlane16_swap_b32 v76, v78
    v_permlane16_swap_b32 v77, v79
    buffer_store_dwordx4 v[76:79], v19, s[12:15], s27 offen offset:1920 sc0 sc1
    s_branch L_afront
L_adone:
    s_setprio 0
    s_load_dwordx2 s[60:61], s[0:1], 32
    s_load_dwordx2 s[64:65], s[0:1], 48
    s_load_dwordx2 s[68:69], s[0:1], 0
    s_load_dwordx2 s[8:9], s[0:1], 40
    s_load_dwordx2 s[34:35], s[0:1], 56
    s_lshl_b32 s58, s19, 4
    s_add_u32 s58, s58, s22
    s_lshl_b32 s58, s58, 7
    s_add_u32 s58, s58, 16875520
    s_mul_i32 s50, s18, 3072
    s_mov_b32 s4, s44
    s_mov_b32 s5, s45
    s_mov_b32 s6, 256
    s_mov_b32 s7, 0x00020000
    s_waitcnt lgkmcnt(0)
    s_mov_b32 s62, 6291456
    s_mov_b32 s63, 0x00020000
    s_mov_b32 s66, 6291456
    s_mov_b32 s67, 0x00020000
    s_mov_b32 s70, 2621440
    s_mov_b32 s71, 0x00020000
    v_bfe_u32 v236, v1, 3, 2
    v_bfe_u32 v237, v1, 5, 1
    v_mul_u32_u24 v237, 16, v237
    v_add_u32 v236, v236, v237
    v_mul_u32_u24 v190, 3072, v236
    v_bfe_u32 v236, v1, 4, 1
    v_lshlrev_b32 v236, 2, v236
    v_and_b32 v237, 7, v1
    v_xor_b32 v236, v236, v237
    v_lshl_add_u32 v190, v236, 4, v190
    v_bfe_u32 v236, v1, 3, 2
    v_bfe_u32 v237, v1, 5, 1
    v_mul_u32_u24 v237, 16, v237
    v_add_u32 v236, v236, v237
    v_mul_u32_u24 v191, 4096, v236
    v_bfe_u32 v236, v1, 4, 1
    v_lshlrev_b32 v236, 2, v236
    v_and_b32 v237, 7, v1
    v_xor_b32 v236, v236, v237
    v_lshl_add_u32 v191, v236, 4, v191
    v_bfe_u32 v236, v1, 2, 2
    v_lshlrev_b32 v192, 7, v236
    v_lshrrev_b32 v237, 4, v1
    v_lshlrev_b32 v237, 1, v237
    v_bfe_u32 v236, v1, 1, 1
    v_add_u32 v237, v237, v236
    v_bfe_u32 v236, v1, 3, 1
    v_lshlrev_b32 v236, 2, v236
    v_xor_b32 v237, v237, v236
    v_lshl_add_u32 v192, v237, 4, v192
    v_and_b32 v236, 1, v1
    v_lshl_add_u32 v192, v236, 3, v192
    s_add_u32 s75, s50, 104448
    s_lshl_b32 s54, s18, 12
    s_add_u32 s54, s54, 129024
    v_add_u32 v196, s75, v192
    v_add_u32 v192, s54, v192
    v_lshrrev_b32 v236, 4, v1
    v_and_b32 v237, 15, v1
    v_lshlrev_b32 v238, 4, v237
    v_lshl_add_u32 v193, v236, 16, v238
    v_mul_u32_u24 v254, 49152, v236
    v_add_u32 v254, v254, v238
    v_mul_u32_u24 v195, 1280, v237
    v_lshl_add_u32 v195, v236, 3, v195
    s_lshr_b32 s26, s2, 2
    s_and_b32 s27, s2, 3
    s_mul_i32 s72, s26, 98304
    s_mul_i32 s28, s27, 12288
    s_add_u32 s72, s72, s28
    s_mul_i32 s28, s18, 384
    s_add_u32 s72, s72, s28
    s_mul_i32 s78, s18, 786432
    s_lshl_b32 s28, s2, 8
    s_add_u32 s78, s78, s28
    s_add_u32 s78, s78, 16908288
    s_lshl_b32 s26, s2, 3
    s_add_u32 s26, s26, s18
    s_and_b32 s27, s26, 31
    s_lshr_b32 s26, s26, 5
    s_mul_i32 s26, s26, 3
    s_mul_i32 s77, s27, 196608
    s_lshl_b32 s28, s26, 8
    s_add_u32 s77, s77, s28
    s_add_u32 s77, s77, 23199744
    s_lshl_b32 s27, s27, 7
    s_lshr_b32 s28, s26, 2
    s_lshl_b32 s73, s28, 17
    s_and_b32 s28, s26, 3
    s_lshl_b32 s28, s28, 14
    s_add_u32 s73, s73, s28
    s_add_u32 s73, s73, s27
    s_add_u32 s26, s26, 1
    s_lshr_b32 s28, s26, 2
    s_lshl_b32 s74, s28, 17
    s_and_b32 s28, s26, 3
    s_lshl_b32 s28, s28, 14
    s_add_u32 s74, s74, s28
    s_add_u32 s74, s74, s27
    s_add_u32 s26, s26, 1
    s_lshr_b32 s28, s26, 2
    s_lshl_b32 s76, s28, 17
    s_and_b32 s28, s26, 3
    s_lshl_b32 s28, s28, 14
    s_add_u32 s76, s76, s28
    s_add_u32 s76, s76, s27
    s_add_u32 s26, s26, 1
    s_lshr_b32 s21, s2, 3
    s_and_b32 s26, s2, 7
    s_lshl_b32 s26, s26, 2
    s_lshr_b32 s22, s21, 3
    s_add_u32 s26, s26, s22
    s_and_b32 s27, s21, 7
    s_bfe_u32 s29, s2, 0x20001
    s_add_u32 s29, s29, 1
    s_and_b32 s29, s29, 3
    s_mul_i32 s79, s27, 204800
    s_mul_i32 s28, s29, 25600
    s_add_u32 s79, s79, s28
    s_add_u32 s79, s79, 29753344
    s_lshl_b32 s29, s29, 3
    v_add_u32 v245, s29, v1
    v_and_b32 v245, 31, v245
    v_lshlrev_b32 v245, 7, v245
    s_lshr_b32 s28, s26, 2
    s_lshl_b32 s28, s28, 12
    s_add_u32 s28, s28, 16842752
    v_add_u32 v245, s28, v245
    s_lshl_b32 s28, s18, 12
    s_add_u32 s53, s79, s28
    s_add_u32 s53, s53, 73728
    s_add_u32 s79, s79, s50
    s_mul_i32 s28, s27, 5
    s_add_u32 s28, s28, s18
    s_mul_i32 s28, s28, 65536
    s_lshl_b32 s29, s26, 11
    s_add_u32 s28, s28, s29
    s_add_u32 s28, s28, 10485760
    s_cmp_lt_u32 s18, 5
    s_cselect_b32 s80, s28, 2147483648
    s_lshl_b32 s28, s26, 2
    s_and_b32 s29, s18, 3
    s_add_u32 s28, s28, s29
    s_lshl_b32 s28, s28, 11
    s_lshl_b32 s29, s27, 8
    s_add_u32 s28, s28, s29
    s_add_u32 s28, s28, 15990784
    s_lshl_b32 s29, s2, 7
    s_mul_i32 s59, s18, 32768
    s_add_u32 s59, s59, s29
    s_add_u32 s59, s59, 16744448
    s_cmp_ge_u32 s18, 4
    s_cselect_b32 s59, s28, s59
    s_cmp_eq_u32 s18, 2
    s_cselect_b32 s59, 2147483648, s59
    s_lshl_b32 s28, s26, 2
    s_and_b32 s29, s18, 3
    s_add_u32 s28, s28, s29
    s_mul_i32 s28, s28, 20480
    s_mul_i32 s29, s27, 160
    s_add_u32 s28, s28, s29
    s_cmp_ge_u32 s18, 4
    s_cselect_b32 s82, s28, 2147483648
    s_mov_b32 s10, 3072
    s_mov_b32 s11, 0x00020000
    v_lshlrev_b32 v246, 6, v1
    s_cmp_eq_u32 s18, 6
    s_cselect_b32 s8, s34, s8
    s_cselect_b32 s9, s35, s9
    s_cselect_b32 s10, 4096, s10
    s_mul_i32 s26, s21, 43
    s_lshr_b32 s26, s26, 8
    s_mul_i32 s27, s26, 6
    s_sub_u32 s27, s21, s27
    s_and_b32 s22, s2, 1
    s_mul_i32 s22, s22, 5
    s_add_u32 s26, s26, s22
    s_bfe_u32 s22, s2, 0x20001
    s_mul_i32 s22, s22, 6
    s_add_u32 s27, s27, s22
    s_mov_b32 s48, 0
    s_lshl_b32 s28, s27, 1
    s_and_b32 s29, s18, 1
    s_add_u32 s28, s28, s29
    s_lshl_b32 s28, s28, 17
    s_and_b32 s29, s18, 2
    s_lshl_b32 s29, s29, 10
    s_add_u32 s28, s28, s29
    s_add_u32 s45, s28, 16908288
    s_cmp_lt_u32 s18, 4
    s_cselect_b32 s28, 28672, 0
    s_cselect_b32 s29, 0, 46080
    s_cselect_b32 s46, 1024, 0
    s_cselect_b32 s47, 0, 3072
    s_add_u32 s48, s48, s28
    s_add_u32 s48, s48, s29
    s_and_b32 s48, s48, 0xffff
    s_add_u32 s44, s45, s48
    s_add_u32 s46, s46, s47
    s_sub_u32 s47, 4096, s46
    s_lshl_b32 s26, s26, 2
    s_lshr_b32 s28, s18, 1
    s_add_u32 s26, s26, s28
    s_mul_i32 s26, s26, 48
    s_lshl_b32 s27, s27, 1
    s_add_u32 s26, s26, s27
    s_and_b32 s28, s18, 1
    s_add_u32 s26, s26, s28
    s_lshl_b32 s26, s26, 10
    s_add_u32 s26, s26, 13107200
    s_cmp_lt_u32 s21, 30
    s_cselect_b32 s81, s26, 2147483648
    s_lshl_b32 s26, s2, 2
    s_add_u32 s26, s26, 16809984
    s_cmp_eq_u32 s18, 0
    s_cselect_b32 s83, s26, 2147483648
    v_mov_b32 v248, -1
    v_mov_b32 v249, -1
    v_mov_b32 v250, -1
    v_mov_b32 v251, -1
    s_lshr_b32 s26, s2, 3
    s_lshl_b32 s26, s26, 3
    s_getpc_b64 s[36:37]
L_pc2:
    s_add_u32 s36, s36, L_merge-L_pc2
    s_addc_u32 s37, s37, 0
    v_add_u32 v252, s26, v1
    v_add_u32 v252, 0, v252
    v_lshlrev_b32 v252, 7, v252
    v_min_u32 v252, L_end-L_merge-4, v252
    v_mov_b32 v253, s37
    v_add_co_u32 v252, vcc, s36, v252
    s_nop 1
    v_addc_co_u32 v253, vcc, 0, v253, vcc
L_afront:
    s_setprio 0
    s_nop 0
    v_mov_b32 v60, 0
    buffer_load_dword v59, v60, s[4:7], 0 offen sc1
    s_and_b32 s20, s2, 7
    s_lshr_b32 s21, s2, 3
    s_lshl_b32 s16, s20, 2
    s_lshr_b32 s22, s21, 3
    s_add_u32 s16, s16, s22
    s_and_b32 s17, s21, 7
    s_lshl_b32 s17, s17, 8
    s_lshr_b32 s22, s16, 1
    s_and_b32 s23, s16, 1
    s_mul_i32 s24, s22, 5
    s_add_u32 s25, s24, 2
    s_mul_i32 s26, s23, 3
    s_add_u32 s24, s24, s26
    s_lshl_b32 s24, s24, 15
    s_lshl_b32 s25, s25, 15
    s_lshl_b32 s23, s23, 3
    s_and_b32 s19, s18, 3
    s_lshr_b32 s20, s18, 2
    v_and_b32 v6, 31, v1
    v_lshrrev_b32 v7, 5, v1
    v_lshlrev_b32 v5, 4, v1
    s_lshl_b32 s21, s20, 14
    s_add_u32 s21, s21, 2621440
    s_add_u32 s26, s24, s21
    s_add_u32 s27, s25, s21
    s_mul_i32 s28, s16, 81920
    s_mul_i32 s29, s20, 40960
    s_add_u32 s28, s28, s29
    s_add_u32 s28, s28, 5242880
    s_mov_b32 s40, s26
    s_mov_b32 s41, s26
    s_add_u32 s42, s26, 30720
    s_cmp_eq_u32 s19, 1
    s_cbranch_scc0 L_nj1
    s_add_u32 s40, s26, 33792
    s_sub_u32 s41, s27, 1024
    s_mov_b32 s42, s41
L_nj1:
    s_mov_b32 s49, 2048
    s_cmp_ge_u32 s19, 2
    s_cbranch_scc0 L_nj2
    s_sub_u32 s29, s19, 2
    s_mul_i32 s29, s29, 3072
    s_add_u32 s40, s28, s29
    s_mov_b32 s41, s40
    s_lshr_b32 s29, s29, 11
    s_lshl_b32 s29, s29, 10
    s_sub_u32 s42, s40, s29
    s_mov_b32 s49, 5120
L_nj2:
    v_add_u32 v54, s40, v5
    v_add_u32 v55, s41, v5
    v_add_u32 v56, s42, v5
    s_lshl_b32 s29, s19, 6
    s_add_u32 s17, s17, s29
    s_lshl_b32 s29, s17, 4
    s_add_u32 s30, s24, s29
    s_add_u32 s31, s25, s29
    v_lshlrev_b32 v35, 4, v6
    v_lshl_add_u32 v34, v7, 15, v35
    s_mul_i32 s29, s20, 12288
    v_lshl_add_u32 v2, v7, 11, v35
    v_add_u32 v2, s29, v2
    v_add_u32 v3, 49152, v2
    s_add_u32 s21, s29, 4096
    s_add_u32 s21, s21, s23
    v_add_u32 v8, s21, v35
    v_add_u32 v9, 49152, v8
    v_mul_u32_u24 v231, 320, v7
    v_add_u32 v231, v231, v35
    s_add_u32 s21, s29, 6144
    v_add_u32 v231, s21, v231
    v_cmp_gt_u32 vcc, 20, v6
    v_cmp_eq_u32 s[40:41], 20, v6
    v_mov_b32 v232, 98320
    v_mov_b32 v233, 98304
    v_cndmask_b32 v232, v232, v233, s[40:41]
    v_cndmask_b32 v4, v232, v231, vcc
    v_add_u32 v231, 24576, v231
    v_cndmask_b32 v10, v232, v231, vcc
    v_add_u32 v231, 24576, v231
    v_cndmask_b32 v11, v232, v231, vcc
    v_add_u32 v231, 24576, v231
    v_cndmask_b32 v53, v232, v231, vcc
    v_and_b32 v231, 7, v1
    v_cmp_gt_u32 vcc, 4, v231
    v_mov_b32 v232, 0x3f803f80
    v_lshrrev_b32 v233, 3, v1
    v_cndmask_b32 v232, 0, v232, vcc
    v_mul_u32_u24 v233, 640, v233
    v_lshl_add_u32 v231, v231, 2, v233
    v_add_u32 v231, 98304, v231
    ds_write_b32 v231, v232
    v_and_b32 v237, 15, v1
    v_lshlrev_b32 v238, 4, v237
    s_lshr_b32 s26, s17, 8
    s_lshl_b32 s26, s26, 5
    s_add_u32 s26, s26, s16
    s_lshl_b32 s26, s26, 7
    s_add_u32 s26, s26, 16842752
    s_cmp_eq_u32 s18, 0
    s_cselect_b32 s51, s26, 2147483648
    s_lshl_b32 s27, s20, 5
    s_add_u32 s27, s27, s17
    v_add_u32 v236, s27, v6
    v_lshrrev_b32 v236, 4, v236
    v_mul_u32_u24 v236, 20480, v236
    s_lshr_b32 s28, s16, 3
    s_mul_i32 s28, s28, 5120
    s_add_u32 s28, s28, 7864320
    s_and_b32 s29, s16, 7
    s_lshl_b32 s27, s29, 9
    s_add_u32 s27, s27, s28
    v_add_u32 v57, s27, v236
    v_add_u32 v57, v57, v238
    v_lshl_add_u32 v57, v7, 8, v57
    s_lshl_b32 s27, s29, 7
    s_add_u32 s27, s27, s28
    s_add_u32 s27, s27, 4096
    v_add_u32 v58, s27, v236
    v_lshl_add_u32 v58, v237, 3, v58
    v_mov_b32 v52, 0xdddddddd
    v_mov_b32 v62, v245
    v_add_u32 v61, 65536, v5
    v_mov_b32 v64, 0
    v_mov_b32 v65, 0
    v_mov_b32 v66, 0
    v_mov_b32 v67, 0
    v_mov_b32 v68, 0
    v_mov_b32 v69, 0
    v_mov_b32 v70, 0
    v_mov_b32 v71, 0
    v_mov_b32 v72, 0
    v_mov_b32 v73, 0
    v_mov_b32 v74, 0
    v_mov_b32 v75, 0
    v_mov_b32 v76, 0
    v_mov_b32 v77, 0
    v_mov_b32 v78, 0
    v_mov_b32 v79, 0
    v_mov_b32 v80, 0
    v_mov_b32 v81, 0
    v_mov_b32 v82, 0
    v_mov_b32 v83, 0
    v_mov_b32 v84, 0
    v_mov_b32 v85, 0
    v_mov_b32 v86, 0
    v_mov_b32 v87, 0
    v_mov_b32 v88, 0
    v_mov_b32 v89, 0
    v_mov_b32 v90, 0
    v_mov_b32 v91, 0
    v_mov_b32 v92, 0
    v_mov_b32 v93, 0
    v_mov_b32 v94, 0
    v_mov_b32 v95, 0
    s_mov_b32 s33, 32768
L_tg:
    s_waitcnt vmcnt(0)
    v_readfirstlane_b32 s55, v59
    s_sub_u32 s33, s33, 1
    s_cmp_lg_u32 s55, 0
    s_cbranch_scc1 L_tgd
    s_cmp_lt_i32 s33, 1
    s_cbranch_scc1 L_tgd
    buffer_load_dword v59, v60, s[4:7], 0 offen sc1
    s_branch L_tg
L_tgd:
    v_mov_b32 v243, 35840
    s_cmp_ge_u32 s18, 4
    s_cbranch_scc1 L_hs
    v_mov_b32 v244, 1
    s_mov_b64 exec, 1
    ds_add_rtn_u32 v244, v243, v244
    s_waitcnt lgkmcnt(0)
    v_readfirstlane_b32 s32, v244
    s_mov_b64 exec, -1
    s_cmp_lg_u32 s32, 3
    s_cbranch_scc1 L_hs
    v_lshlrev_b32 v243, 2, v1
    s_mov_b32 exec_hi, 0
    buffer_store_dword v59, v243, s[12:15], s58 offen sc0 sc1
    s_mov_b32 exec_hi, -1
L_hs:
    s_mov_b64 s[42:43], 0
    v_mov_b32 v233, 0
    v_mov_b32 v230, 35840
    s_mul_i32 s38, s19, 3072
    s_add_u32 s38, s38, 104448
    s_lshl_b32 s29, s20, 10
    s_add_u32 s29, s29, s38
    v_add_u32 v16, s29, v5
    s_xor_b32 s28, s20, 1
    s_lshl_b32 s29, s28, 10
    s_add_u32 s29, s29, s38
    v_add_u32 v12, s29, v5
    s_lshl_b32 s28, s28, 9
    v_xor_b32 v20, s28, v5
    s_add_u32 s29, s38, s23
    s_add_u32 s29, s29, 2048
    v_add_u32 v20, s29, v20
    s_mov_b32 s52, 0
    s_cmp_lt_u32 s18, 4
    s_cbranch_scc1 L_h2x
    v_lshlrev_b32 v239, 2, v1
    v_and_b32 v239, 31, v239
    v_add_u32 v239, 163776, v239
    ds_write_b32 v239, v60
    s_cmp_ge_u32 s18, 6
    s_cbranch_scc1 L_hw2
    s_mul_i32 s26, s16, 20
    v_bfe_u32 v232, v1, 4, 1
    v_mul_u32_u24 v232, 19, v232
    v_add_u32 v232, s26, v232
    v_lshrrev_b32 v232, 7, v232
    v_and_b32 v233, 15, v1
    v_mad_u32_u24 v234, v7, 5, 5
    v_add_u32 v234, v234, v232
    s_cmp_eq_u32 s18, 4
    s_cbranch_scc1 L_h4
    s_lshr_b32 s27, s17, 8
    s_lshl_b32 s27, s27, 1
    v_and_b32 v235, 1, v1
    v_add_u32 v235, s27, v235
    v_cmp_eq_u32 vcc, 0, v7
    v_mov_b32 v234, 15
    s_nop 0
    v_cndmask_b32 v234, v234, v232, vcc
    v_cndmask_b32 v233, v233, v235, vcc
L_h4:
    v_lshl_add_u32 v233, v234, 4, v233
    v_lshlrev_b32 v233, 7, v233
    v_add_u32 v233, 16875520, v233
    s_mov_b32 s33, 32768
    s_cmp_eq_u32 s18, 4
    s_cselect_b32 s40, 0x01010101, -1
    s_cselect_b32 s41, 0x01010101, 0
    s_mov_b64 s[42:43], -1
    s_sleep 12
L_hp:
    s_mov_b64 exec, s[40:41]
    buffer_load_dword v231, v233, s[12:15], 0 offen sc1
    s_sub_u32 s33, s33, 1
    s_waitcnt vmcnt(0)
    v_cmp_ne_u32 vcc, s55, v231
    s_mov_b64 exec, -1
    s_cbranch_vccz L_hd
    s_cmp_lt_i32 s33, 1
    s_cbranch_scc1 L_hd
    s_sleep 6
    s_branch L_hp
L_hd:
    v_mov_b32 v231, 1
    s_mov_b64 exec, 1
    ds_add_u32 v230, v231 offset:4
    s_mov_b64 exec, -1
L_hw2:
    s_mov_b32 s39, 524288
L_hc:
    ds_read_b32 v231, v230 offset:4
    s_sub_u32 s39, s39, 1
    s_waitcnt lgkmcnt(0)
    v_readfirstlane_b32 s32, v231
    s_cmp_lt_i32 s39, 1
    s_cbranch_scc1 L_hcd
    s_cmp_lt_u32 s32, 2
    s_cbranch_scc1 L_hc
L_hcd:
    s_add_u32 m0, s50, 0
    s_mov_b32 s52, 0
    buffer_load_dwordx4 v54, s[12:15], s52 offen offset:0 lds
    buffer_load_dwordx4 v55, s[12:15], s52 offen offset:1024 lds
    buffer_load_dwordx4 v56, s[12:15], s52 offen offset:2048 lds
    s_lshl_b32 s28, s49, 3
    s_sub_u32 m0, s50, 12288
    v_subrev_u32 v240, s28, v54
    v_subrev_u32 v241, s28, v55
    v_subrev_u32 v242, s28, v56
    buffer_load_dwordx4 v240, s[12:15], 0 offen offset:0 lds
    buffer_load_dwordx4 v241, s[12:15], 0 offen offset:1024 lds
    buffer_load_dwordx4 v242, s[12:15], 0 offen offset:2048 lds
    s_mov_b32 m0, s38
    s_sub_u32 s28, s30, 512
    buffer_load_dwordx4 v34, s[12:15], s30 offen lds
    s_add_u32 m0, s38, 512
    s_sub_u32 s28, s31, 2048
    buffer_load_dwordx4 v34, s[12:15], s30 offen offset:512 lds
    s_add_u32 m0, s38, 2048
    s_nop 0
    buffer_load_dwordx4 v5, s[12:15], s31 offen lds
L_h2:
    s_cmp_eq_u64 s[42:43], 0
    s_cbranch_scc1 L_h2d
    s_sub_u32 s33, s33, 1
    s_cmp_lt_i32 s33, 1
    s_cbranch_scc1 L_h2d
    s_sleep 6
    buffer_load_dword v231, v233, s[12:15], 0 offen sc1
    s_waitcnt vmcnt(0)
    v_cmp_ne_u32 s[42:43], s55, v231
    s_mov_b64 exec, -1
    s_branch L_h2
L_h2d:
    s_waitcnt vmcnt(0)
L_h2x:
    s_waitcnt lgkmcnt(0)
    s_barrier
    ds_read_b128 v[12:15], v12
    ds_read_b128 v[16:19], v16
    ds_read_b64 v[20:21], v20
    ds_read_b128 v[22:25], v2 offset:0
    ds_read_b64 v[26:27], v8 offset:0
    ds_read_b128 v[28:31], v2 offset:512
    ds_read_b64 v[32:33], v8 offset:512
    ds_read_b128 v[36:39], v4 offset:0
    ds_read_b128 v[40:43], v4 offset:640
    s_waitcnt lgkmcnt(4)
    v_mfma_f32_32x32x4_2b_bf16 v[96:127], v[26:27], v[20:21], 0
    s_add_u32 m0, s50, 24576
    s_add_u32 s52, s52, s49
    buffer_load_dwordx4 v54, s[12:15], s52 offen offset:0 lds
    buffer_load_dwordx4 v55, s[12:15], s52 offen offset:1024 lds
    buffer_load_dwordx4 v56, s[12:15], s52 offen offset:2048 lds
    s_nop 12
    v_mfma_f32_32x32x16_bf16 v[96:111], v[22:25], v[12:15], v[96:111]
    v_mfma_f32_32x32x16_bf16 v[112:127], v[22:25], v[16:19], v[112:127]
    s_nop 9
    s_waitcnt lgkmcnt(0)
    s_setprio 2
    v_exp_f32 v96, v96
    ds_read_b128 v[22:25], v2 offset:1024
    v_exp_f32 v97, v97
    v_exp_f32 v98, v98
    v_exp_f32 v99, v99
    v_mfma_f32_32x32x4_2b_bf16 v[128:159], v[32:33], v[20:21], 0
    ds_read_b64 v[26:27], v8 offset:1024
    s_add_u32 m0, s50, 49152
    s_add_u32 s52, s52, s49
    v_exp_f32 v100, v100
    v_exp_f32 v101, v101
    v_exp_f32 v102, v102
    v_exp_f32 v103, v103
    v_exp_f32 v104, v104
    v_exp_f32 v105, v105
    v_exp_f32 v106, v106
    v_exp_f32 v107, v107
    v_smfmac_f32_32x32x32_bf16 v[64:79], v[36:39], v[96:103], v52
    ds_read_b128 v[44:47], v4 offset:1280
    buffer_load_dwordx4 v54, s[12:15], s52 offen offset:0 lds
    v_exp_f32 v108, v108
    v_exp_f32 v109, v109
    v_exp_f32 v110, v110
    v_exp_f32 v111, v111
    v_exp_f32 v112, v112
    v_exp_f32 v113, v113
    v_smfmac_f32_32x32x32_bf16 v[64:79], v[40:43], v[104:111], v52
    ds_read_b128 v[48:51], v4 offset:1920
    v_exp_f32 v114, v114
    v_exp_f32 v115, v115
    v_exp_f32 v116, v116
    v_exp_f32 v117, v117
    v_mfma_f32_32x32x16_bf16 v[128:143], v[28:31], v[12:15], v[128:143]
    s_setprio 1
    buffer_load_dwordx4 v55, s[12:15], s52 offen offset:1024 lds
    v_exp_f32 v118, v118
    v_exp_f32 v119, v119
    v_exp_f32 v120, v120
    v_exp_f32 v121, v121
    v_mfma_f32_32x32x16_bf16 v[144:159], v[28:31], v[16:19], v[144:159]
    buffer_load_dwordx4 v56, s[12:15], s52 offen offset:2048 lds
    s_add_u32 m0, s54, 0
    v_exp_f32 v122, v122
    v_exp_f32 v123, v123
    v_exp_f32 v124, v124
    v_exp_f32 v125, v125
    v_smfmac_f32_32x32x32_bf16 v[80:95], v[36:39], v[112:119], v52
    buffer_load_dwordx4 v190, s[60:63], s72 offen offset:0 lds
    v_exp_f32 v126, v126
    v_exp_f32 v127, v127
    s_waitcnt lgkmcnt(0)
    v_exp_f32 v128, v128
    v_smfmac_f32_32x32x32_bf16 v[80:95], v[40:43], v[120:127], v52
    ds_read_b128 v[28:31], v2 offset:1536
    v_exp_f32 v129, v129
    v_exp_f32 v130, v130
    v_exp_f32 v131, v131
    v_mfma_f32_32x32x4_2b_bf16 v[96:127], v[26:27], v[20:21], 0
    ds_read_b64 v[32:33], v8 offset:1536
    s_add_u32 m0, s54, 896
    v_exp_f32 v132, v132
    v_exp_f32 v133, v133
    v_exp_f32 v134, v134
    v_exp_f32 v135, v135
    v_exp_f32 v136, v136
    v_exp_f32 v137, v137
    v_exp_f32 v138, v138
    v_exp_f32 v139, v139
    v_smfmac_f32_32x32x32_bf16 v[64:79], v[44:47], v[128:135], v52
    ds_read_b128 v[36:39], v4 offset:2560
    buffer_load_dwordx4 v190, s[60:63], s72 offen offset:128 lds
    v_exp_f32 v140, v140
    v_exp_f32 v141, v141
    v_exp_f32 v142, v142
    v_exp_f32 v143, v143
    v_exp_f32 v144, v144
    v_exp_f32 v145, v145
    v_smfmac_f32_32x32x32_bf16 v[64:79], v[48:51], v[136:143], v52
    ds_read_b128 v[40:43], v4 offset:3200
    v_exp_f32 v146, v146
    v_exp_f32 v147, v147
    v_exp_f32 v148, v148
    v_exp_f32 v149, v149
    v_mfma_f32_32x32x16_bf16 v[96:111], v[22:25], v[12:15], v[96:111]
    s_setprio 0
    s_add_u32 m0, s54, 1792
    v_exp_f32 v150, v150
    v_exp_f32 v151, v151
    v_exp_f32 v152, v152
    v_exp_f32 v153, v153
    v_mfma_f32_32x32x16_bf16 v[112:127], v[22:25], v[16:19], v[112:127]
    buffer_load_dwordx4 v190, s[60:63], s72 offen offset:256 lds
    v_exp_f32 v154, v154
    v_exp_f32 v155, v155
    v_exp_f32 v156, v156
    v_exp_f32 v157, v157
    v_smfmac_f32_32x32x32_bf16 v[80:95], v[44:47], v[144:151], v52
    v_exp_f32 v158, v158
    v_exp_f32 v159, v159
    s_waitcnt vmcnt(6) lgkmcnt(0)
    s_barrier
    s_setprio 3
    v_exp_f32 v96, v96
    v_smfmac_f32_32x32x32_bf16 v[80:95], v[48:51], v[152:159], v52
    ds_read_b128 v[22:25], v2 offset:24576
    v_exp_f32 v97, v97
    v_exp_f32 v98, v98
    v_exp_f32 v99, v99
    v_mfma_f32_32x32x4_2b_bf16 v[128:159], v[32:33], v[20:21], 0
    ds_read_b64 v[26:27], v8 offset:24576
    v_exp_f32 v100, v100
    v_exp_f32 v101, v101
    v_exp_f32 v102, v102
    v_exp_f32 v103, v103
    v_exp_f32 v104, v104
    v_exp_f32 v105, v105
    v_exp_f32 v106, v106
    v_exp_f32 v107, v107
    v_smfmac_f32_32x32x32_bf16 v[64:79], v[36:39], v[96:103], v52
    ds_read_b128 v[44:47], v4 offset:3840
    v_exp_f32 v108, v108
    v_exp_f32 v109, v109
    v_exp_f32 v110, v110
    v_exp_f32 v111, v111
    v_exp_f32 v112, v112
    v_exp_f32 v113, v113
    v_smfmac_f32_32x32x32_bf16 v[64:79], v[40:43], v[104:111], v52
    ds_read_b128 v[48:51], v4 offset:4480
    s_add_u32 m0, s50, 73728
    s_add_u32 s52, s52, s49
    v_exp_f32 v114, v114
    v_exp_f32 v115, v115
    v_exp_f32 v116, v116
    v_exp_f32 v117, v117
    v_mfma_f32_32x32x16_bf16 v[128:143], v[28:31], v[12:15], v[128:143]
    buffer_load_dwordx4 v54, s[12:15], s52 offen offset:0 lds
    v_exp_f32 v118, v118
    v_exp_f32 v119, v119
    v_exp_f32 v120, v120
    v_exp_f32 v121, v121
    v_mfma_f32_32x32x16_bf16 v[144:159], v[28:31], v[16:19], v[144:159]
    buffer_load_dwordx4 v55, s[12:15], s52 offen offset:1024 lds
    v_exp_f32 v122, v122
    v_exp_f32 v123, v123
    v_exp_f32 v124, v124
    v_exp_f32 v125, v125
    v_smfmac_f32_32x32x32_bf16 v[80:95], v[36:39], v[112:119], v52
    buffer_load_dwordx4 v56, s[12:15], s52 offen offset:2048 lds
    v_exp_f32 v126, v126
    v_exp_f32 v127, v127
    s_waitcnt lgkmcnt(0)
    v_exp_f32 v128, v128
    v_smfmac_f32_32x32x32_bf16 v[80:95], v[40:43], v[120:127], v52
    ds_read_b128 v[28:31], v2 offset:25088
    buffer_load_dwordx2 v[172:173], v195, s[68:71], s82 offen offset:0
    v_exp_f32 v129, v129
    v_exp_f32 v130, v130
    v_exp_f32 v131, v131
    v_mfma_f32_32x32x4_2b_bf16 v[96:127], v[26:27], v[20:21], 0
    ds_read_b64 v[32:33], v8 offset:25088
    buffer_load_dwordx2 v[174:175], v195, s[68:71], s82 offen offset:32
    v_exp_f32 v132, v132
    v_exp_f32 v133, v133
    v_exp_f32 v134, v134
    v_exp_f32 v135, v135
    v_exp_f32 v136, v136
    v_exp_f32 v137, v137
    v_exp_f32 v138, v138
    v_exp_f32 v139, v139
    v_smfmac_f32_32x32x32_bf16 v[64:79], v[44:47], v[128:135], v52
    ds_read_b128 v[36:39], v10 offset:0
    buffer_load_dwordx2 v[176:177], v195, s[68:71], s82 offen offset:64
    v_exp_f32 v140, v140
    v_exp_f32 v141, v141
    v_exp_f32 v142, v142
    v_exp_f32 v143, v143
    v_exp_f32 v144, v144
    v_exp_f32 v145, v145
    v_smfmac_f32_32x32x32_bf16 v[64:79], v[48:51], v[136:143], v52
    ds_read_b128 v[40:43], v10 offset:640
    buffer_load_dwordx2 v[178:179], v195, s[68:71], s82 offen offset:96
    v_exp_f32 v146, v146
    v_exp_f32 v147, v147
    v_exp_f32 v148, v148
    v_exp_f32 v149, v149
    v_mfma_f32_32x32x16_bf16 v[96:111], v[22:25], v[12:15], v[96:111]
    buffer_load_dwordx2 v[180:181], v195, s[68:71], s82 offen offset:128
    v_exp_f32 v150, v150
    v_exp_f32 v151, v151
    v_exp_f32 v152, v152
    v_exp_f32 v153, v153
    v_mfma_f32_32x32x16_bf16 v[112:127], v[22:25], v[16:19], v[112:127]
    v_exp_f32 v154, v154
    v_exp_f32 v155, v155
    v_exp_f32 v156, v156
    v_exp_f32 v157, v157
    v_smfmac_f32_32x32x32_bf16 v[80:95], v[44:47], v[144:151], v52
    v_exp_f32 v158, v158
    v_exp_f32 v159, v159
    s_waitcnt lgkmcnt(0)
    s_setprio 2
    v_exp_f32 v96, v96
    v_smfmac_f32_32x32x32_bf16 v[80:95], v[48:51], v[152:159], v52
    ds_read_b128 v[22:25], v2 offset:25600
    v_exp_f32 v97, v97
    v_exp_f32 v98, v98
    v_exp_f32 v99, v99
    v_mfma_f32_32x32x4_2b_bf16 v[128:159], v[32:33], v[20:21], 0
    ds_read_b64 v[26:27], v8 offset:25600
    v_exp_f32 v100, v100
    v_exp_f32 v101, v101
    v_exp_f32 v102, v102
    v_exp_f32 v103, v103
    v_exp_f32 v104, v104
    v_exp_f32 v105, v105
    v_exp_f32 v106, v106
    v_exp_f32 v107, v107
    v_smfmac_f32_32x32x32_bf16 v[64:79], v[36:39], v[96:103], v52
    ds_read_b128 v[44:47], v10 offset:1280
    s_mov_b32 exec_hi, 0
    buffer_store_dwordx2 v[248:249], v58, s[12:15], 0 offen sc0 sc1
    s_cmp_ge_u32 s18, 4
    s_movk_i32 s26, 0xff
    s_cselect_b32 exec_lo, 0xffff, s26
    buffer_store_dwordx4 v[248:251], v5, s[12:15], s59 offen sc0 sc1
    s_mov_b64 exec, -1
    v_exp_f32 v108, v108
    v_exp_f32 v109, v109
    v_exp_f32 v110, v110
    v_exp_f32 v111, v111
    v_exp_f32 v112, v112
    v_exp_f32 v113, v113
    v_smfmac_f32_32x32x32_bf16 v[64:79], v[40:43], v[104:111], v52
    ds_read_b128 v[48:51], v10 offset:1920
    v_exp_f32 v114, v114
    v_exp_f32 v115, v115
    v_exp_f32 v116, v116
    v_exp_f32 v117, v117
    v_mfma_f32_32x32x16_bf16 v[128:143], v[28:31], v[12:15], v[128:143]
    s_setprio 1
    v_exp_f32 v118, v118
    v_exp_f32 v119, v119
    v_exp_f32 v120, v120
    v_exp_f32 v121, v121
    v_mfma_f32_32x32x16_bf16 v[144:159], v[28:31], v[16:19], v[144:159]
    v_exp_f32 v122, v122
    v_exp_f32 v123, v123
    v_exp_f32 v124, v124
    v_exp_f32 v125, v125
    v_smfmac_f32_32x32x32_bf16 v[80:95], v[36:39], v[112:119], v52
    v_exp_f32 v126, v126
    v_exp_f32 v127, v127
    s_waitcnt lgkmcnt(0)
    v_exp_f32 v128, v128
    v_smfmac_f32_32x32x32_bf16 v[80:95], v[40:43], v[120:127], v52
    ds_read_b128 v[28:31], v2 offset:26112
    v_exp_f32 v129, v129
    v_exp_f32 v130, v130
    v_exp_f32 v131, v131
    v_mfma_f32_32x32x4_2b_bf16 v[96:127], v[26:27], v[20:21], 0
    ds_read_b64 v[32:33], v8 offset:26112
    v_exp_f32 v132, v132
    v_exp_f32 v133, v133
    v_exp_f32 v134, v134
    v_exp_f32 v135, v135
    v_exp_f32 v136, v136
    v_exp_f32 v137, v137
    v_exp_f32 v138, v138
    v_exp_f32 v139, v139
    v_smfmac_f32_32x32x32_bf16 v[64:79], v[44:47], v[128:135], v52
    ds_read_b128 v[36:39], v10 offset:2560
    buffer_store_dwordx4 v[248:251], v57, s[12:15], 0 offen sc0 sc1
    v_exp_f32 v140, v140
    v_exp_f32 v141, v141
    v_exp_f32 v142, v142
    v_exp_f32 v143, v143
    v_exp_f32 v144, v144
    v_exp_f32 v145, v145
    v_smfmac_f32_32x32x32_bf16 v[64:79], v[48:51], v[136:143], v52
    ds_read_b128 v[40:43], v10 offset:3200
    v_exp_f32 v146, v146
    v_exp_f32 v147, v147
    v_exp_f32 v148, v148
    v_exp_f32 v149, v149
    v_mfma_f32_32x32x16_bf16 v[96:111], v[22:25], v[12:15], v[96:111]
    s_setprio 0
    v_exp_f32 v150, v150
    v_exp_f32 v151, v151
    v_exp_f32 v152, v152
    v_exp_f32 v153, v153
    v_mfma_f32_32x32x16_bf16 v[112:127], v[22:25], v[16:19], v[112:127]
    v_exp_f32 v154, v154
    v_exp_f32 v155, v155
    v_exp_f32 v156, v156
    v_exp_f32 v157, v157
    v_smfmac_f32_32x32x32_bf16 v[80:95], v[44:47], v[144:151], v52
    v_exp_f32 v158, v158
    v_exp_f32 v159, v159
    s_waitcnt vmcnt(11) lgkmcnt(0)
    s_barrier
    s_setprio 3
    v_exp_f32 v96, v96
    v_smfmac_f32_32x32x32_bf16 v[80:95], v[48:51], v[152:159], v52
    ds_read_b64_tr_b16 v[232:233], v192 offset:0
    ds_read_b128 v[22:25], v3 offset:0
    v_exp_f32 v97, v97
    v_exp_f32 v98, v98
    v_exp_f32 v99, v99
    v_mfma_f32_32x32x4_2b_bf16 v[128:159], v[32:33], v[20:21], 0
    ds_read_b64_tr_b16 v[234:235], v192 offset:512
    ds_read_b64 v[26:27], v9 offset:0
    v_exp_f32 v100, v100
    v_exp_f32 v101, v101
    v_exp_f32 v102, v102
    v_exp_f32 v103, v103
    v_exp_f32 v104, v104
    v_exp_f32 v105, v105
    v_exp_f32 v106, v106
    v_exp_f32 v107, v107
    v_smfmac_f32_32x32x32_bf16 v[64:79], v[36:39], v[96:103], v52
    ds_read_b64_tr_b16 v[236:237], v192 offset:1024
    ds_read_b128 v[44:47], v10 offset:3840
    v_exp_f32 v108, v108
    v_exp_f32 v109, v109
    v_exp_f32 v110, v110
    v_exp_f32 v111, v111
    v_exp_f32 v112, v112
    v_exp_f32 v113, v113
    v_smfmac_f32_32x32x32_bf16 v[64:79], v[40:43], v[104:111], v52
    ds_read_b64_tr_b16 v[238:239], v192 offset:1536
    ds_read_b128 v[48:51], v10 offset:4480
    s_add_u32 m0, s50, 0
    s_add_u32 s52, s52, s49
    v_exp_f32 v114, v114
    v_exp_f32 v115, v115
    v_exp_f32 v116, v116
    v_exp_f32 v117, v117
    v_mfma_f32_32x32x16_bf16 v[128:143], v[28:31], v[12:15], v[128:143]
    ds_read_b64_tr_b16 v[240:241], v192 offset:2048
    buffer_load_dwordx4 v54, s[12:15], s52 offen offset:0 lds
    v_exp_f32 v118, v118
    v_exp_f32 v119, v119
    v_exp_f32 v120, v120
    v_exp_f32 v121, v121
    v_mfma_f32_32x32x16_bf16 v[144:159], v[28:31], v[16:19], v[144:159]
    ds_read_b64_tr_b16 v[242:243], v192 offset:2560
    buffer_load_dwordx4 v55, s[12:15], s52 offen offset:1024 lds
    v_exp_f32 v122, v122
    v_exp_f32 v123, v123
    v_exp_f32 v124, v124
    v_exp_f32 v125, v125
    v_smfmac_f32_32x32x32_bf16 v[80:95], v[36:39], v[112:119], v52
    buffer_load_dwordx4 v56, s[12:15], s52 offen offset:2048 lds
    v_exp_f32 v126, v126
    v_exp_f32 v127, v127
    s_waitcnt lgkmcnt(0)
    v_exp_f32 v128, v128
    v_smfmac_f32_32x32x32_bf16 v[80:95], v[40:43], v[120:127], v52
    ds_read_b128 v[28:31], v3 offset:512
    v_exp_f32 v129, v129
    v_exp_f32 v130, v130
    v_exp_f32 v131, v131
    v_mfma_f32_32x32x4_2b_bf16 v[96:127], v[26:27], v[20:21], 0
    ds_read_b64 v[32:33], v9 offset:512
    v_exp_f32 v132, v132
    v_exp_f32 v133, v133
    v_exp_f32 v134, v134
    v_exp_f32 v135, v135
    v_exp_f32 v136, v136
    v_exp_f32 v137, v137
    v_exp_f32 v138, v138
    v_exp_f32 v139, v139
    v_smfmac_f32_32x32x32_bf16 v[64:79], v[44:47], v[128:135], v52
    ds_read_b128 v[36:39], v11 offset:0
    s_add_u32 s26, s78, 0
    buffer_store_dwordx4 v[232:235], v193, s[12:15], s26 offen sc0 sc1
    v_exp_f32 v140, v140
    v_exp_f32 v141, v141
    v_exp_f32 v142, v142
    v_exp_f32 v143, v143
    v_exp_f32 v144, v144
    v_exp_f32 v145, v145
    v_smfmac_f32_32x32x32_bf16 v[64:79], v[48:51], v[136:143], v52
    ds_read_b128 v[40:43], v11 offset:640
    v_exp_f32 v146, v146
    v_exp_f32 v147, v147
    v_exp_f32 v148, v148
    v_exp_f32 v149, v149
    v_mfma_f32_32x32x16_bf16 v[96:111], v[22:25], v[12:15], v[96:111]
    v_exp_f32 v150, v150
    v_exp_f32 v151, v151
    v_exp_f32 v152, v152
    v_exp_f32 v153, v153
    v_mfma_f32_32x32x16_bf16 v[112:127], v[22:25], v[16:19], v[112:127]
    v_exp_f32 v154, v154
    v_exp_f32 v155, v155
    v_exp_f32 v156, v156
    v_exp_f32 v157, v157
    v_smfmac_f32_32x32x32_bf16 v[80:95], v[44:47], v[144:151], v52
    v_exp_f32 v158, v158
    v_exp_f32 v159, v159
    s_waitcnt lgkmcnt(0)
    s_setprio 2
    v_exp_f32 v96, v96
    v_smfmac_f32_32x32x32_bf16 v[80:95], v[48:51], v[152:159], v52
    ds_read_b128 v[22:25], v3 offset:1024
    v_exp_f32 v97, v97
    v_exp_f32 v98, v98
    v_exp_f32 v99, v99
    v_mfma_f32_32x32x4_2b_bf16 v[128:159], v[32:33], v[20:21], 0
    ds_read_b64 v[26:27], v9 offset:1024
    v_exp_f32 v100, v100
    v_exp_f32 v101, v101
    v_exp_f32 v102, v102
    v_exp_f32 v103, v103
    v_exp_f32 v104, v104
    v_exp_f32 v105, v105
    v_exp_f32 v106, v106
    v_exp_f32 v107, v107
    v_smfmac_f32_32x32x32_bf16 v[64:79], v[36:39], v[96:103], v52
    ds_read_b128 v[44:47], v11 offset:1280
    s_add_u32 s26, s78, 262144
    buffer_store_dwordx4 v[236:239], v193, s[12:15], s26 offen sc0 sc1
    v_exp_f32 v108, v108
    v_exp_f32 v109, v109
    v_exp_f32 v110, v110
    v_exp_f32 v111, v111
    v_exp_f32 v112, v112
    v_exp_f32 v113, v113
    v_smfmac_f32_32x32x32_bf16 v[64:79], v[40:43], v[104:111], v52
    ds_read_b128 v[48:51], v11 offset:1920
    v_exp_f32 v114, v114
    v_exp_f32 v115, v115
    v_exp_f32 v116, v116
    v_exp_f32 v117, v117
    v_mfma_f32_32x32x16_bf16 v[128:143], v[28:31], v[12:15], v[128:143]
    s_setprio 1
    v_exp_f32 v118, v118
    v_exp_f32 v119, v119
    v_exp_f32 v120, v120
    v_exp_f32 v121, v121
    v_mfma_f32_32x32x16_bf16 v[144:159], v[28:31], v[16:19], v[144:159]
    v_exp_f32 v122, v122
    v_exp_f32 v123, v123
    v_exp_f32 v124, v124
    v_exp_f32 v125, v125
    v_smfmac_f32_32x32x32_bf16 v[80:95], v[36:39], v[112:119], v52
    v_exp_f32 v126, v126
    v_exp_f32 v127, v127
    s_waitcnt lgkmcnt(0)
    v_exp_f32 v128, v128
    v_smfmac_f32_32x32x32_bf16 v[80:95], v[40:43], v[120:127], v52
    ds_read_b128 v[28:31], v3 offset:1536
    v_exp_f32 v129, v129
    v_exp_f32 v130, v130
    v_exp_f32 v131, v131
    v_mfma_f32_32x32x4_2b_bf16 v[96:127], v[26:27], v[20:21], 0
    ds_read_b64 v[32:33], v9 offset:1536
    v_exp_f32 v132, v132
    v_exp_f32 v133, v133
    v_exp_f32 v134, v134
    v_exp_f32 v135, v135
    v_exp_f32 v136, v136
    v_exp_f32 v137, v137
    v_exp_f32 v138, v138
    v_exp_f32 v139, v139
    v_smfmac_f32_32x32x32_bf16 v[64:79], v[44:47], v[128:135], v52
    ds_read_b128 v[36:39], v11 offset:2560
    s_add_u32 s26, s78, 524288
    buffer_store_dwordx4 v[240:243], v193, s[12:15], s26 offen sc0 sc1
    v_exp_f32 v140, v140
    v_exp_f32 v141, v141
    v_exp_f32 v142, v142
    v_exp_f32 v143, v143
    v_exp_f32 v144, v144
    v_exp_f32 v145, v145
    v_smfmac_f32_32x32x32_bf16 v[64:79], v[48:51], v[136:143], v52
    ds_read_b128 v[40:43], v11 offset:3200
    v_exp_f32 v146, v146
    v_exp_f32 v147, v147
    v_exp_f32 v148, v148
    v_exp_f32 v149, v149
    v_mfma_f32_32x32x16_bf16 v[96:111], v[22:25], v[12:15], v[96:111]
    s_setprio 0
    v_exp_f32 v150, v150
    v_exp_f32 v151, v151
    v_exp_f32 v152, v152
    v_exp_f32 v153, v153
    v_mfma_f32_32x32x16_bf16 v[112:127], v[22:25], v[16:19], v[112:127]
    v_exp_f32 v154, v154
    v_exp_f32 v155, v155
    v_exp_f32 v156, v156
    v_exp_f32 v157, v157
    v_smfmac_f32_32x32x32_bf16 v[80:95], v[44:47], v[144:151], v52
    v_exp_f32 v158, v158
    v_exp_f32 v159, v159
    s_waitcnt vmcnt(14) lgkmcnt(0)
    s_barrier
    s_setprio 3
    v_exp_f32 v96, v96
    v_smfmac_f32_32x32x32_bf16 v[80:95], v[48:51], v[152:159], v52
    ds_read_b128 v[22:25], v3 offset:24576
    v_exp_f32 v97, v97
    v_exp_f32 v98, v98
    v_exp_f32 v99, v99
    v_mfma_f32_32x32x4_2b_bf16 v[128:159], v[32:33], v[20:21], 0
    ds_read_b64 v[26:27], v9 offset:24576
    v_exp_f32 v100, v100
    v_exp_f32 v101, v101
    v_exp_f32 v102, v102
    v_exp_f32 v103, v103
    v_exp_f32 v104, v104
    v_exp_f32 v105, v105
    v_exp_f32 v106, v106
    v_exp_f32 v107, v107
    v_smfmac_f32_32x32x32_bf16 v[64:79], v[36:39], v[96:103], v52
    ds_read_b128 v[44:47], v11 offset:3840
    v_exp_f32 v108, v108
    v_exp_f32 v109, v109
    v_exp_f32 v110, v110
    v_exp_f32 v111, v111
    v_exp_f32 v112, v112
    v_exp_f32 v113, v113
    v_smfmac_f32_32x32x32_bf16 v[64:79], v[40:43], v[104:111], v52
    ds_read_b128 v[48:51], v11 offset:4480
    s_add_u32 m0, s50, 24576
    s_add_u32 s52, s52, s49
    v_exp_f32 v114, v114
    v_exp_f32 v115, v115
    v_exp_f32 v116, v116
    v_exp_f32 v117, v117
    v_mfma_f32_32x32x16_bf16 v[128:143], v[28:31], v[12:15], v[128:143]
    buffer_load_dwordx4 v54, s[12:15], s52 offen offset:0 lds
    v_exp_f32 v118, v118
    v_exp_f32 v119, v119
    v_exp_f32 v120, v120
    v_exp_f32 v121, v121
    v_mfma_f32_32x32x16_bf16 v[144:159], v[28:31], v[16:19], v[144:159]
    buffer_load_dwordx4 v55, s[12:15], s52 offen offset:1024 lds
    v_exp_f32 v122, v122
    v_exp_f32 v123, v123
    v_exp_f32 v124, v124
    v_exp_f32 v125, v125
    v_smfmac_f32_32x32x32_bf16 v[80:95], v[36:39], v[112:119], v52
    buffer_load_dwordx4 v56, s[12:15], s52 offen offset:2048 lds
    v_exp_f32 v126, v126
    v_exp_f32 v127, v127
    s_waitcnt lgkmcnt(0)
    v_exp_f32 v128, v128
    v_smfmac_f32_32x32x32_bf16 v[80:95], v[40:43], v[120:127], v52
    ds_read_b128 v[28:31], v3 offset:25088
    s_mov_b32 m0, s54
    v_exp_f32 v129, v129
    v_exp_f32 v130, v130
    v_exp_f32 v131, v131
    v_mfma_f32_32x32x4_2b_bf16 v[96:127], v[26:27], v[20:21], 0
    ds_read_b64 v[32:33], v9 offset:25088
    buffer_load_dwordx4 v5, s[12:15], s53 offen offset:0 lds
    v_exp_f32 v132, v132
    v_exp_f32 v133, v133
    v_exp_f32 v134, v134
    v_exp_f32 v135, v135
    v_exp_f32 v136, v136
    v_exp_f32 v137, v137
    v_exp_f32 v138, v138
    v_exp_f32 v139, v139
    v_smfmac_f32_32x32x32_bf16 v[64:79], v[44:47], v[128:135], v52
    ds_read_b128 v[36:39], v53 offset:0
    buffer_load_dwordx4 v5, s[12:15], s53 offen offset:1024 lds
    v_exp_f32 v140, v140
    v_exp_f32 v141, v141
    v_exp_f32 v142, v142
    v_exp_f32 v143, v143
    v_exp_f32 v144, v144
    v_exp_f32 v145, v145
    v_smfmac_f32_32x32x32_bf16 v[64:79], v[48:51], v[136:143], v52
    ds_read_b128 v[40:43], v53 offset:640
    buffer_load_dwordx4 v5, s[12:15], s53 offen offset:2048 lds
    v_exp_f32 v146, v146
    v_exp_f32 v147, v147
    v_exp_f32 v148, v148
    v_exp_f32 v149, v149
    v_mfma_f32_32x32x16_bf16 v[96:111], v[22:25], v[12:15], v[96:111]
    buffer_load_dwordx4 v5, s[12:15], s53 offen offset:3072 lds
    v_exp_f32 v150, v150
    v_exp_f32 v151, v151
    v_exp_f32 v152, v152
    v_exp_f32 v153, v153
    v_mfma_f32_32x32x16_bf16 v[112:127], v[22:25], v[16:19], v[112:127]
    s_add_u32 m0, s75, 0
    v_exp_f32 v154, v154
    v_exp_f32 v155, v155
    v_exp_f32 v156, v156
    v_exp_f32 v157, v157
    v_smfmac_f32_32x32x32_bf16 v[80:95], v[44:47], v[144:151], v52
    buffer_load_dwordx4 v191, s[64:67], s73 offen lds
    v_exp_f32 v158, v158
    v_exp_f32 v159, v159
    s_waitcnt lgkmcnt(0)
    s_setprio 2
    v_exp_f32 v96, v96
    v_smfmac_f32_32x32x32_bf16 v[80:95], v[48:51], v[152:159], v52
    ds_read_b128 v[22:25], v3 offset:25600
    v_exp_f32 v97, v97
    v_exp_f32 v98, v98
    v_exp_f32 v99, v99
    v_mfma_f32_32x32x4_2b_bf16 v[128:159], v[32:33], v[20:21], 0
    ds_read_b64 v[26:27], v9 offset:25600
    v_exp_f32 v100, v100
    v_exp_f32 v101, v101
    v_exp_f32 v102, v102
    v_exp_f32 v103, v103
    v_exp_f32 v104, v104
    v_exp_f32 v105, v105
    v_exp_f32 v106, v106
    v_exp_f32 v107, v107
    v_smfmac_f32_32x32x32_bf16 v[64:79], v[36:39], v[96:103], v52
    ds_read_b128 v[44:47], v53 offset:1280
    v_exp_f32 v108, v108
    v_exp_f32 v109, v109
    v_exp_f32 v110, v110
    v_exp_f32 v111, v111
    v_exp_f32 v112, v112
    v_exp_f32 v113, v113
    v_smfmac_f32_32x32x32_bf16 v[64:79], v[40:43], v[104:111], v52
    ds_read_b128 v[48:51], v53 offset:1920
    v_exp_f32 v114, v114
    v_exp_f32 v115, v115
    v_exp_f32 v116, v116
    v_exp_f32 v117, v117
    v_mfma_f32_32x32x16_bf16 v[128:143], v[28:31], v[12:15], v[128:143]
    s_setprio 1
    v_exp_f32 v118, v118
    v_exp_f32 v119, v119
    v_exp_f32 v120, v120
    v_exp_f32 v121, v121
    v_mfma_f32_32x32x16_bf16 v[144:159], v[28:31], v[16:19], v[144:159]
    s_add_u32 m0, s75, 1024
    v_exp_f32 v122, v122
    v_exp_f32 v123, v123
    v_exp_f32 v124, v124
    v_exp_f32 v125, v125
    v_smfmac_f32_32x32x32_bf16 v[80:95], v[36:39], v[112:119], v52
    buffer_load_dwordx4 v191, s[64:67], s74 offen lds
    v_exp_f32 v126, v126
    v_exp_f32 v127, v127
    s_waitcnt lgkmcnt(0)
    v_exp_f32 v128, v128
    v_smfmac_f32_32x32x32_bf16 v[80:95], v[40:43], v[120:127], v52
    ds_read_b128 v[28:31], v3 offset:26112
    v_exp_f32 v129, v129
    v_exp_f32 v130, v130
    v_exp_f32 v131, v131
    v_mfma_f32_32x32x4_2b_bf16 v[96:127], v[26:27], v[20:21], 0
    ds_read_b64 v[32:33], v9 offset:26112
    v_exp_f32 v132, v132
    v_exp_f32 v133, v133
    v_exp_f32 v134, v134
    v_exp_f32 v135, v135
    v_exp_f32 v136, v136
    v_exp_f32 v137, v137
    v_exp_f32 v138, v138
    v_exp_f32 v139, v139
    v_smfmac_f32_32x32x32_bf16 v[64:79], v[44:47], v[128:135], v52
    ds_read_b128 v[36:39], v53 offset:2560
    v_exp_f32 v140, v140
    v_exp_f32 v141, v141
    v_exp_f32 v142, v142
    v_exp_f32 v143, v143
    v_exp_f32 v144, v144
    v_exp_f32 v145, v145
    v_smfmac_f32_32x32x32_bf16 v[64:79], v[48:51], v[136:143], v52
    ds_read_b128 v[40:43], v53 offset:3200
    v_exp_f32 v146, v146
    v_exp_f32 v147, v147
    v_exp_f32 v148, v148
    v_exp_f32 v149, v149
    v_mfma_f32_32x32x16_bf16 v[96:111], v[22:25], v[12:15], v[96:111]
    s_setprio 0
    v_exp_f32 v150, v150
    v_exp_f32 v151, v151
    v_exp_f32 v152, v152
    v_exp_f32 v153, v153
    v_mfma_f32_32x32x16_bf16 v[112:127], v[22:25], v[16:19], v[112:127]
    s_add_u32 m0, s75, 2048
    v_exp_f32 v154, v154
    v_exp_f32 v155, v155
    v_exp_f32 v156, v156
    v_exp_f32 v157, v157
    v_smfmac_f32_32x32x32_bf16 v[80:95], v[44:47], v[144:151], v52
    buffer_load_dwordx4 v191, s[64:67], s76 offen lds
    v_exp_f32 v158, v158
    v_exp_f32 v159, v159
    s_waitcnt vmcnt(10) lgkmcnt(0)
    s_barrier
    s_setprio 3
    v_exp_f32 v96, v96
    v_smfmac_f32_32x32x32_bf16 v[80:95], v[48:51], v[152:159], v52
    ds_read_b128 v[22:25], v2 offset:0
    v_exp_f32 v97, v97
    v_exp_f32 v98, v98
    v_exp_f32 v99, v99
    v_mfma_f32_32x32x4_2b_bf16 v[128:159], v[32:33], v[20:21], 0
    ds_read_b64 v[26:27], v8 offset:0
    v_exp_f32 v100, v100
    v_exp_f32 v101, v101
    v_exp_f32 v102, v102
    v_exp_f32 v103, v103
    v_exp_f32 v104, v104
    v_exp_f32 v105, v105
    v_exp_f32 v106, v106
    v_exp_f32 v107, v107
    v_smfmac_f32_32x32x32_bf16 v[64:79], v[36:39], v[96:103], v52
    ds_read_b128 v[44:47], v53 offset:3840
    s_mov_b64 exec, 1
    buffer_store_dword v59, v60, s[12:15], s83 offen sc0 sc1
    s_mov_b64 exec, -1
    v_exp_f32 v108, v108
    v_exp_f32 v109, v109
    v_exp_f32 v110, v110
    v_exp_f32 v111, v111
    v_exp_f32 v112, v112
    v_exp_f32 v113, v113
    v_smfmac_f32_32x32x32_bf16 v[64:79], v[40:43], v[104:111], v52
    ds_read_b128 v[48:51], v53 offset:4480
    s_add_u32 m0, s50, 49152
    s_add_u32 s52, s52, s49
    v_exp_f32 v114, v114
    v_exp_f32 v115, v115
    v_exp_f32 v116, v116
    v_exp_f32 v117, v117
    v_mfma_f32_32x32x16_bf16 v[128:143], v[28:31], v[12:15], v[128:143]
    buffer_load_dwordx4 v54, s[12:15], s52 offen offset:0 lds
    v_exp_f32 v118, v118
    v_exp_f32 v119, v119
    v_exp_f32 v120, v120
    v_exp_f32 v121, v121
    v_mfma_f32_32x32x16_bf16 v[144:159], v[28:31], v[16:19], v[144:159]
    buffer_load_dwordx4 v55, s[12:15], s52 offen offset:1024 lds
    v_exp_f32 v122, v122
    v_exp_f32 v123, v123
    v_exp_f32 v124, v124
    v_exp_f32 v125, v125
    v_smfmac_f32_32x32x32_bf16 v[80:95], v[36:39], v[112:119], v52
    buffer_load_dwordx4 v56, s[12:15], s52 offen offset:2048 lds
    v_exp_f32 v126, v126
    v_exp_f32 v127, v127
    s_waitcnt lgkmcnt(0)
    v_exp_f32 v128, v128
    v_smfmac_f32_32x32x32_bf16 v[80:95], v[40:43], v[120:127], v52
    ds_read_b128 v[28:31], v2 offset:512
    v_exp_f32 v129, v129
    v_exp_f32 v130, v130
    v_exp_f32 v131, v131
    v_mfma_f32_32x32x4_2b_bf16 v[96:127], v[26:27], v[20:21], 0
    ds_read_b64 v[32:33], v8 offset:512
    v_exp_f32 v132, v132
    v_exp_f32 v133, v133
    v_exp_f32 v134, v134
    v_exp_f32 v135, v135
    v_exp_f32 v136, v136
    v_exp_f32 v137, v137
    v_exp_f32 v138, v138
    v_exp_f32 v139, v139
    v_smfmac_f32_32x32x32_bf16 v[64:79], v[44:47], v[128:135], v52
    ds_read_b128 v[36:39], v4 offset:0
    v_exp_f32 v140, v140
    v_exp_f32 v141, v141
    v_exp_f32 v142, v142
    v_exp_f32 v143, v143
    v_exp_f32 v144, v144
    v_exp_f32 v145, v145
    v_smfmac_f32_32x32x32_bf16 v[64:79], v[48:51], v[136:143], v52
    ds_read_b128 v[40:43], v4 offset:640
    v_exp_f32 v146, v146
    v_exp_f32 v147, v147
    v_exp_f32 v148, v148
    v_exp_f32 v149, v149
    v_mfma_f32_32x32x16_bf16 v[96:111], v[22:25], v[12:15], v[96:111]
    buffer_store_dwordx4 v[248:251], v5, s[12:15], s81 offen sc0 sc1
    v_exp_f32 v150, v150
    v_exp_f32 v151, v151
    v_exp_f32 v152, v152
    v_exp_f32 v153, v153
    v_mfma_f32_32x32x16_bf16 v[112:127], v[22:25], v[16:19], v[112:127]
    v_exp_f32 v154, v154
    v_exp_f32 v155, v155
    v_exp_f32 v156, v156
    v_exp_f32 v157, v157
    v_smfmac_f32_32x32x32_bf16 v[80:95], v[44:47], v[144:151], v52
    s_cmp_lt_u32 s18, 5
    s_cbranch_scc1 L_npf
    s_cmp_eq_u32 s18, 7
    s_cbranch_scc1 L_npf
    buffer_load_dword v247, v246, s[8:11], 0 offen
    buffer_load_dword v247, v246, s[8:11], 0 offen offset:128
L_npf:
    v_exp_f32 v158, v158
    v_exp_f32 v159, v159
    s_waitcnt lgkmcnt(0)
    s_setprio 2
    v_exp_f32 v96, v96
    v_smfmac_f32_32x32x32_bf16 v[80:95], v[48:51], v[152:159], v52
    ds_read_b128 v[22:25], v2 offset:1024
    v_exp_f32 v97, v97
    v_exp_f32 v98, v98
    v_exp_f32 v99, v99
    v_mfma_f32_32x32x4_2b_bf16 v[128:159], v[32:33], v[20:21], 0
    ds_read_b64 v[26:27], v8 offset:1024
    v_exp_f32 v100, v100
    v_exp_f32 v101, v101
    v_exp_f32 v102, v102
    v_exp_f32 v103, v103
    v_exp_f32 v104, v104
    v_exp_f32 v105, v105
    v_exp_f32 v106, v106
    v_exp_f32 v107, v107
    v_smfmac_f32_32x32x32_bf16 v[64:79], v[36:39], v[96:103], v52
    ds_read_b128 v[44:47], v4 offset:1280
    v_exp_f32 v108, v108
    v_exp_f32 v109, v109
    v_exp_f32 v110, v110
    v_exp_f32 v111, v111
    v_exp_f32 v112, v112
    v_exp_f32 v113, v113
    v_smfmac_f32_32x32x32_bf16 v[64:79], v[40:43], v[104:111], v52
    ds_read_b128 v[48:51], v4 offset:1920
    v_exp_f32 v114, v114
    v_exp_f32 v115, v115
    v_exp_f32 v116, v116
    v_exp_f32 v117, v117
    v_mfma_f32_32x32x16_bf16 v[128:143], v[28:31], v[12:15], v[128:143]
    s_setprio 1
    buffer_store_dwordx4 v[248:251], v5, s[12:15], s80 offen sc0 sc1
    v_exp_f32 v118, v118
    v_exp_f32 v119, v119
    v_exp_f32 v120, v120
    v_exp_f32 v121, v121
    v_mfma_f32_32x32x16_bf16 v[144:159], v[28:31], v[16:19], v[144:159]
    v_exp_f32 v122, v122
    v_exp_f32 v123, v123
    v_exp_f32 v124, v124
    v_exp_f32 v125, v125
    v_smfmac_f32_32x32x32_bf16 v[80:95], v[36:39], v[112:119], v52
    v_exp_f32 v126, v126
    v_exp_f32 v127, v127
    s_waitcnt lgkmcnt(0)
    v_exp_f32 v128, v128
    v_smfmac_f32_32x32x32_bf16 v[80:95], v[40:43], v[120:127], v52
    ds_read_b128 v[28:31], v2 offset:1536
    v_exp_f32 v129, v129
    v_exp_f32 v130, v130
    v_exp_f32 v131, v131
    v_mfma_f32_32x32x4_2b_bf16 v[96:127], v[26:27], v[20:21], 0
    ds_read_b64 v[32:33], v8 offset:1536
    v_exp_f32 v132, v132
    v_exp_f32 v133, v133
    v_exp_f32 v134, v134
    v_exp_f32 v135, v135
    v_exp_f32 v136, v136
    v_exp_f32 v137, v137
    v_exp_f32 v138, v138
    v_exp_f32 v139, v139
    v_smfmac_f32_32x32x32_bf16 v[64:79], v[44:47], v[128:135], v52
    ds_read_b128 v[36:39], v4 offset:2560
    v_exp_f32 v140, v140
    v_exp_f32 v141, v141
    v_exp_f32 v142, v142
    v_exp_f32 v143, v143
    v_exp_f32 v144, v144
    v_exp_f32 v145, v145
    v_smfmac_f32_32x32x32_bf16 v[64:79], v[48:51], v[136:143], v52
    ds_read_b128 v[40:43], v4 offset:3200
    v_exp_f32 v146, v146
    v_exp_f32 v147, v147
    v_exp_f32 v148, v148
    v_exp_f32 v149, v149
    v_mfma_f32_32x32x16_bf16 v[96:111], v[22:25], v[12:15], v[96:111]
    s_setprio 0
    buffer_store_dwordx4 v[248:251], v5, s[12:15], s80 offen offset:1024 sc0 sc1
    v_exp_f32 v150, v150
    v_exp_f32 v151, v151
    v_exp_f32 v152, v152
    v_exp_f32 v153, v153
    v_mfma_f32_32x32x16_bf16 v[112:127], v[22:25], v[16:19], v[112:127]
    v_exp_f32 v154, v154
    v_exp_f32 v155, v155
    v_exp_f32 v156, v156
    v_exp_f32 v157, v157
    v_smfmac_f32_32x32x32_bf16 v[80:95], v[44:47], v[144:151], v52
    v_exp_f32 v158, v158
    v_exp_f32 v159, v159
    s_waitcnt vmcnt(7) lgkmcnt(0)
    s_barrier
    s_setprio 3
    v_exp_f32 v96, v96
    v_smfmac_f32_32x32x32_bf16 v[80:95], v[48:51], v[152:159], v52
    ds_read_b64_tr_b16 v[232:233], v196 offset:0
    ds_read_b128 v[22:25], v2 offset:24576
    v_exp_f32 v97, v97
    v_exp_f32 v98, v98
    v_exp_f32 v99, v99
    v_mfma_f32_32x32x4_2b_bf16 v[128:159], v[32:33], v[20:21], 0
    ds_read_b64_tr_b16 v[234:235], v196 offset:512
    ds_read_b64 v[26:27], v8 offset:24576
    v_exp_f32 v100, v100
    v_exp_f32 v101, v101
    v_exp_f32 v102, v102
    v_exp_f32 v103, v103
    v_exp_f32 v104, v104
    v_exp_f32 v105, v105
    v_exp_f32 v106, v106
    v_exp_f32 v107, v107
    v_smfmac_f32_32x32x32_bf16 v[64:79], v[36:39], v[96:103], v52
    ds_read_b64_tr_b16 v[236:237], v196 offset:1024
    ds_read_b128 v[44:47], v4 offset:3840
    v_exp_f32 v108, v108
    v_exp_f32 v109, v109
    v_exp_f32 v110, v110
    v_exp_f32 v111, v111
    v_exp_f32 v112, v112
    v_exp_f32 v113, v113
    v_smfmac_f32_32x32x32_bf16 v[64:79], v[40:43], v[104:111], v52
    ds_read_b64_tr_b16 v[238:239], v196 offset:1536
    ds_read_b128 v[48:51], v4 offset:4480
    s_add_u32 m0, s50, 73728
    s_add_u32 s52, s52, s49
    v_exp_f32 v114, v114
    v_exp_f32 v115, v115
    v_exp_f32 v116, v116
    v_exp_f32 v117, v117
    v_mfma_f32_32x32x16_bf16 v[128:143], v[28:31], v[12:15], v[128:143]
    ds_read_b64_tr_b16 v[240:241], v196 offset:2048
    buffer_load_dwordx4 v54, s[12:15], s52 offen offset:0 lds
    v_exp_f32 v118, v118
    v_exp_f32 v119, v119
    v_exp_f32 v120, v120
    v_exp_f32 v121, v121
    v_mfma_f32_32x32x16_bf16 v[144:159], v[28:31], v[16:19], v[144:159]
    ds_read_b64_tr_b16 v[242:243], v196 offset:2560
    buffer_load_dwordx4 v55, s[12:15], s52 offen offset:1024 lds
    v_exp_f32 v122, v122
    v_exp_f32 v123, v123
    v_exp_f32 v124, v124
    v_exp_f32 v125, v125
    v_smfmac_f32_32x32x32_bf16 v[80:95], v[36:39], v[112:119], v52
    buffer_load_dwordx4 v56, s[12:15], s52 offen offset:2048 lds
    v_exp_f32 v126, v126
    v_exp_f32 v127, v127
    s_waitcnt lgkmcnt(0)
    v_exp_f32 v128, v128
    v_smfmac_f32_32x32x32_bf16 v[80:95], v[40:43], v[120:127], v52
    ds_read_b128 v[28:31], v2 offset:25088
    s_mov_b32 s26, 16809984
    buffer_load_dwordx4 v[212:215], v5, s[12:15], s26 offen sc1
    s_mov_b32 s33, 32768
    v_exp_f32 v129, v129
    v_exp_f32 v130, v130
    v_exp_f32 v131, v131
    v_mfma_f32_32x32x4_2b_bf16 v[96:127], v[26:27], v[20:21], 0
    ds_read_b64 v[32:33], v8 offset:25088
    v_exp_f32 v132, v132
    v_exp_f32 v133, v133
    v_exp_f32 v134, v134
    v_exp_f32 v135, v135
    v_exp_f32 v136, v136
    v_exp_f32 v137, v137
    v_exp_f32 v138, v138
    v_exp_f32 v139, v139
    v_smfmac_f32_32x32x32_bf16 v[64:79], v[44:47], v[128:135], v52
    ds_read_b128 v[36:39], v10 offset:0
    v_exp_f32 v140, v140
    v_exp_f32 v141, v141
    v_exp_f32 v142, v142
    v_exp_f32 v143, v143
    v_exp_f32 v144, v144
    v_exp_f32 v145, v145
    v_smfmac_f32_32x32x32_bf16 v[64:79], v[48:51], v[136:143], v52
    ds_read_b128 v[40:43], v10 offset:640
    v_exp_f32 v146, v146
    v_exp_f32 v147, v147
    v_exp_f32 v148, v148
    v_exp_f32 v149, v149
    v_mfma_f32_32x32x16_bf16 v[96:111], v[22:25], v[12:15], v[96:111]
    buffer_store_dwordx4 v[232:235], v254, s[12:15], s77 offen offset:0 sc0 sc1
    v_exp_f32 v150, v150
    v_exp_f32 v151, v151
    v_exp_f32 v152, v152
    v_exp_f32 v153, v153
    v_mfma_f32_32x32x16_bf16 v[112:127], v[22:25], v[16:19], v[112:127]
    v_exp_f32 v154, v154
    v_exp_f32 v155, v155
    v_exp_f32 v156, v156
    v_exp_f32 v157, v157
    v_smfmac_f32_32x32x32_bf16 v[80:95], v[44:47], v[144:151], v52
    v_exp_f32 v158, v158
    v_exp_f32 v159, v159
    s_waitcnt lgkmcnt(0)
    s_setprio 2
    v_exp_f32 v96, v96
    v_smfmac_f32_32x32x32_bf16 v[80:95], v[48:51], v[152:159], v52
    ds_read_b128 v[22:25], v2 offset:25600
    v_exp_f32 v97, v97
    v_exp_f32 v98, v98
    v_exp_f32 v99, v99
    v_mfma_f32_32x32x4_2b_bf16 v[128:159], v[32:33], v[20:21], 0
    ds_read_b64 v[26:27], v8 offset:25600
    v_exp_f32 v100, v100
    v_exp_f32 v101, v101
    v_exp_f32 v102, v102
    v_exp_f32 v103, v103
    v_exp_f32 v104, v104
    v_exp_f32 v105, v105
    v_exp_f32 v106, v106
    v_exp_f32 v107, v107
    v_smfmac_f32_32x32x32_bf16 v[64:79], v[36:39], v[96:103], v52
    ds_read_b128 v[44:47], v10 offset:1280
    v_exp_f32 v108, v108
    v_exp_f32 v109, v109
    v_exp_f32 v110, v110
    v_exp_f32 v111, v111
    v_exp_f32 v112, v112
    v_exp_f32 v113, v113
    v_smfmac_f32_32x32x32_bf16 v[64:79], v[40:43], v[104:111], v52
    ds_read_b128 v[48:51], v10 offset:1920
    v_exp_f32 v114, v114
    v_exp_f32 v115, v115
    v_exp_f32 v116, v116
    v_exp_f32 v117, v117
    v_mfma_f32_32x32x16_bf16 v[128:143], v[28:31], v[12:15], v[128:143]
    s_setprio 1
    buffer_store_dwordx4 v[236:239], v254, s[12:15], s77 offen offset:256 sc0 sc1
    v_exp_f32 v118, v118
    v_exp_f32 v119, v119
    v_exp_f32 v120, v120
    v_exp_f32 v121, v121
    v_mfma_f32_32x32x16_bf16 v[144:159], v[28:31], v[16:19], v[144:159]
    v_exp_f32 v122, v122
    v_exp_f32 v123, v123
    v_exp_f32 v124, v124
    v_exp_f32 v125, v125
    v_smfmac_f32_32x32x32_bf16 v[80:95], v[36:39], v[112:119], v52
    v_exp_f32 v126, v126
    v_exp_f32 v127, v127
    s_waitcnt vmcnt(2) lgkmcnt(0)
    v_exp_f32 v128, v128
    v_smfmac_f32_32x32x32_bf16 v[80:95], v[40:43], v[120:127], v52
    ds_read_b128 v[28:31], v2 offset:26112
L_f1:
    v_xor_b32 v212, s55, v212
    v_xor_b32 v213, s55, v213
    v_xor_b32 v214, s55, v214
    v_xor_b32 v215, s55, v215
    v_or3_b32 v212, v212, v213, v214
    v_or_b32 v212, v212, v215
    v_cmp_ne_u32 vcc, 0, v212
    s_cbranch_vccnz L_f1r
L_f1d:
    v_exp_f32 v129, v129
    v_exp_f32 v130, v130
    v_exp_f32 v131, v131
    v_mfma_f32_32x32x4_2b_bf16 v[96:127], v[26:27], v[20:21], 0
    ds_read_b64 v[32:33], v8 offset:26112
    v_exp_f32 v132, v132
    v_exp_f32 v133, v133
    v_exp_f32 v134, v134
    v_exp_f32 v135, v135
    v_exp_f32 v136, v136
    v_exp_f32 v137, v137
    v_exp_f32 v138, v138
    v_exp_f32 v139, v139
    v_smfmac_f32_32x32x32_bf16 v[64:79], v[44:47], v[128:135], v52
    ds_read_b128 v[36:39], v10 offset:2560
    buffer_load_dwordx4 v[184:187], v5, s[12:15], s44 offen
    buffer_load_dwordx4 v[188:191], v61, s[12:15], s44 offen
    s_add_u32 s44, s44, s46
    v_exp_f32 v140, v140
    v_exp_f32 v141, v141
    v_exp_f32 v142, v142
    v_exp_f32 v143, v143
    v_exp_f32 v144, v144
    v_exp_f32 v145, v145
    v_smfmac_f32_32x32x32_bf16 v[64:79], v[48:51], v[136:143], v52
    ds_read_b128 v[40:43], v10 offset:3200
    v_exp_f32 v146, v146
    v_exp_f32 v147, v147
    v_exp_f32 v148, v148
    v_exp_f32 v149, v149
    v_mfma_f32_32x32x16_bf16 v[96:111], v[22:25], v[12:15], v[96:111]
    s_setprio 0
    buffer_store_dwordx4 v[240:243], v254, s[12:15], s77 offen offset:512 sc0 sc1
    v_exp_f32 v150, v150
    v_exp_f32 v151, v151
    v_exp_f32 v152, v152
    v_exp_f32 v153, v153
    v_mfma_f32_32x32x16_bf16 v[112:127], v[22:25], v[16:19], v[112:127]
    v_exp_f32 v154, v154
    v_exp_f32 v155, v155
    v_exp_f32 v156, v156
    v_exp_f32 v157, v157
    v_smfmac_f32_32x32x32_bf16 v[80:95], v[44:47], v[144:151], v52
    v_exp_f32 v158, v158
    v_exp_f32 v159, v159
    s_waitcnt vmcnt(5) lgkmcnt(0)
    s_barrier
    s_setprio 3
    v_exp_f32 v96, v96
    v_smfmac_f32_32x32x32_bf16 v[80:95], v[48:51], v[152:159], v52
    ds_read_b128 v[22:25], v3 offset:0
    v_exp_f32 v97, v97
    v_exp_f32 v98, v98
    v_exp_f32 v99, v99
    v_mfma_f32_32x32x4_2b_bf16 v[128:159], v[32:33], v[20:21], 0
    ds_read_b64 v[26:27], v9 offset:0
    buffer_load_dwordx4 v[192:195], v5, s[12:15], s44 offen
    buffer_load_dwordx4 v[196:199], v61, s[12:15], s44 offen
    s_add_u32 s44, s44, s47
    v_exp_f32 v100, v100
    v_exp_f32 v101, v101
    v_exp_f32 v102, v102
    v_exp_f32 v103, v103
    v_exp_f32 v104, v104
    v_exp_f32 v105, v105
    v_exp_f32 v106, v106
    v_exp_f32 v107, v107
    v_smfmac_f32_32x32x32_bf16 v[64:79], v[36:39], v[96:103], v52
    ds_read_b128 v[44:47], v10 offset:3840
    s_cmp_lg_u32 s18, 4
    s_cbranch_scc1 L_nct
    s_mov_b64 exec, 0xff
    global_load_dword v252, v[252:253], off
    s_mov_b64 exec, -1
L_nct:
    v_exp_f32 v108, v108
    v_exp_f32 v109, v109
    v_exp_f32 v110, v110
    v_exp_f32 v111, v111
    v_exp_f32 v112, v112
    v_exp_f32 v113, v113
    v_smfmac_f32_32x32x32_bf16 v[64:79], v[40:43], v[104:111], v52
    ds_read_b128 v[48:51], v10 offset:4480
    s_add_u32 m0, s50, 0
    s_add_u32 s52, s79, 0
    v_exp_f32 v114, v114
    v_exp_f32 v115, v115
    v_exp_f32 v116, v116
    v_exp_f32 v117, v117
    v_mfma_f32_32x32x16_bf16 v[128:143], v[28:31], v[12:15], v[128:143]
    buffer_load_dwordx4 v5, s[12:15], s52 offen offset:0 lds
    v_exp_f32 v118, v118
    v_exp_f32 v119, v119
    v_exp_f32 v120, v120
    v_exp_f32 v121, v121
    v_mfma_f32_32x32x16_bf16 v[144:159], v[28:31], v[16:19], v[144:159]
    buffer_load_dwordx4 v5, s[12:15], s52 offen offset:1024 lds
    v_exp_f32 v122, v122
    v_exp_f32 v123, v123
    v_exp_f32 v124, v124
    v_exp_f32 v125, v125
    v_smfmac_f32_32x32x32_bf16 v[80:95], v[36:39], v[112:119], v52
    buffer_load_dwordx4 v5, s[12:15], s52 offen offset:2048 lds
    v_exp_f32 v126, v126
    v_exp_f32 v127, v127
    s_waitcnt lgkmcnt(0)
    v_exp_f32 v128, v128
    v_smfmac_f32_32x32x32_bf16 v[80:95], v[40:43], v[120:127], v52
    ds_read_b128 v[28:31], v3 offset:512
    v_exp_f32 v129, v129
    v_exp_f32 v130, v130
    v_exp_f32 v131, v131
    v_mfma_f32_32x32x4_2b_bf16 v[96:127], v[26:27], v[20:21], 0
    ds_read_b64 v[32:33], v9 offset:512
    buffer_load_dwordx4 v[200:203], v5, s[12:15], s44 offen
    buffer_load_dwordx4 v[204:207], v61, s[12:15], s44 offen
    s_add_u32 s44, s44, s46
    v_exp_f32 v132, v132
    v_exp_f32 v133, v133
    v_exp_f32 v134, v134
    v_exp_f32 v135, v135
    v_exp_f32 v136, v136
    v_exp_f32 v137, v137
    v_exp_f32 v138, v138
    v_exp_f32 v139, v139
    v_smfmac_f32_32x32x32_bf16 v[64:79], v[44:47], v[128:135], v52
    ds_read_b128 v[36:39], v11 offset:0
    v_exp_f32 v140, v140
    v_exp_f32 v141, v141
    v_exp_f32 v142, v142
    v_exp_f32 v143, v143
    v_exp_f32 v144, v144
    v_exp_f32 v145, v145
    v_smfmac_f32_32x32x32_bf16 v[64:79], v[48:51], v[136:143], v52
    ds_read_b128 v[40:43], v11 offset:640
    v_exp_f32 v146, v146
    v_exp_f32 v147, v147
    v_exp_f32 v148, v148
    v_exp_f32 v149, v149
    v_mfma_f32_32x32x16_bf16 v[96:111], v[22:25], v[12:15], v[96:111]
    buffer_load_dwordx4 v[208:211], v5, s[12:15], s44 offen
    buffer_load_dwordx4 v[212:215], v61, s[12:15], s44 offen
    s_add_u32 s44, s44, s47
    v_exp_f32 v150, v150
    v_exp_f32 v151, v151
    v_exp_f32 v152, v152
    v_exp_f32 v153, v153
    v_mfma_f32_32x32x16_bf16 v[112:127], v[22:25], v[16:19], v[112:127]
    v_exp_f32 v154, v154
    v_exp_f32 v155, v155
    v_exp_f32 v156, v156
    v_exp_f32 v157, v157
    v_smfmac_f32_32x32x32_bf16 v[80:95], v[44:47], v[144:151], v52
    s_cmp_lt_u32 s18, 4
    s_cbranch_scc1 L_ns2
    s_add_u32 s27, s59, 13500416
    s_mov_b64 exec, 0xffff
    buffer_store_dwordx4 v[248:251], v5, s[12:15], s27 offen
    s_mov_b64 exec, -1
L_ns2:
    v_exp_f32 v158, v158
    v_exp_f32 v159, v159
    s_waitcnt lgkmcnt(0)
    s_setprio 2
    v_exp_f32 v96, v96
    v_smfmac_f32_32x32x32_bf16 v[80:95], v[48:51], v[152:159], v52
    ds_read_b128 v[22:25], v3 offset:1024
    v_exp_f32 v97, v97
    v_exp_f32 v98, v98
    v_exp_f32 v99, v99
    v_mfma_f32_32x32x4_2b_bf16 v[128:159], v[32:33], v[20:21], 0
    ds_read_b64 v[26:27], v9 offset:1024
    v_exp_f32 v100, v100
    v_exp_f32 v101, v101
    v_exp_f32 v102, v102
    v_exp_f32 v103, v103
    v_exp_f32 v104, v104
    v_exp_f32 v105, v105
    v_exp_f32 v106, v106
    v_exp_f32 v107, v107
    v_smfmac_f32_32x32x32_bf16 v[64:79], v[36:39], v[96:103], v52
    ds_read_b128 v[44:47], v11 offset:1280
    buffer_load_dwordx4 v[216:219], v5, s[12:15], s44 offen
    buffer_load_dwordx4 v[220:223], v61, s[12:15], s44 offen
    s_add_u32 s44, s44, s46
    v_exp_f32 v108, v108
    v_exp_f32 v109, v109
    v_exp_f32 v110, v110
    v_exp_f32 v111, v111
    v_exp_f32 v112, v112
    v_exp_f32 v113, v113
    v_smfmac_f32_32x32x32_bf16 v[64:79], v[40:43], v[104:111], v52
    ds_read_b128 v[48:51], v11 offset:1920
    v_exp_f32 v114, v114
    v_exp_f32 v115, v115
    v_exp_f32 v116, v116
    v_exp_f32 v117, v117
    v_mfma_f32_32x32x16_bf16 v[128:143], v[28:31], v[12:15], v[128:143]
    s_setprio 1
    v_exp_f32 v118, v118
    v_exp_f32 v119, v119
    v_exp_f32 v120, v120
    v_exp_f32 v121, v121
    v_mfma_f32_32x32x16_bf16 v[144:159], v[28:31], v[16:19], v[144:159]
    s_cmp_lg_u32 s20, 0
    s_cbranch_scc1 L_nx0
    s_add_u32 s27, s45, 25600
    buffer_load_dwordx4 v[176:179], v5, s[12:15], s27 offen
    buffer_load_dwordx4 v[180:183], v61, s[12:15], s27 offen
L_nx0:
    v_exp_f32 v122, v122
    v_exp_f32 v123, v123
    v_exp_f32 v124, v124
    v_exp_f32 v125, v125
    v_smfmac_f32_32x32x32_bf16 v[80:95], v[36:39], v[112:119], v52
    v_exp_f32 v126, v126
    v_exp_f32 v127, v127
    s_waitcnt lgkmcnt(0)
    v_exp_f32 v128, v128
    v_smfmac_f32_32x32x32_bf16 v[80:95], v[40:43], v[120:127], v52
    ds_read_b128 v[28:31], v3 offset:1536
    v_exp_f32 v129, v129
    v_exp_f32 v130, v130
    v_exp_f32 v131, v131
    v_mfma_f32_32x32x4_2b_bf16 v[96:127], v[26:27], v[20:21], 0
    ds_read_b64 v[32:33], v9 offset:1536
    v_exp_f32 v132, v132
    v_exp_f32 v133, v133
    v_exp_f32 v134, v134
    v_exp_f32 v135, v135
    v_exp_f32 v136, v136
    v_exp_f32 v137, v137
    v_exp_f32 v138, v138
    v_exp_f32 v139, v139
    v_smfmac_f32_32x32x32_bf16 v[64:79], v[44:47], v[128:135], v52
    ds_read_b128 v[36:39], v11 offset:2560
    buffer_load_dwordx4 v[224:227], v5, s[12:15], s44 offen
    buffer_load_dwordx4 v[228:231], v61, s[12:15], s44 offen
    s_add_u32 s44, s44, s47
    v_exp_f32 v140, v140
    v_exp_f32 v141, v141
    v_exp_f32 v142, v142
    v_exp_f32 v143, v143
    v_exp_f32 v144, v144
    v_exp_f32 v145, v145
    v_smfmac_f32_32x32x32_bf16 v[64:79], v[48:51], v[136:143], v52
    ds_read_b128 v[40:43], v11 offset:3200
    v_exp_f32 v146, v146
    v_exp_f32 v147, v147
    v_exp_f32 v148, v148
    v_exp_f32 v149, v149
    v_mfma_f32_32x32x16_bf16 v[96:111], v[22:25], v[12:15], v[96:111]
    s_setprio 0
    v_exp_f32 v150, v150
    v_exp_f32 v151, v151
    v_exp_f32 v152, v152
    v_exp_f32 v153, v153
    v_mfma_f32_32x32x16_bf16 v[112:127], v[22:25], v[16:19], v[112:127]
    s_cmp_lg_u32 s20, 0
    s_cbranch_scc1 L_nx1
    s_add_u32 s27, s45, 24576
    buffer_load_dwordx4 v[168:171], v5, s[12:15], s27 offen
    buffer_load_dwordx4 v[172:175], v61, s[12:15], s27 offen
L_nx1:
    v_exp_f32 v154, v154
    v_exp_f32 v155, v155
    v_exp_f32 v156, v156
    v_exp_f32 v157, v157
    v_smfmac_f32_32x32x32_bf16 v[80:95], v[44:47], v[144:151], v52
    v_exp_f32 v158, v158
    v_exp_f32 v159, v159
    s_waitcnt vmcnt(13) lgkmcnt(0)
    s_barrier
    s_setprio 3
    v_exp_f32 v96, v96
    v_smfmac_f32_32x32x32_bf16 v[80:95], v[48:51], v[152:159], v52
    ds_read_b128 v[22:25], v3 offset:24576
    v_exp_f32 v97, v97
    v_exp_f32 v98, v98
    v_exp_f32 v99, v99
    v_mfma_f32_32x32x4_2b_bf16 v[128:159], v[32:33], v[20:21], 0
    ds_read_b64 v[26:27], v9 offset:24576
    buffer_load_dwordx4 v[232:235], v5, s[12:15], s44 offen
    buffer_load_dwordx4 v[236:239], v61, s[12:15], s44 offen
    s_add_u32 s44, s44, s46
    v_exp_f32 v100, v100
    v_exp_f32 v101, v101
    v_exp_f32 v102, v102
    v_exp_f32 v103, v103
    v_exp_f32 v104, v104
    v_exp_f32 v105, v105
    v_exp_f32 v106, v106
    v_exp_f32 v107, v107
    v_smfmac_f32_32x32x32_bf16 v[64:79], v[36:39], v[96:103], v52
    ds_read_b128 v[44:47], v11 offset:3840
    s_mov_b64 exec, 1
    buffer_store_dword v59, v60, s[12:15], s83 offen offset:1024 sc0 sc1
    s_mov_b64 exec, -1
    v_exp_f32 v108, v108
    v_exp_f32 v109, v109
    v_exp_f32 v110, v110
    v_exp_f32 v111, v111
    v_exp_f32 v112, v112
    v_exp_f32 v113, v113
    v_smfmac_f32_32x32x32_bf16 v[64:79], v[40:43], v[104:111], v52
    ds_read_b128 v[48:51], v11 offset:4480
    s_add_u32 m0, s50, 24576
    s_add_u32 s52, s79, 24576
    v_exp_f32 v114, v114
    v_exp_f32 v115, v115
    v_exp_f32 v116, v116
    v_exp_f32 v117, v117
    v_mfma_f32_32x32x16_bf16 v[128:143], v[28:31], v[12:15], v[128:143]
    buffer_load_dwordx4 v5, s[12:15], s52 offen offset:0 lds
    v_exp_f32 v118, v118
    v_exp_f32 v119, v119
    v_exp_f32 v120, v120
    v_exp_f32 v121, v121
    v_mfma_f32_32x32x16_bf16 v[144:159], v[28:31], v[16:19], v[144:159]
    buffer_load_dwordx4 v5, s[12:15], s52 offen offset:1024 lds
    v_exp_f32 v122, v122
    v_exp_f32 v123, v123
    v_exp_f32 v124, v124
    v_exp_f32 v125, v125
    v_smfmac_f32_32x32x32_bf16 v[80:95], v[36:39], v[112:119], v52
    buffer_load_dwordx4 v5, s[12:15], s52 offen offset:2048 lds
    v_exp_f32 v126, v126
    v_exp_f32 v127, v127
    s_waitcnt lgkmcnt(0)
    v_exp_f32 v128, v128
    v_smfmac_f32_32x32x32_bf16 v[80:95], v[40:43], v[120:127], v52
    ds_read_b128 v[28:31], v3 offset:25088
    v_exp_f32 v129, v129
    v_exp_f32 v130, v130
    v_exp_f32 v131, v131
    v_mfma_f32_32x32x4_2b_bf16 v[96:127], v[26:27], v[20:21], 0
    ds_read_b64 v[32:33], v9 offset:25088
    v_exp_f32 v132, v132
    v_exp_f32 v133, v133
    v_exp_f32 v134, v134
    v_exp_f32 v135, v135
    v_exp_f32 v136, v136
    v_exp_f32 v137, v137
    v_exp_f32 v138, v138
    v_exp_f32 v139, v139
    v_smfmac_f32_32x32x32_bf16 v[64:79], v[44:47], v[128:135], v52
    ds_read_b128 v[36:39], v53 offset:0
    buffer_load_dwordx4 v[240:243], v5, s[12:15], s44 offen
    buffer_load_dwordx4 v[244:247], v61, s[12:15], s44 offen
    s_add_u32 s44, s44, s47
    v_exp_f32 v140, v140
    v_exp_f32 v141, v141
    v_exp_f32 v142, v142
    v_exp_f32 v143, v143
    v_exp_f32 v144, v144
    v_exp_f32 v145, v145
    v_smfmac_f32_32x32x32_bf16 v[64:79], v[48:51], v[136:143], v52
    ds_read_b128 v[40:43], v53 offset:640
    v_exp_f32 v146, v146
    v_exp_f32 v147, v147
    v_exp_f32 v148, v148
    v_exp_f32 v149, v149
    v_mfma_f32_32x32x16_bf16 v[96:111], v[22:25], v[12:15], v[96:111]
    v_exp_f32 v150, v150
    v_exp_f32 v151, v151
    v_exp_f32 v152, v152
    v_exp_f32 v153, v153
    v_mfma_f32_32x32x16_bf16 v[112:127], v[22:25], v[16:19], v[112:127]
    s_cmp_lg_u32 s20, 0
    s_cbranch_scc1 L_nx2
    s_add_u32 s27, s45, 21504
    buffer_load_dwordx4 v[160:163], v5, s[12:15], s27 offen
    buffer_load_dwordx4 v[164:167], v61, s[12:15], s27 offen
L_nx2:
    v_exp_f32 v154, v154
    v_exp_f32 v155, v155
    v_exp_f32 v156, v156
    v_exp_f32 v157, v157
    v_smfmac_f32_32x32x32_bf16 v[80:95], v[44:47], v[144:151], v52
    v_exp_f32 v158, v158
    v_exp_f32 v159, v159
    s_waitcnt lgkmcnt(0)
    s_setprio 2
    v_exp_f32 v96, v96
    v_smfmac_f32_32x32x32_bf16 v[80:95], v[48:51], v[152:159], v52
    ds_read_b128 v[22:25], v3 offset:25600
    v_exp_f32 v97, v97
    v_exp_f32 v98, v98
    v_exp_f32 v99, v99
    v_mfma_f32_32x32x4_2b_bf16 v[128:159], v[32:33], v[20:21], 0
    ds_read_b64 v[26:27], v9 offset:25600
    v_exp_f32 v100, v100
    v_exp_f32 v101, v101
    v_exp_f32 v102, v102
    v_exp_f32 v103, v103
    v_exp_f32 v104, v104
    v_exp_f32 v105, v105
    v_exp_f32 v106, v106
    v_exp_f32 v107, v107
    v_smfmac_f32_32x32x32_bf16 v[64:79], v[36:39], v[96:103], v52
    ds_read_b128 v[44:47], v53 offset:1280
    buffer_load_dwordx4 v[248:251], v5, s[12:15], s44 offen
    buffer_load_dwordx4 v[252:255], v61, s[12:15], s44 offen
    s_add_u32 s44, s44, s46
    v_exp_f32 v108, v108
    v_exp_f32 v109, v109
    v_exp_f32 v110, v110
    v_exp_f32 v111, v111
    v_exp_f32 v112, v112
    v_exp_f32 v113, v113
    v_smfmac_f32_32x32x32_bf16 v[64:79], v[40:43], v[104:111], v52
    ds_read_b128 v[48:51], v53 offset:1920
    v_exp_f32 v114, v114
    v_exp_f32 v115, v115
    v_exp_f32 v116, v116
    v_exp_f32 v117, v117
    v_mfma_f32_32x32x16_bf16 v[128:143], v[28:31], v[12:15], v[128:143]
    s_setprio 1
    v_exp_f32 v118, v118
    v_exp_f32 v119, v119
    v_exp_f32 v120, v120
    v_exp_f32 v121, v121
    v_mfma_f32_32x32x16_bf16 v[144:159], v[28:31], v[16:19], v[144:159]
    v_exp_f32 v122, v122
    v_exp_f32 v123, v123
    v_exp_f32 v124, v124
    v_exp_f32 v125, v125
    v_smfmac_f32_32x32x32_bf16 v[80:95], v[36:39], v[112:119], v52
    v_exp_f32 v126, v126
    v_exp_f32 v127, v127
    s_waitcnt lgkmcnt(0)
    v_exp_f32 v128, v128
    v_smfmac_f32_32x32x32_bf16 v[80:95], v[40:43], v[120:127], v52
    ds_read_b128 v[28:31], v3 offset:26112
    v_exp_f32 v129, v129
    v_exp_f32 v130, v130
    v_exp_f32 v131, v131
    v_mfma_f32_32x32x4_2b_bf16 v[96:127], v[26:27], v[20:21], 0
    ds_read_b64 v[32:33], v9 offset:26112
    v_exp_f32 v132, v132
    v_exp_f32 v133, v133
    v_exp_f32 v134, v134
    v_exp_f32 v135, v135
    v_exp_f32 v136, v136
    v_exp_f32 v137, v137
    v_exp_f32 v138, v138
    v_exp_f32 v139, v139
    v_smfmac_f32_32x32x32_bf16 v[64:79], v[44:47], v[128:135], v52
    ds_read_b128 v[36:39], v53 offset:2560
    v_exp_f32 v140, v140
    v_exp_f32 v141, v141
    v_exp_f32 v142, v142
    v_exp_f32 v143, v143
    v_exp_f32 v144, v144
    v_exp_f32 v145, v145
    v_smfmac_f32_32x32x32_bf16 v[64:79], v[48:51], v[136:143], v52
    ds_read_b128 v[40:43], v53 offset:3200
    v_exp_f32 v146, v146
    v_exp_f32 v147, v147
    v_exp_f32 v148, v148
    v_exp_f32 v149, v149
    v_mfma_f32_32x32x16_bf16 v[96:111], v[22:25], v[12:15], v[96:111]
    s_setprio 0
    v_exp_f32 v150, v150
    v_exp_f32 v151, v151
    v_exp_f32 v152, v152
    v_exp_f32 v153, v153
    v_mfma_f32_32x32x16_bf16 v[112:127], v[22:25], v[16:19], v[112:127]
    v_exp_f32 v154, v154
    v_exp_f32 v155, v155
    v_exp_f32 v156, v156
    v_exp_f32 v157, v157
    v_smfmac_f32_32x32x32_bf16 v[80:95], v[44:47], v[144:151], v52
    v_exp_f32 v158, v158
    v_exp_f32 v159, v159
    s_waitcnt vmcnt(23) lgkmcnt(0)
    s_barrier
    s_setprio 2
    v_exp_f32 v96, v96
    v_smfmac_f32_32x32x32_bf16 v[80:95], v[48:51], v[152:159], v52
    v_exp_f32 v97, v97
    v_exp_f32 v98, v98
    v_exp_f32 v99, v99
    v_mfma_f32_32x32x4_2b_bf16 v[128:159], v[32:33], v[20:21], 0
    v_exp_f32 v100, v100
    v_exp_f32 v101, v101
    v_exp_f32 v102, v102
    v_exp_f32 v103, v103
    v_exp_f32 v104, v104
    v_exp_f32 v105, v105
    v_exp_f32 v106, v106
    v_exp_f32 v107, v107
    v_smfmac_f32_32x32x32_bf16 v[64:79], v[36:39], v[96:103], v52
    ds_read_b128 v[44:47], v53 offset:3840
    v_exp_f32 v108, v108
    v_exp_f32 v109, v109
    v_exp_f32 v110, v110
    v_exp_f32 v111, v111
    v_exp_f32 v112, v112
    v_exp_f32 v113, v113
    v_smfmac_f32_32x32x32_bf16 v[64:79], v[40:43], v[104:111], v52
    ds_read_b128 v[48:51], v53 offset:4480
    s_add_u32 m0, s50, 49152
    s_add_u32 s52, s79, 49152
    v_exp_f32 v114, v114
    v_exp_f32 v115, v115
    v_exp_f32 v116, v116
    v_exp_f32 v117, v117
    v_mfma_f32_32x32x16_bf16 v[128:143], v[28:31], v[12:15], v[128:143]
    s_setprio 1
    buffer_load_dwordx4 v5, s[12:15], s52 offen offset:0 lds
    v_exp_f32 v118, v118
    v_exp_f32 v119, v119
    v_exp_f32 v120, v120
    v_exp_f32 v121, v121
    v_mfma_f32_32x32x16_bf16 v[144:159], v[28:31], v[16:19], v[144:159]
    buffer_load_dwordx4 v5, s[12:15], s52 offen offset:1024 lds
    v_exp_f32 v122, v122
    v_exp_f32 v123, v123
    v_exp_f32 v124, v124
    v_exp_f32 v125, v125
    v_smfmac_f32_32x32x32_bf16 v[80:95], v[36:39], v[112:119], v52
    buffer_load_dwordx4 v5, s[12:15], s52 offen offset:2048 lds
    v_exp_f32 v126, v126
    v_exp_f32 v127, v127
    s_waitcnt lgkmcnt(0)
    v_exp_f32 v128, v128
    v_smfmac_f32_32x32x32_bf16 v[80:95], v[40:43], v[120:127], v52
    s_mov_b32 s26, 16811008
    buffer_load_dwordx4 v[22:25], v5, s[12:15], s26 offen sc1
    v_add_u32 v28, s75, v5
    s_xor_b32 s21, s18, 4
    s_mul_i32 s21, s21, 3072
    s_add_u32 s21, s21, 104448
    v_add_u32 v29, s21, v5
    v_exp_f32 v129, v129
    v_exp_f32 v130, v130
    v_exp_f32 v131, v131
    v_exp_f32 v132, v132
    v_exp_f32 v133, v133
    v_exp_f32 v134, v134
    v_exp_f32 v135, v135
    v_exp_f32 v136, v136
    v_exp_f32 v137, v137
    v_exp_f32 v138, v138
    v_exp_f32 v139, v139
    v_smfmac_f32_32x32x32_bf16 v[64:79], v[44:47], v[128:135], v52
    v_exp_f32 v140, v140
    v_exp_f32 v141, v141
    v_exp_f32 v142, v142
    v_exp_f32 v143, v143
    v_exp_f32 v144, v144
    v_exp_f32 v145, v145
    v_smfmac_f32_32x32x32_bf16 v[64:79], v[48:51], v[136:143], v52
    v_exp_f32 v146, v146
    v_exp_f32 v147, v147
    v_exp_f32 v148, v148
    v_exp_f32 v149, v149
    s_setprio 0
    v_exp_f32 v150, v150
    v_exp_f32 v151, v151
    v_exp_f32 v152, v152
    v_exp_f32 v153, v153
    v_exp_f32 v154, v154
    v_exp_f32 v155, v155
    v_exp_f32 v156, v156
    v_exp_f32 v157, v157
    v_smfmac_f32_32x32x32_bf16 v[80:95], v[44:47], v[144:151], v52
    ds_write_b128 v28, v[64:67] offset:0
    ds_write_b128 v28, v[68:71] offset:1024
    ds_write_b128 v28, v[72:75] offset:2048
    v_exp_f32 v158, v158
    v_exp_f32 v159, v159
    s_setprio 3
    s_nop 0
    v_smfmac_f32_32x32x32_bf16 v[80:95], v[48:51], v[152:159], v52
L_merge:
    s_mov_b32 s33, 32768
    s_waitcnt vmcnt(0)
L_g2:
    v_xor_b32 v22, s55, v22
    v_xor_b32 v23, s55, v23
    v_xor_b32 v24, s55, v24
    v_xor_b32 v25, s55, v25
    v_or3_b32 v22, v22, v23, v24
    v_or_b32 v22, v22, v25
    v_cmp_ne_u32 vcc, 0, v22
    s_cbranch_vccnz L_g2r
L_g2d:
    s_waitcnt lgkmcnt(0)
    s_barrier
    ds_read_b128 v[104:107], v29 offset:2048
    ds_read_b128 v[96:99], v29 offset:0
    ds_read_b128 v[100:103], v29 offset:1024
    s_cmp_lg_u32 s18, 0
    s_cbranch_scc1 L_nep
    buffer_load_dword v61, v62, s[12:15], 0 offen sc1
L_nep:
    v_lshlrev_b32 v114, 2, v1
    s_mov_b32 exec_hi, 0
    buffer_store_dword v59, v114, s[12:15], s51 offen sc0 sc1
    s_mov_b32 exec_hi, -1
    s_mov_b32 s38, 0x30800000
    s_mov_b32 s39, 0x71800000
    v_mov_b32 v112, 0
    v_mov_b32 v113, 0
    s_waitcnt lgkmcnt(2)
    v_pk_add_f32 v[104:105], v[104:105], v[88:89]
    v_pk_add_f32 v[106:107], v[106:107], v[90:91]
    v_mov_b32 v109, v104
    v_mov_b32 v108, v104
    s_waitcnt lgkmcnt(0)
    v_pk_add_f32 v[96:97], v[96:97], v[80:81]
    v_permlane32_swap_b32 v109, v108
    v_pk_add_f32 v[98:99], v[98:99], v[82:83]
    v_rcp_f32 v110, v108
    v_pk_add_f32 v[100:101], v[100:101], v[84:85]
    v_pk_add_f32 v[102:103], v[102:103], v[86:87]
    v_cmp_nge_f32 s[40:41], v108, s38
    v_cmp_nle_f32 s[42:43], v108, s39
    v_pk_mul_f32 v[116:117], v[96:97], v[112:113]
    v_pk_fma_f32 v[116:117], v[98:99], v[112:113], v[116:117]
    v_pk_fma_f32 v[116:117], v[100:101], v[112:113], v[116:117]
    v_pk_fma_f32 v[116:117], v[102:103], v[112:113], v[116:117]
    v_pk_fma_f32 v[116:117], v[104:105], v[112:113], v[116:117]
    v_pk_fma_f32 v[116:117], v[106:107], v[112:113], v[116:117]
    s_or_b64 s[40:41], s[40:41], s[42:43]
    v_cmp_u_f32 vcc, v116, v117
    v_pk_mul_f32 v[96:97], v[96:97], v[110:111] op_sel_hi:[1,0]
    v_pk_mul_f32 v[98:99], v[98:99], v[110:111] op_sel_hi:[1,0]
    v_pk_mul_f32 v[100:101], v[100:101], v[110:111] op_sel_hi:[1,0]
    v_pk_mul_f32 v[102:103], v[102:103], v[110:111] op_sel_hi:[1,0]
    v_pk_mul_f32 v[104:105], v[104:105], v[110:111] op_sel_hi:[1,0]
    v_pk_mul_f32 v[106:107], v[106:107], v[110:111] op_sel_hi:[1,0]
    s_or_b64 s[40:41], s[40:41], vcc
    s_cbranch_scc1 L_slow
L_pack:
    v_cvt_pk_bf16_f32 v120, v96, v97
    v_cvt_pk_bf16_f32 v121, v98, v99
    v_cvt_pk_bf16_f32 v122, v100, v101
    v_cvt_pk_bf16_f32 v123, v102, v103
    v_cvt_pk_bf16_f32 v124, v104, v105
    v_cvt_pk_bf16_f32 v125, v106, v107
L_store:
    buffer_store_dwordx4 v[120:123], v57, s[12:15], 0 offen sc0 sc1
    s_mov_b32 exec_hi, 0
    buffer_store_dwordx2 v[124:125], v58, s[12:15], 0 offen sc0 sc1
    s_mov_b32 exec_hi, -1
    s_setprio 0
    s_load_dwordx2 s[8:9], s[0:1], 40
    s_load_dwordx4 s[40:43], s[0:1], 56
    s_lshr_b32 s21, s2, 3
    s_and_b32 s16, s2, 7
    s_lshl_b32 s16, s16, 2
    s_lshr_b32 s22, s21, 3
    s_add_u32 s16, s16, s22
    s_and_b32 s17, s21, 7
    s_and_b32 s25, s18, 3
    s_and_b32 s56, s18, 1
    s_bfe_u32 s57, s18, 0x10001
    s_lshl_b32 s19, s16, 2
    s_add_u32 s19, s19, s25
    s_mul_i32 s30, s19, 20480
    s_add_u32 s30, s30, 7864320
    v_lshlrev_b32 v2, 4, v1
    v_and_b32 v6, 15, v1
    v_lshrrev_b32 v7, 4, v1
    s_mul_i32 s52, s21, 43
    s_lshr_b32 s52, s52, 8
    s_mul_i32 s53, s52, 6
    s_sub_u32 s53, s21, s53
    s_and_b32 s22, s2, 1
    s_mul_i32 s22, s22, 5
    s_add_u32 s52, s52, s22
    s_bfe_u32 s22, s2, 0x20001
    s_mul_i32 s22, s22, 6
    s_add_u32 s53, s53, s22
    s_mov_b32 s58, 0
    s_mov_b32 s68, 0
    s_cmp_lt_u32 s21, 30
    s_cselect_b32 s54, 1, 0
    s_waitcnt lgkmcnt(0)
    s_cmp_ge_u32 s18, 4
    s_cbranch_scc1 L_Y
    s_setprio 0
    v_mov_b32 v8, 163776
    v_mov_b32 v9, 1
    s_mov_b64 exec, 1
    ds_add_u32 v8, v9 offset:8
    s_mov_b64 exec, -1
    s_lshl_b32 s27, s53, 2
    s_lshl_b32 s28, s56, 1
    s_add_u32 s27, s27, s28
    s_lshl_b32 s27, s27, 16
    s_lshl_b32 s28, s57, 11
    s_add_u32 s27, s27, s28
    s_add_u32 s30, s27, 16908288
    s_mov_b32 s31, s58
    s_add_u32 s27, s30, s31
    s_add_u32 s28, s27, 65536
    s_lshl_b32 s29, s18, 11
    s_add_u32 s29, s29, 81920
    s_cmp_lg_u32 s18, 0
    s_cbranch_scc1 L_apd
    s_setprio 3
    s_mov_b32 s33, 32768
    s_waitcnt vmcnt(3)
L_ap:
    v_cmp_ne_u32 vcc, s55, v61
    s_mov_b32 s32, 0
    s_sub_u32 s33, s33, 1
    s_bfe_u32 s34, vcc_lo, 524288
    s_cselect_b32 s34, 0, 1
    s_or_b32 s32, s32, s34
    s_bfe_u32 s34, vcc_lo, 524296
    s_cselect_b32 s34, 0, 2
    s_or_b32 s32, s32, s34
    s_bfe_u32 s34, vcc_lo, 524304
    s_cselect_b32 s34, 0, 4
    s_or_b32 s32, s32, s34
    s_bfe_u32 s34, vcc_lo, 524312
    s_cselect_b32 s34, 0, 8
    s_or_b32 s32, s32, s34
    s_cmp_lt_i32 s33, 1
    s_cselect_b32 s32, 15, s32
    v_mov_b32 v9, s32
    ds_write_b32 v8, v9
    s_cmp_eq_u32 s32, 15
    s_cbranch_scc1 L_apd
    s_sleep 3
    s_mov_b32 exec_hi, 0
    buffer_load_dword v61, v62, s[12:15], 0 offen sc1
    s_mov_b64 exec, -1
    s_waitcnt vmcnt(0)
    s_branch L_ap
L_apd:
    s_setprio 0
    s_cmp_eq_u32 s54, 0
    s_cbranch_scc0 L_Xd
    v_mov_b32 v3, 163784
    s_mov_b32 s33, 524288
L_wf3:
    ds_read_b32 v4, v3
    s_sub_u32 s33, s33, 1
    s_waitcnt lgkmcnt(0)
    v_readfirstlane_b32 s32, v4
    s_cmp_eq_u32 s33, 0
    s_cbranch_scc1 L_wd3
    s_cmp_lt_u32 s32, 8
    s_cbranch_scc1 L_wf3
L_wd3:
    s_branch L_Xe
L_Xd:
    v_mov_b32 v3, 163780
    s_mov_b32 s33, 524288
L_wf4:
    s_sleep 2
    ds_read_b32 v4, v3
    s_sub_u32 s33, s33, 1
    s_waitcnt lgkmcnt(0)
    v_readfirstlane_b32 s32, v4
    s_cmp_eq_u32 s33, 0
    s_cbranch_scc1 L_wd4
    s_cmp_lt_u32 s32, 4
    s_cbranch_scc1 L_wf4
L_wd4:
    buffer_load_dwordx4 v[72:75], v2, s[12:15], s27 offen offset:0
    buffer_load_dwordx4 v[76:79], v2, s[12:15], s28 offen offset:0
    buffer_load_dwordx4 v[80:83], v2, s[12:15], s27 offen offset:1024
    buffer_load_dwordx4 v[84:87], v2, s[12:15], s28 offen offset:1024
    s_add_u32 s31, s31, 4096
    s_and_b32 s31, s31, 0xffff
    s_add_u32 s27, s30, s31
    s_add_u32 s28, s27, 65536
    buffer_load_dwordx4 v[88:91], v2, s[12:15], s27 offen offset:0
    buffer_load_dwordx4 v[92:95], v2, s[12:15], s28 offen offset:0
    buffer_load_dwordx4 v[96:99], v2, s[12:15], s27 offen offset:1024
    buffer_load_dwordx4 v[100:103], v2, s[12:15], s28 offen offset:1024
    s_add_u32 s31, s31, 4096
    s_and_b32 s31, s31, 0xffff
    s_add_u32 s27, s30, s31
    s_add_u32 s28, s27, 65536
    buffer_load_dwordx4 v[104:107], v2, s[12:15], s27 offen offset:0
    buffer_load_dwordx4 v[108:111], v2, s[12:15], s28 offen offset:0
    buffer_load_dwordx4 v[112:115], v2, s[12:15], s27 offen offset:1024
    buffer_load_dwordx4 v[116:119], v2, s[12:15], s28 offen offset:1024
    s_add_u32 s31, s31, 4096
    s_and_b32 s31, s31, 0xffff
    s_add_u32 s27, s30, s31
    s_add_u32 s28, s27, 65536
    buffer_load_dwordx4 v[120:123], v2, s[12:15], s27 offen offset:0
    buffer_load_dwordx4 v[124:127], v2, s[12:15], s28 offen offset:0
    buffer_load_dwordx4 v[128:131], v2, s[12:15], s27 offen offset:1024
    buffer_load_dwordx4 v[132:135], v2, s[12:15], s28 offen offset:1024
    s_add_u32 s31, s31, 4096
    s_and_b32 s31, s31, 0xffff
    s_add_u32 s27, s30, s31
    s_add_u32 s28, s27, 65536
    buffer_load_dwordx4 v[136:139], v2, s[12:15], s27 offen offset:0
    s_waitcnt vmcnt(16)
    buffer_load_dwordx4 v[140:143], v2, s[12:15], s28 offen offset:0
    s_waitcnt vmcnt(16)
    buffer_load_dwordx4 v[144:147], v2, s[12:15], s27 offen offset:1024
    s_waitcnt vmcnt(16)
    buffer_load_dwordx4 v[148:151], v2, s[12:15], s28 offen offset:1024
    s_waitcnt vmcnt(16)
    s_add_u32 s31, s31, 4096
    s_and_b32 s31, s31, 0xffff
    s_add_u32 s27, s30, s31
    s_add_u32 s28, s27, 65536
    buffer_load_dwordx4 v[152:155], v2, s[12:15], s27 offen offset:0
    s_waitcnt vmcnt(16)
    buffer_load_dwordx4 v[156:159], v2, s[12:15], s28 offen offset:0
    s_waitcnt vmcnt(16)
    s_mov_b32 s10, 3072
    s_mov_b32 s11, 0x00020000
    s_lshl_b32 s27, s53, 7
    s_lshl_b32 s28, s56, 6
    s_add_u32 s27, s27, s28
    s_cmp_eq_u32 s57, 0
    s_cselect_b32 s27, s27, 0x80000000
    v_lshlrev_b32 v3, 3, v7
    buffer_load_dwordx2 v[40:41], v3, s[8:11], s27 offen
    buffer_load_dwordx2 v[42:43], v3, s[8:11], s27 offen offset:32
    v_bfe_u32 v3, v1, 5, 1
    v_lshlrev_b32 v3, 8, v3
    v_bfe_u32 v4, v1, 1, 1
    v_lshl_add_u32 v3, v4, 7, v3
    v_bfe_u32 v4, v1, 2, 3
    v_lshl_add_u32 v3, v4, 4, v3
    v_and_b32 v4, 1, v1
    v_lshl_add_u32 v3, v4, 3, v3
    s_lshl_b32 s27, s57, 11
    v_add_u32 v3, s27, v3
    v_add_u32 v4, 65536, v3
    v_add_u32 v6, 131072, v3
    v_add_u32 v5, s29, v2
    v_add_u32 v0, 57344, v5
    s_lshl_b32 s70, s52, 2
    s_lshl_b32 s28, s57, 1
    s_add_u32 s70, s70, s28
    s_mul_i32 s70, s70, 48
    s_lshl_b32 s28, s53, 1
    s_add_u32 s70, s70, s28
    s_add_u32 s70, s70, s56
    s_lshl_b32 s70, s70, 10
    s_add_u32 s70, s70, 13107200
    s_add_u32 s71, s70, 49152
    s_mov_b32 s20, 0xc0135761
    s_mov_b32 s22, 0xbdd2d3e8
    s_mov_b32 s23, s22
    s_mul_i32 s72, s52, 24
    s_add_u32 s72, s72, s53
    s_lshl_b32 s72, s72, 7
    s_add_u32 s72, s72, 16777216
    s_cmp_eq_u32 s18, 0
    s_cselect_b32 s72, s72, 0x80000000
    s_lshl_b32 s73, s18, 12
    s_add_u32 s73, s73, 32768
    s_xor_b32 s74, s73, 8192
    s_waitcnt vmcnt(0)
    v_lshlrev_b32 v8, 16, v40
    v_and_b32 v9, 0xffff0000, v40
    v_lshlrev_b32 v10, 16, v41
    v_and_b32 v11, 0xffff0000, v41
    v_lshlrev_b32 v12, 16, v42
    v_and_b32 v13, 0xffff0000, v42
    v_lshlrev_b32 v14, 16, v43
    v_and_b32 v15, 0xffff0000, v43
    v_lshlrev_b32 v16, 16, v40
    v_and_b32 v17, 0xffff0000, v40
    v_lshlrev_b32 v18, 16, v41
    v_and_b32 v19, 0xffff0000, v41
    v_lshlrev_b32 v20, 16, v42
    v_and_b32 v21, 0xffff0000, v42
    v_lshlrev_b32 v22, 16, v43
    v_and_b32 v23, 0xffff0000, v43
    v_lshlrev_b32 v24, 16, v40
    v_and_b32 v25, 0xffff0000, v40
    v_lshlrev_b32 v26, 16, v41
    v_and_b32 v27, 0xffff0000, v41
    v_lshlrev_b32 v28, 16, v42
    v_and_b32 v29, 0xffff0000, v42
    v_lshlrev_b32 v30, 16, v43
    v_and_b32 v31, 0xffff0000, v43
    v_lshlrev_b32 v32, 16, v40
    v_and_b32 v33, 0xffff0000, v40
    v_lshlrev_b32 v34, 16, v41
    v_and_b32 v35, 0xffff0000, v41
    v_lshlrev_b32 v36, 16, v42
    v_and_b32 v37, 0xffff0000, v42
    v_lshlrev_b32 v38, 16, v43
    v_and_b32 v39, 0xffff0000, v43
    s_barrier
    ds_read_b64_tr_b16 v[40:41], v3 offset:0
    ds_read_b64_tr_b16 v[42:43], v3 offset:512
    ds_read_b64_tr_b16 v[44:45], v3 offset:4096
    ds_read_b64_tr_b16 v[46:47], v3 offset:4608
    ds_read_b64_tr_b16 v[48:49], v3 offset:8192
    ds_read_b64_tr_b16 v[50:51], v3 offset:8704
    ds_read_b64_tr_b16 v[52:53], v3 offset:12288
    ds_read_b64_tr_b16 v[54:55], v3 offset:12800
    s_waitcnt lgkmcnt(6)
    v_mfma_f32_16x16x32_bf16 v[8:11], v[72:75], v[40:43], v[8:11]
    ds_read_b64_tr_b16 v[56:57], v3 offset:1024
    v_mfma_f32_16x16x32_bf16 v[12:15], v[76:79], v[40:43], v[12:15]
    ds_read_b64_tr_b16 v[58:59], v3 offset:1536
    s_waitcnt lgkmcnt(6)
    v_mfma_f32_16x16x32_bf16 v[16:19], v[72:75], v[44:47], v[16:19]
    ds_read_b64_tr_b16 v[60:61], v3 offset:5120
    v_mfma_f32_16x16x32_bf16 v[20:23], v[76:79], v[44:47], v[20:23]
    ds_read_b64_tr_b16 v[62:63], v3 offset:5632
    s_waitcnt lgkmcnt(6)
    v_mfma_f32_16x16x32_bf16 v[24:27], v[72:75], v[48:51], v[24:27]
    ds_read_b64_tr_b16 v[64:65], v3 offset:9216
    v_mfma_f32_16x16x32_bf16 v[28:31], v[76:79], v[48:51], v[28:31]
    ds_read_b64_tr_b16 v[66:67], v3 offset:9728
    s_waitcnt lgkmcnt(6)
    v_mfma_f32_16x16x32_bf16 v[32:35], v[72:75], v[52:55], v[32:35]
    ds_read_b64_tr_b16 v[68:69], v3 offset:13312
    v_mfma_f32_16x16x32_bf16 v[36:39], v[76:79], v[52:55], v[36:39]
    ds_read_b64_tr_b16 v[70:71], v3 offset:13824
    ds_read_b128 v[72:75], v5 offset:0
    ds_read_b128 v[76:79], v5 offset:1024
    s_waitcnt lgkmcnt(8)
    v_mfma_f32_16x16x32_bf16 v[8:11], v[80:83], v[56:59], v[8:11]
    s_barrier
    ds_read_b64_tr_b16 v[40:41], v3 offset:16384
    v_mfma_f32_16x16x32_bf16 v[12:15], v[84:87], v[56:59], v[12:15]
    ds_read_b64_tr_b16 v[42:43], v3 offset:16896
    s_waitcnt lgkmcnt(8)
    v_mfma_f32_16x16x32_bf16 v[16:19], v[80:83], v[60:63], v[16:19]
    ds_read_b64_tr_b16 v[44:45], v3 offset:20480
    v_mfma_f32_16x16x32_bf16 v[20:23], v[84:87], v[60:63], v[20:23]
    ds_read_b64_tr_b16 v[46:47], v3 offset:20992
    s_waitcnt lgkmcnt(8)
    v_mfma_f32_16x16x32_bf16 v[24:27], v[80:83], v[64:67], v[24:27]
    ds_read_b64_tr_b16 v[48:49], v3 offset:24576
    v_mfma_f32_16x16x32_bf16 v[28:31], v[84:87], v[64:67], v[28:31]
    ds_read_b64_tr_b16 v[50:51], v3 offset:25088
    s_waitcnt lgkmcnt(8)
    v_mfma_f32_16x16x32_bf16 v[32:35], v[80:83], v[68:71], v[32:35]
    ds_read_b64_tr_b16 v[52:53], v3 offset:28672
    v_mfma_f32_16x16x32_bf16 v[36:39], v[84:87], v[68:71], v[36:39]
    ds_read_b64_tr_b16 v[54:55], v3 offset:29184
    ds_read_b128 v[80:83], v5 offset:8192
    ds_read_b128 v[84:87], v5 offset:9216
    s_waitcnt lgkmcnt(8)
    v_mfma_f32_16x16x32_bf16 v[8:11], v[88:91], v[40:43], v[8:11]
    ds_read_b64_tr_b16 v[56:57], v3 offset:17408
    v_mfma_f32_16x16x32_bf16 v[12:15], v[92:95], v[40:43], v[12:15]
    ds_read_b64_tr_b16 v[58:59], v3 offset:17920
    s_waitcnt lgkmcnt(8)
    v_mfma_f32_16x16x32_bf16 v[16:19], v[88:91], v[44:47], v[16:19]
    ds_read_b64_tr_b16 v[60:61], v3 offset:21504
    v_mfma_f32_16x16x32_bf16 v[20:23], v[92:95], v[44:47], v[20:23]
    ds_read_b64_tr_b16 v[62:63], v3 offset:22016
    s_waitcnt lgkmcnt(8)
    v_mfma_f32_16x16x32_bf16 v[24:27], v[88:91], v[48:51], v[24:27]
    ds_read_b64_tr_b16 v[64:65], v3 offset:25600
    v_mfma_f32_16x16x32_bf16 v[28:31], v[92:95], v[48:51], v[28:31]
    ds_read_b64_tr_b16 v[66:67], v3 offset:26112
    s_waitcnt lgkmcnt(8)
    v_mfma_f32_16x16x32_bf16 v[32:35], v[88:91], v[52:55], v[32:35]
    ds_read_b64_tr_b16 v[68:69], v3 offset:29696
    v_mfma_f32_16x16x32_bf16 v[36:39], v[92:95], v[52:55], v[36:39]
    ds_read_b64_tr_b16 v[70:71], v3 offset:30208
    ds_read_b128 v[88:91], v5 offset:16384
    ds_read_b128 v[92:95], v5 offset:17408
    s_waitcnt lgkmcnt(8)
    v_mfma_f32_16x16x32_bf16 v[8:11], v[96:99], v[56:59], v[8:11]
    s_barrier
    ds_read_b64_tr_b16 v[40:41], v3 offset:32768
    v_mfma_f32_16x16x32_bf16 v[12:15], v[100:103], v[56:59], v[12:15]
    ds_read_b64_tr_b16 v[42:43], v3 offset:33280
    s_waitcnt lgkmcnt(8)
    v_mfma_f32_16x16x32_bf16 v[16:19], v[96:99], v[60:63], v[16:19]
    ds_read_b64_tr_b16 v[44:45], v3 offset:36864
    v_mfma_f32_16x16x32_bf16 v[20:23], v[100:103], v[60:63], v[20:23]
    ds_read_b64_tr_b16 v[46:47], v3 offset:37376
    s_waitcnt lgkmcnt(8)
    v_mfma_f32_16x16x32_bf16 v[24:27], v[96:99], v[64:67], v[24:27]
    ds_read_b64_tr_b16 v[48:49], v3 offset:40960
    v_mfma_f32_16x16x32_bf16 v[28:31], v[100:103], v[64:67], v[28:31]
    ds_read_b64_tr_b16 v[50:51], v3 offset:41472
    s_waitcnt lgkmcnt(8)
    v_mfma_f32_16x16x32_bf16 v[32:35], v[96:99], v[68:71], v[32:35]
    ds_read_b64_tr_b16 v[52:53], v3 offset:45056
    v_mfma_f32_16x16x32_bf16 v[36:39], v[100:103], v[68:71], v[36:39]
    ds_read_b64_tr_b16 v[54:55], v3 offset:45568
    ds_read_b128 v[96:99], v5 offset:24576
    ds_read_b128 v[100:103], v5 offset:25600
    s_waitcnt lgkmcnt(8)
    v_mfma_f32_16x16x32_bf16 v[8:11], v[104:107], v[40:43], v[8:11]
    ds_read_b64_tr_b16 v[56:57], v3 offset:33792
    v_mfma_f32_16x16x32_bf16 v[12:15], v[108:111], v[40:43], v[12:15]
    ds_read_b64_tr_b16 v[58:59], v3 offset:34304
    s_waitcnt lgkmcnt(8)
    v_mfma_f32_16x16x32_bf16 v[16:19], v[104:107], v[44:47], v[16:19]
    ds_read_b64_tr_b16 v[60:61], v3 offset:37888
    v_mfma_f32_16x16x32_bf16 v[20:23], v[108:111], v[44:47], v[20:23]
    ds_read_b64_tr_b16 v[62:63], v3 offset:38400
    s_waitcnt lgkmcnt(8)
    v_mfma_f32_16x16x32_bf16 v[24:27], v[104:107], v[48:51], v[24:27]
    ds_read_b64_tr_b16 v[64:65], v3 offset:41984
    v_mfma_f32_16x16x32_bf16 v[28:31], v[108:111], v[48:51], v[28:31]
    ds_read_b64_tr_b16 v[66:67], v3 offset:42496
    s_waitcnt lgkmcnt(8)
    v_mfma_f32_16x16x32_bf16 v[32:35], v[104:107], v[52:55], v[32:35]
    ds_read_b64_tr_b16 v[68:69], v3 offset:46080
    v_mfma_f32_16x16x32_bf16 v[36:39], v[108:111], v[52:55], v[36:39]
    ds_read_b64_tr_b16 v[70:71], v3 offset:46592
    ds_read_b128 v[104:107], v5 offset:32768
    ds_read_b128 v[108:111], v5 offset:33792
    s_waitcnt lgkmcnt(8)
    v_mfma_f32_16x16x32_bf16 v[8:11], v[112:115], v[56:59], v[8:11]
    s_barrier
    ds_read_b64_tr_b16 v[40:41], v3 offset:49152
    v_mfma_f32_16x16x32_bf16 v[12:15], v[116:119], v[56:59], v[12:15]
    ds_read_b64_tr_b16 v[42:43], v3 offset:49664
    s_waitcnt lgkmcnt(8)
    v_mfma_f32_16x16x32_bf16 v[16:19], v[112:115], v[60:63], v[16:19]
    ds_read_b64_tr_b16 v[44:45], v3 offset:53248
    v_mfma_f32_16x16x32_bf16 v[20:23], v[116:119], v[60:63], v[20:23]
    ds_read_b64_tr_b16 v[46:47], v3 offset:53760
    s_waitcnt lgkmcnt(8)
    v_mfma_f32_16x16x32_bf16 v[24:27], v[112:115], v[64:67], v[24:27]
    ds_read_b64_tr_b16 v[48:49], v3 offset:57344
    v_mfma_f32_16x16x32_bf16 v[28:31], v[116:119], v[64:67], v[28:31]
    ds_read_b64_tr_b16 v[50:51], v3 offset:57856
    s_waitcnt lgkmcnt(8)
    v_mfma_f32_16x16x32_bf16 v[32:35], v[112:115], v[68:71], v[32:35]
    ds_read_b64_tr_b16 v[52:53], v3 offset:61440
    v_mfma_f32_16x16x32_bf16 v[36:39], v[116:119], v[68:71], v[36:39]
    ds_read_b64_tr_b16 v[54:55], v3 offset:61952
    ds_read_b128 v[112:115], v5 offset:40960
    ds_read_b128 v[116:119], v5 offset:41984
    s_waitcnt lgkmcnt(8)
    v_mfma_f32_16x16x32_bf16 v[8:11], v[120:123], v[40:43], v[8:11]
    ds_read_b64_tr_b16 v[56:57], v3 offset:50176
    v_mfma_f32_16x16x32_bf16 v[12:15], v[124:127], v[40:43], v[12:15]
    ds_read_b64_tr_b16 v[58:59], v3 offset:50688
    s_waitcnt lgkmcnt(8)
    v_mfma_f32_16x16x32_bf16 v[16:19], v[120:123], v[44:47], v[16:19]
    ds_read_b64_tr_b16 v[60:61], v3 offset:54272
    v_mfma_f32_16x16x32_bf16 v[20:23], v[124:127], v[44:47], v[20:23]
    ds_read_b64_tr_b16 v[62:63], v3 offset:54784
    s_waitcnt lgkmcnt(8)
    v_mfma_f32_16x16x32_bf16 v[24:27], v[120:123], v[48:51], v[24:27]
    ds_read_b64_tr_b16 v[64:65], v3 offset:58368
    v_mfma_f32_16x16x32_bf16 v[28:31], v[124:127], v[48:51], v[28:31]
    ds_read_b64_tr_b16 v[66:67], v3 offset:58880
    s_waitcnt lgkmcnt(8)
    v_mfma_f32_16x16x32_bf16 v[32:35], v[120:123], v[52:55], v[32:35]
    ds_read_b64_tr_b16 v[68:69], v3 offset:62464
    v_mfma_f32_16x16x32_bf16 v[36:39], v[124:127], v[52:55], v[36:39]
    ds_read_b64_tr_b16 v[70:71], v3 offset:62976
    ds_read_b128 v[120:123], v5 offset:49152
    ds_read_b128 v[124:127], v5 offset:50176
    s_waitcnt lgkmcnt(8)
    v_mfma_f32_16x16x32_bf16 v[8:11], v[128:131], v[56:59], v[8:11]
    s_barrier
    ds_read_b64_tr_b16 v[40:41], v4 offset:0
    v_mfma_f32_16x16x32_bf16 v[12:15], v[132:135], v[56:59], v[12:15]
    ds_read_b64_tr_b16 v[42:43], v4 offset:512
    s_waitcnt lgkmcnt(8)
    v_mfma_f32_16x16x32_bf16 v[16:19], v[128:131], v[60:63], v[16:19]
    ds_read_b64_tr_b16 v[44:45], v4 offset:4096
    v_mfma_f32_16x16x32_bf16 v[20:23], v[132:135], v[60:63], v[20:23]
    ds_read_b64_tr_b16 v[46:47], v4 offset:4608
    s_waitcnt lgkmcnt(8)
    v_mfma_f32_16x16x32_bf16 v[24:27], v[128:131], v[64:67], v[24:27]
    ds_read_b64_tr_b16 v[48:49], v4 offset:8192
    v_mfma_f32_16x16x32_bf16 v[28:31], v[132:135], v[64:67], v[28:31]
    ds_read_b64_tr_b16 v[50:51], v4 offset:8704
    s_waitcnt lgkmcnt(8)
    v_mfma_f32_16x16x32_bf16 v[32:35], v[128:131], v[68:71], v[32:35]
    ds_read_b64_tr_b16 v[52:53], v4 offset:12288
    v_mfma_f32_16x16x32_bf16 v[36:39], v[132:135], v[68:71], v[36:39]
    ds_read_b64_tr_b16 v[54:55], v4 offset:12800
    ds_read_b128 v[128:131], v0 offset:0
    ds_read_b128 v[132:135], v0 offset:1024
    s_waitcnt lgkmcnt(8)
    v_mfma_f32_16x16x32_bf16 v[8:11], v[136:139], v[40:43], v[8:11]
    ds_read_b64_tr_b16 v[56:57], v4 offset:1024
    v_mfma_f32_16x16x32_bf16 v[12:15], v[140:143], v[40:43], v[12:15]
    ds_read_b64_tr_b16 v[58:59], v4 offset:1536
    s_waitcnt lgkmcnt(8)
    v_mfma_f32_16x16x32_bf16 v[16:19], v[136:139], v[44:47], v[16:19]
    ds_read_b64_tr_b16 v[60:61], v4 offset:5120
    v_mfma_f32_16x16x32_bf16 v[20:23], v[140:143], v[44:47], v[20:23]
    ds_read_b64_tr_b16 v[62:63], v4 offset:5632
    s_waitcnt lgkmcnt(8)
    v_mfma_f32_16x16x32_bf16 v[24:27], v[136:139], v[48:51], v[24:27]
    ds_read_b64_tr_b16 v[64:65], v4 offset:9216
    v_mfma_f32_16x16x32_bf16 v[28:31], v[140:143], v[48:51], v[28:31]
    ds_read_b64_tr_b16 v[66:67], v4 offset:9728
    s_waitcnt lgkmcnt(8)
    v_mfma_f32_16x16x32_bf16 v[32:35], v[136:139], v[52:55], v[32:35]
    ds_read_b64_tr_b16 v[68:69], v4 offset:13312
    v_mfma_f32_16x16x32_bf16 v[36:39], v[140:143], v[52:55], v[36:39]
    ds_read_b64_tr_b16 v[70:71], v4 offset:13824
    ds_read_b128 v[136:139], v0 offset:8192
    ds_read_b128 v[140:143], v0 offset:9216
    s_waitcnt lgkmcnt(8)
    v_mfma_f32_16x16x32_bf16 v[8:11], v[144:147], v[56:59], v[8:11]
    s_barrier
    ds_read_b64_tr_b16 v[40:41], v3 offset:0
    v_mfma_f32_16x16x32_bf16 v[12:15], v[148:151], v[56:59], v[12:15]
    ds_read_b64_tr_b16 v[42:43], v3 offset:512
    s_waitcnt lgkmcnt(8)
    v_mfma_f32_16x16x32_bf16 v[16:19], v[144:147], v[60:63], v[16:19]
    ds_read_b64_tr_b16 v[44:45], v3 offset:4096
    v_mfma_f32_16x16x32_bf16 v[20:23], v[148:151], v[60:63], v[20:23]
    ds_read_b64_tr_b16 v[46:47], v3 offset:4608
    s_waitcnt lgkmcnt(8)
    v_mfma_f32_16x16x32_bf16 v[24:27], v[144:147], v[64:67], v[24:27]
    ds_read_b64_tr_b16 v[48:49], v3 offset:8192
    v_mfma_f32_16x16x32_bf16 v[28:31], v[148:151], v[64:67], v[28:31]
    ds_read_b64_tr_b16 v[50:51], v3 offset:8704
    s_waitcnt lgkmcnt(8)
    v_mfma_f32_16x16x32_bf16 v[32:35], v[144:147], v[68:71], v[32:35]
    ds_read_b64_tr_b16 v[52:53], v3 offset:12288
    v_mfma_f32_16x16x32_bf16 v[36:39], v[148:151], v[68:71], v[36:39]
    ds_read_b64_tr_b16 v[54:55], v3 offset:12800
    s_waitcnt lgkmcnt(6)
    v_mfma_f32_16x16x32_bf16 v[8:11], v[152:155], v[40:43], v[8:11]
    ds_read_b64_tr_b16 v[56:57], v3 offset:1024
    v_mfma_f32_16x16x32_bf16 v[12:15], v[156:159], v[40:43], v[12:15]
    ds_read_b64_tr_b16 v[58:59], v3 offset:1536
    s_waitcnt lgkmcnt(6)
    v_mfma_f32_16x16x32_bf16 v[16:19], v[152:155], v[44:47], v[16:19]
    ds_read_b64_tr_b16 v[60:61], v3 offset:5120
    v_mfma_f32_16x16x32_bf16 v[20:23], v[156:159], v[44:47], v[20:23]
    ds_read_b64_tr_b16 v[62:63], v3 offset:5632
    s_waitcnt lgkmcnt(6)
    v_mfma_f32_16x16x32_bf16 v[24:27], v[152:155], v[48:51], v[24:27]
    ds_read_b64_tr_b16 v[64:65], v3 offset:9216
    v_mfma_f32_16x16x32_bf16 v[28:31], v[156:159], v[48:51], v[28:31]
    ds_read_b64_tr_b16 v[66:67], v3 offset:9728
    s_waitcnt lgkmcnt(6)
    v_mfma_f32_16x16x32_bf16 v[32:35], v[152:155], v[52:55], v[32:35]
    ds_read_b64_tr_b16 v[68:69], v3 offset:13312
    v_mfma_f32_16x16x32_bf16 v[36:39], v[156:159], v[52:55], v[36:39]
    ds_read_b64_tr_b16 v[70:71], v3 offset:13824
    s_waitcnt lgkmcnt(6)
    v_mfma_f32_16x16x32_bf16 v[8:11], v[160:163], v[56:59], v[8:11]
    s_barrier
    ds_read_b64_tr_b16 v[40:41], v4 offset:16384
    v_mfma_f32_16x16x32_bf16 v[12:15], v[164:167], v[56:59], v[12:15]
    ds_read_b64_tr_b16 v[42:43], v4 offset:16896
    s_waitcnt lgkmcnt(6)
    v_mfma_f32_16x16x32_bf16 v[16:19], v[160:163], v[60:63], v[16:19]
    ds_read_b64_tr_b16 v[44:45], v4 offset:20480
    v_mfma_f32_16x16x32_bf16 v[20:23], v[164:167], v[60:63], v[20:23]
    ds_read_b64_tr_b16 v[46:47], v4 offset:20992
    s_waitcnt lgkmcnt(6)
    v_mfma_f32_16x16x32_bf16 v[24:27], v[160:163], v[64:67], v[24:27]
    ds_read_b64_tr_b16 v[48:49], v4 offset:24576
    v_mfma_f32_16x16x32_bf16 v[28:31], v[164:167], v[64:67], v[28:31]
    ds_read_b64_tr_b16 v[50:51], v4 offset:25088
    s_waitcnt lgkmcnt(6)
    v_mfma_f32_16x16x32_bf16 v[32:35], v[160:163], v[68:71], v[32:35]
    ds_read_b64_tr_b16 v[52:53], v4 offset:28672
    v_mfma_f32_16x16x32_bf16 v[36:39], v[164:167], v[68:71], v[36:39]
    ds_read_b64_tr_b16 v[54:55], v4 offset:29184
    s_waitcnt lgkmcnt(6)
    v_mfma_f32_16x16x32_bf16 v[8:11], v[168:171], v[40:43], v[8:11]
    ds_read_b64_tr_b16 v[56:57], v4 offset:17408
    v_mfma_f32_16x16x32_bf16 v[12:15], v[172:175], v[40:43], v[12:15]
    ds_read_b64_tr_b16 v[58:59], v4 offset:17920
    s_waitcnt lgkmcnt(6)
    v_mfma_f32_16x16x32_bf16 v[16:19], v[168:171], v[44:47], v[16:19]
    ds_read_b64_tr_b16 v[60:61], v4 offset:21504
    v_mfma_f32_16x16x32_bf16 v[20:23], v[172:175], v[44:47], v[20:23]
    ds_read_b64_tr_b16 v[62:63], v4 offset:22016
    s_waitcnt lgkmcnt(6)
    v_mfma_f32_16x16x32_bf16 v[24:27], v[168:171], v[48:51], v[24:27]
    ds_read_b64_tr_b16 v[64:65], v4 offset:25600
    v_mfma_f32_16x16x32_bf16 v[28:31], v[172:175], v[48:51], v[28:31]
    ds_read_b64_tr_b16 v[66:67], v4 offset:26112
    s_waitcnt lgkmcnt(6)
    v_mfma_f32_16x16x32_bf16 v[32:35], v[168:171], v[52:55], v[32:35]
    ds_read_b64_tr_b16 v[68:69], v4 offset:29696
    v_mfma_f32_16x16x32_bf16 v[36:39], v[172:175], v[52:55], v[36:39]
    ds_read_b64_tr_b16 v[70:71], v4 offset:30208
    s_waitcnt lgkmcnt(6)
    v_mfma_f32_16x16x32_bf16 v[8:11], v[176:179], v[56:59], v[8:11]
    s_barrier
    ds_read_b64_tr_b16 v[40:41], v3 offset:16384
    v_mfma_f32_16x16x32_bf16 v[12:15], v[180:183], v[56:59], v[12:15]
    ds_read_b64_tr_b16 v[42:43], v3 offset:16896
    s_waitcnt lgkmcnt(6)
    v_mfma_f32_16x16x32_bf16 v[16:19], v[176:179], v[60:63], v[16:19]
    ds_read_b64_tr_b16 v[44:45], v3 offset:20480
    v_mfma_f32_16x16x32_bf16 v[20:23], v[180:183], v[60:63], v[20:23]
    ds_read_b64_tr_b16 v[46:47], v3 offset:20992
    s_waitcnt lgkmcnt(6)
    v_mfma_f32_16x16x32_bf16 v[24:27], v[176:179], v[64:67], v[24:27]
    ds_read_b64_tr_b16 v[48:49], v3 offset:24576
    v_mfma_f32_16x16x32_bf16 v[28:31], v[180:183], v[64:67], v[28:31]
    ds_read_b64_tr_b16 v[50:51], v3 offset:25088
    s_waitcnt lgkmcnt(6)
    v_mfma_f32_16x16x32_bf16 v[32:35], v[176:179], v[68:71], v[32:35]
    ds_read_b64_tr_b16 v[52:53], v3 offset:28672
    v_mfma_f32_16x16x32_bf16 v[36:39], v[180:183], v[68:71], v[36:39]
    ds_read_b64_tr_b16 v[54:55], v3 offset:29184
    s_waitcnt lgkmcnt(6)
    v_mfma_f32_16x16x32_bf16 v[8:11], v[184:187], v[40:43], v[8:11]
    ds_read_b64_tr_b16 v[56:57], v3 offset:17408
    v_mfma_f32_16x16x32_bf16 v[12:15], v[188:191], v[40:43], v[12:15]
    ds_read_b64_tr_b16 v[58:59], v3 offset:17920
    s_waitcnt lgkmcnt(6)
    v_mfma_f32_16x16x32_bf16 v[16:19], v[184:187], v[44:47], v[16:19]
    ds_read_b64_tr_b16 v[60:61], v3 offset:21504
    v_mfma_f32_16x16x32_bf16 v[20:23], v[188:191], v[44:47], v[20:23]
    ds_read_b64_tr_b16 v[62:63], v3 offset:22016
    s_waitcnt lgkmcnt(6)
    v_mfma_f32_16x16x32_bf16 v[24:27], v[184:187], v[48:51], v[24:27]
    ds_read_b64_tr_b16 v[64:65], v3 offset:25600
    v_mfma_f32_16x16x32_bf16 v[28:31], v[188:191], v[48:51], v[28:31]
    ds_read_b64_tr_b16 v[66:67], v3 offset:26112
    s_waitcnt lgkmcnt(6)
    v_mfma_f32_16x16x32_bf16 v[32:35], v[184:187], v[52:55], v[32:35]
    ds_read_b64_tr_b16 v[68:69], v3 offset:29696
    v_mfma_f32_16x16x32_bf16 v[36:39], v[188:191], v[52:55], v[36:39]
    ds_read_b64_tr_b16 v[70:71], v3 offset:30208
    s_waitcnt lgkmcnt(6)
    v_mfma_f32_16x16x32_bf16 v[8:11], v[192:195], v[56:59], v[8:11]
    s_barrier
    ds_read_b64_tr_b16 v[40:41], v4 offset:32768
    v_mfma_f32_16x16x32_bf16 v[12:15], v[196:199], v[56:59], v[12:15]
    ds_read_b64_tr_b16 v[42:43], v4 offset:33280
    s_waitcnt lgkmcnt(6)
    v_mfma_f32_16x16x32_bf16 v[16:19], v[192:195], v[60:63], v[16:19]
    ds_read_b64_tr_b16 v[44:45], v4 offset:36864
    v_mfma_f32_16x16x32_bf16 v[20:23], v[196:199], v[60:63], v[20:23]
    ds_read_b64_tr_b16 v[46:47], v4 offset:37376
    s_waitcnt lgkmcnt(6)
    v_mfma_f32_16x16x32_bf16 v[24:27], v[192:195], v[64:67], v[24:27]
    ds_read_b64_tr_b16 v[48:49], v4 offset:40960
    v_mfma_f32_16x16x32_bf16 v[28:31], v[196:199], v[64:67], v[28:31]
    ds_read_b64_tr_b16 v[50:51], v4 offset:41472
    s_waitcnt lgkmcnt(6)
    v_mfma_f32_16x16x32_bf16 v[32:35], v[192:195], v[68:71], v[32:35]
    ds_read_b64_tr_b16 v[52:53], v4 offset:45056
    v_mfma_f32_16x16x32_bf16 v[36:39], v[196:199], v[68:71], v[36:39]
    ds_read_b64_tr_b16 v[54:55], v4 offset:45568
    s_waitcnt lgkmcnt(6)
    v_mfma_f32_16x16x32_bf16 v[8:11], v[200:203], v[40:43], v[8:11]
    ds_read_b64_tr_b16 v[56:57], v4 offset:33792
    v_mfma_f32_16x16x32_bf16 v[12:15], v[204:207], v[40:43], v[12:15]
    ds_read_b64_tr_b16 v[58:59], v4 offset:34304
    s_waitcnt lgkmcnt(6)
    v_mfma_f32_16x16x32_bf16 v[16:19], v[200:203], v[44:47], v[16:19]
    ds_read_b64_tr_b16 v[60:61], v4 offset:37888
    v_mfma_f32_16x16x32_bf16 v[20:23], v[204:207], v[44:47], v[20:23]
    ds_read_b64_tr_b16 v[62:63], v4 offset:38400
    s_waitcnt lgkmcnt(6)
    v_mfma_f32_16x16x32_bf16 v[24:27], v[200:203], v[48:51], v[24:27]
    ds_read_b64_tr_b16 v[64:65], v4 offset:41984
    v_mfma_f32_16x16x32_bf16 v[28:31], v[204:207], v[48:51], v[28:31]
    ds_read_b64_tr_b16 v[66:67], v4 offset:42496
    s_waitcnt lgkmcnt(6)
    v_mfma_f32_16x16x32_bf16 v[32:35], v[200:203], v[52:55], v[32:35]
    ds_read_b64_tr_b16 v[68:69], v4 offset:46080
    v_mfma_f32_16x16x32_bf16 v[36:39], v[204:207], v[52:55], v[36:39]
    ds_read_b64_tr_b16 v[70:71], v4 offset:46592
    s_waitcnt lgkmcnt(6)
    v_mfma_f32_16x16x32_bf16 v[8:11], v[208:211], v[56:59], v[8:11]
    s_barrier
    ds_read_b64_tr_b16 v[40:41], v3 offset:32768
    v_mfma_f32_16x16x32_bf16 v[12:15], v[212:215], v[56:59], v[12:15]
    ds_read_b64_tr_b16 v[42:43], v3 offset:33280
    s_waitcnt lgkmcnt(6)
    v_mfma_f32_16x16x32_bf16 v[16:19], v[208:211], v[60:63], v[16:19]
    ds_read_b64_tr_b16 v[44:45], v3 offset:36864
    v_mfma_f32_16x16x32_bf16 v[20:23], v[212:215], v[60:63], v[20:23]
    ds_read_b64_tr_b16 v[46:47], v3 offset:37376
    s_waitcnt lgkmcnt(6)
    v_mfma_f32_16x16x32_bf16 v[24:27], v[208:211], v[64:67], v[24:27]
    ds_read_b64_tr_b16 v[48:49], v3 offset:40960
    v_mfma_f32_16x16x32_bf16 v[28:31], v[212:215], v[64:67], v[28:31]
    ds_read_b64_tr_b16 v[50:51], v3 offset:41472
    s_waitcnt lgkmcnt(6)
    v_mfma_f32_16x16x32_bf16 v[32:35], v[208:211], v[68:71], v[32:35]
    ds_read_b64_tr_b16 v[52:53], v3 offset:45056
    v_mfma_f32_16x16x32_bf16 v[36:39], v[212:215], v[68:71], v[36:39]
    ds_read_b64_tr_b16 v[54:55], v3 offset:45568
    s_waitcnt lgkmcnt(6)
    v_mfma_f32_16x16x32_bf16 v[8:11], v[216:219], v[40:43], v[8:11]
    ds_read_b64_tr_b16 v[56:57], v3 offset:33792
    v_mfma_f32_16x16x32_bf16 v[12:15], v[220:223], v[40:43], v[12:15]
    ds_read_b64_tr_b16 v[58:59], v3 offset:34304
    s_waitcnt lgkmcnt(6)
    v_mfma_f32_16x16x32_bf16 v[16:19], v[216:219], v[44:47], v[16:19]
    ds_read_b64_tr_b16 v[60:61], v3 offset:37888
    v_mfma_f32_16x16x32_bf16 v[20:23], v[220:223], v[44:47], v[20:23]
    ds_read_b64_tr_b16 v[62:63], v3 offset:38400
    s_waitcnt lgkmcnt(6)
    v_mfma_f32_16x16x32_bf16 v[24:27], v[216:219], v[48:51], v[24:27]
    ds_read_b64_tr_b16 v[64:65], v3 offset:41984
    v_mfma_f32_16x16x32_bf16 v[28:31], v[220:223], v[48:51], v[28:31]
    ds_read_b64_tr_b16 v[66:67], v3 offset:42496
    s_waitcnt lgkmcnt(6)
    v_mfma_f32_16x16x32_bf16 v[32:35], v[216:219], v[52:55], v[32:35]
    ds_read_b64_tr_b16 v[68:69], v3 offset:46080
    v_mfma_f32_16x16x32_bf16 v[36:39], v[220:223], v[52:55], v[36:39]
    ds_read_b64_tr_b16 v[70:71], v3 offset:46592
    s_waitcnt lgkmcnt(6)
    v_mfma_f32_16x16x32_bf16 v[8:11], v[224:227], v[56:59], v[8:11]
    s_barrier
    ds_read_b64_tr_b16 v[40:41], v4 offset:49152
    v_mfma_f32_16x16x32_bf16 v[12:15], v[228:231], v[56:59], v[12:15]
    ds_read_b64_tr_b16 v[42:43], v4 offset:49664
    s_waitcnt lgkmcnt(6)
    v_mfma_f32_16x16x32_bf16 v[16:19], v[224:227], v[60:63], v[16:19]
    ds_read_b64_tr_b16 v[44:45], v4 offset:53248
    v_mfma_f32_16x16x32_bf16 v[20:23], v[228:231], v[60:63], v[20:23]
    ds_read_b64_tr_b16 v[46:47], v4 offset:53760
    s_waitcnt lgkmcnt(6)
    v_mfma_f32_16x16x32_bf16 v[24:27], v[224:227], v[64:67], v[24:27]
    ds_read_b64_tr_b16 v[48:49], v4 offset:57344
    v_mfma_f32_16x16x32_bf16 v[28:31], v[228:231], v[64:67], v[28:31]
    ds_read_b64_tr_b16 v[50:51], v4 offset:57856
    s_waitcnt lgkmcnt(6)
    v_mfma_f32_16x16x32_bf16 v[32:35], v[224:227], v[68:71], v[32:35]
    ds_read_b64_tr_b16 v[52:53], v4 offset:61440
    v_mfma_f32_16x16x32_bf16 v[36:39], v[228:231], v[68:71], v[36:39]
    ds_read_b64_tr_b16 v[54:55], v4 offset:61952
    s_waitcnt lgkmcnt(6)
    v_mfma_f32_16x16x32_bf16 v[8:11], v[232:235], v[40:43], v[8:11]
    ds_read_b64_tr_b16 v[56:57], v4 offset:50176
    v_mfma_f32_16x16x32_bf16 v[12:15], v[236:239], v[40:43], v[12:15]
    ds_read_b64_tr_b16 v[58:59], v4 offset:50688
    s_waitcnt lgkmcnt(6)
    v_mfma_f32_16x16x32_bf16 v[16:19], v[232:235], v[44:47], v[16:19]
    ds_read_b64_tr_b16 v[60:61], v4 offset:54272
    v_mfma_f32_16x16x32_bf16 v[20:23], v[236:239], v[44:47], v[20:23]
    ds_read_b64_tr_b16 v[62:63], v4 offset:54784
    s_waitcnt lgkmcnt(6)
    v_mfma_f32_16x16x32_bf16 v[24:27], v[232:235], v[48:51], v[24:27]
    ds_read_b64_tr_b16 v[64:65], v4 offset:58368
    v_mfma_f32_16x16x32_bf16 v[28:31], v[236:239], v[48:51], v[28:31]
    ds_read_b64_tr_b16 v[66:67], v4 offset:58880
    s_waitcnt lgkmcnt(6)
    v_mfma_f32_16x16x32_bf16 v[32:35], v[232:235], v[52:55], v[32:35]
    ds_read_b64_tr_b16 v[68:69], v4 offset:62464
    v_mfma_f32_16x16x32_bf16 v[36:39], v[236:239], v[52:55], v[36:39]
    ds_read_b64_tr_b16 v[70:71], v4 offset:62976
    s_waitcnt lgkmcnt(6)
    v_mfma_f32_16x16x32_bf16 v[8:11], v[240:243], v[56:59], v[8:11]
    s_barrier
    ds_read_b64_tr_b16 v[40:41], v3 offset:49152
    v_mfma_f32_16x16x32_bf16 v[12:15], v[244:247], v[56:59], v[12:15]
    ds_read_b64_tr_b16 v[42:43], v3 offset:49664
    s_waitcnt lgkmcnt(6)
    v_mfma_f32_16x16x32_bf16 v[16:19], v[240:243], v[60:63], v[16:19]
    ds_read_b64_tr_b16 v[44:45], v3 offset:53248
    v_mfma_f32_16x16x32_bf16 v[20:23], v[244:247], v[60:63], v[20:23]
    ds_read_b64_tr_b16 v[46:47], v3 offset:53760
    s_waitcnt lgkmcnt(6)
    v_mfma_f32_16x16x32_bf16 v[24:27], v[240:243], v[64:67], v[24:27]
    ds_read_b64_tr_b16 v[48:49], v3 offset:57344
    v_mfma_f32_16x16x32_bf16 v[28:31], v[244:247], v[64:67], v[28:31]
    ds_read_b64_tr_b16 v[50:51], v3 offset:57856
    s_waitcnt lgkmcnt(6)
    v_mfma_f32_16x16x32_bf16 v[32:35], v[240:243], v[68:71], v[32:35]
    ds_read_b64_tr_b16 v[52:53], v3 offset:61440
    v_mfma_f32_16x16x32_bf16 v[36:39], v[244:247], v[68:71], v[36:39]
    ds_read_b64_tr_b16 v[54:55], v3 offset:61952
    s_waitcnt lgkmcnt(6)
    v_mfma_f32_16x16x32_bf16 v[8:11], v[248:251], v[40:43], v[8:11]
    ds_read_b64_tr_b16 v[56:57], v3 offset:50176
    v_mfma_f32_16x16x32_bf16 v[12:15], v[252:255], v[40:43], v[12:15]
    ds_read_b64_tr_b16 v[58:59], v3 offset:50688
    s_waitcnt lgkmcnt(6)
    v_mfma_f32_16x16x32_bf16 v[16:19], v[248:251], v[44:47], v[16:19]
    ds_read_b64_tr_b16 v[60:61], v3 offset:54272
    v_mfma_f32_16x16x32_bf16 v[20:23], v[252:255], v[44:47], v[20:23]
    ds_read_b64_tr_b16 v[62:63], v3 offset:54784
    s_waitcnt lgkmcnt(6)
    v_mfma_f32_16x16x32_bf16 v[24:27], v[248:251], v[48:51], v[24:27]
    ds_read_b64_tr_b16 v[64:65], v3 offset:58368
    v_mfma_f32_16x16x32_bf16 v[28:31], v[252:255], v[48:51], v[28:31]
    ds_read_b64_tr_b16 v[66:67], v3 offset:58880
    s_waitcnt lgkmcnt(6)
    v_mfma_f32_16x16x32_bf16 v[32:35], v[248:251], v[52:55], v[32:35]
    ds_read_b64_tr_b16 v[68:69], v3 offset:62464
    v_mfma_f32_16x16x32_bf16 v[36:39], v[252:255], v[52:55], v[36:39]
    ds_read_b64_tr_b16 v[70:71], v3 offset:62976
    s_waitcnt lgkmcnt(6)
    v_mfma_f32_16x16x32_bf16 v[8:11], v[72:75], v[56:59], v[8:11]
    s_barrier
    ds_read_b64_tr_b16 v[40:41], v6 offset:0
    v_mfma_f32_16x16x32_bf16 v[12:15], v[76:79], v[56:59], v[12:15]
    ds_read_b64_tr_b16 v[42:43], v6 offset:512
    s_waitcnt lgkmcnt(6)
    v_mfma_f32_16x16x32_bf16 v[16:19], v[72:75], v[60:63], v[16:19]
    ds_read_b64_tr_b16 v[44:45], v6 offset:4096
    v_mfma_f32_16x16x32_bf16 v[20:23], v[76:79], v[60:63], v[20:23]
    ds_read_b64_tr_b16 v[46:47], v6 offset:4608
    s_waitcnt lgkmcnt(6)
    v_mfma_f32_16x16x32_bf16 v[24:27], v[72:75], v[64:67], v[24:27]
    ds_read_b64_tr_b16 v[48:49], v6 offset:8192
    v_mfma_f32_16x16x32_bf16 v[28:31], v[76:79], v[64:67], v[28:31]
    ds_read_b64_tr_b16 v[50:51], v6 offset:8704
    s_waitcnt lgkmcnt(6)
    v_mfma_f32_16x16x32_bf16 v[32:35], v[72:75], v[68:71], v[32:35]
    ds_read_b64_tr_b16 v[52:53], v6 offset:12288
    v_mfma_f32_16x16x32_bf16 v[36:39], v[76:79], v[68:71], v[36:39]
    ds_read_b64_tr_b16 v[54:55], v6 offset:12800
    s_waitcnt lgkmcnt(6)
    v_mfma_f32_16x16x32_bf16 v[8:11], v[80:83], v[40:43], v[8:11]
    ds_read_b64_tr_b16 v[56:57], v6 offset:1024
    v_mfma_f32_16x16x32_bf16 v[12:15], v[84:87], v[40:43], v[12:15]
    ds_read_b64_tr_b16 v[58:59], v6 offset:1536
    s_waitcnt lgkmcnt(6)
    v_mfma_f32_16x16x32_bf16 v[16:19], v[80:83], v[44:47], v[16:19]
    ds_read_b64_tr_b16 v[60:61], v6 offset:5120
    v_mfma_f32_16x16x32_bf16 v[20:23], v[84:87], v[44:47], v[20:23]
    ds_read_b64_tr_b16 v[62:63], v6 offset:5632
    s_waitcnt lgkmcnt(6)
    v_mfma_f32_16x16x32_bf16 v[24:27], v[80:83], v[48:51], v[24:27]
    ds_read_b64_tr_b16 v[64:65], v6 offset:9216
    v_mfma_f32_16x16x32_bf16 v[28:31], v[84:87], v[48:51], v[28:31]
    ds_read_b64_tr_b16 v[66:67], v6 offset:9728
    s_waitcnt lgkmcnt(6)
    v_mfma_f32_16x16x32_bf16 v[32:35], v[80:83], v[52:55], v[32:35]
    ds_read_b64_tr_b16 v[68:69], v6 offset:13312
    v_mfma_f32_16x16x32_bf16 v[36:39], v[84:87], v[52:55], v[36:39]
    ds_read_b64_tr_b16 v[70:71], v6 offset:13824
    s_waitcnt lgkmcnt(6)
    v_mfma_f32_16x16x32_bf16 v[8:11], v[88:91], v[56:59], v[8:11]
    s_barrier
    ds_read_b64_tr_b16 v[40:41], v4 offset:0
    v_mfma_f32_16x16x32_bf16 v[12:15], v[92:95], v[56:59], v[12:15]
    ds_read_b64_tr_b16 v[42:43], v4 offset:512
    s_waitcnt lgkmcnt(6)
    v_mfma_f32_16x16x32_bf16 v[16:19], v[88:91], v[60:63], v[16:19]
    ds_read_b64_tr_b16 v[44:45], v4 offset:4096
    v_mfma_f32_16x16x32_bf16 v[20:23], v[92:95], v[60:63], v[20:23]
    ds_read_b64_tr_b16 v[46:47], v4 offset:4608
    s_waitcnt lgkmcnt(6)
    v_mfma_f32_16x16x32_bf16 v[24:27], v[88:91], v[64:67], v[24:27]
    ds_read_b64_tr_b16 v[48:49], v4 offset:8192
    v_mfma_f32_16x16x32_bf16 v[28:31], v[92:95], v[64:67], v[28:31]
    ds_read_b64_tr_b16 v[50:51], v4 offset:8704
    s_waitcnt lgkmcnt(6)
    v_mfma_f32_16x16x32_bf16 v[32:35], v[88:91], v[68:71], v[32:35]
    ds_read_b64_tr_b16 v[52:53], v4 offset:12288
    v_mfma_f32_16x16x32_bf16 v[36:39], v[92:95], v[68:71], v[36:39]
    ds_read_b64_tr_b16 v[54:55], v4 offset:12800
    s_waitcnt lgkmcnt(6)
    v_mfma_f32_16x16x32_bf16 v[8:11], v[96:99], v[40:43], v[8:11]
    ds_read_b64_tr_b16 v[56:57], v4 offset:1024
    v_mfma_f32_16x16x32_bf16 v[12:15], v[100:103], v[40:43], v[12:15]
    ds_read_b64_tr_b16 v[58:59], v4 offset:1536
    s_waitcnt lgkmcnt(6)
    v_mfma_f32_16x16x32_bf16 v[16:19], v[96:99], v[44:47], v[16:19]
    ds_read_b64_tr_b16 v[60:61], v4 offset:5120
    v_mfma_f32_16x16x32_bf16 v[20:23], v[100:103], v[44:47], v[20:23]
    ds_read_b64_tr_b16 v[62:63], v4 offset:5632
    s_waitcnt lgkmcnt(6)
    v_mfma_f32_16x16x32_bf16 v[24:27], v[96:99], v[48:51], v[24:27]
    ds_read_b64_tr_b16 v[64:65], v4 offset:9216
    v_mfma_f32_16x16x32_bf16 v[28:31], v[100:103], v[48:51], v[28:31]
    ds_read_b64_tr_b16 v[66:67], v4 offset:9728
    s_waitcnt lgkmcnt(6)
    v_mfma_f32_16x16x32_bf16 v[32:35], v[96:99], v[52:55], v[32:35]
    ds_read_b64_tr_b16 v[68:69], v4 offset:13312
    v_mfma_f32_16x16x32_bf16 v[36:39], v[100:103], v[52:55], v[36:39]
    ds_read_b64_tr_b16 v[70:71], v4 offset:13824
    v_add_u32 v200, s73, v2
    v_add_u32 v201, s74, v2
    s_waitcnt lgkmcnt(6)
    v_mfma_f32_16x16x32_bf16 v[8:11], v[104:107], v[56:59], v[8:11]
    s_barrier
    ds_read_b64_tr_b16 v[40:41], v3 offset:0
    v_mfma_f32_16x16x32_bf16 v[12:15], v[108:111], v[56:59], v[12:15]
    ds_read_b64_tr_b16 v[42:43], v3 offset:512
    s_waitcnt lgkmcnt(6)
    v_mfma_f32_16x16x32_bf16 v[16:19], v[104:107], v[60:63], v[16:19]
    ds_read_b64_tr_b16 v[44:45], v3 offset:4096
    v_mfma_f32_16x16x32_bf16 v[20:23], v[108:111], v[60:63], v[20:23]
    ds_read_b64_tr_b16 v[46:47], v3 offset:4608
    s_waitcnt lgkmcnt(6)
    v_mfma_f32_16x16x32_bf16 v[24:27], v[104:107], v[64:67], v[24:27]
    ds_read_b64_tr_b16 v[48:49], v3 offset:8192
    v_mfma_f32_16x16x32_bf16 v[28:31], v[108:111], v[64:67], v[28:31]
    ds_read_b64_tr_b16 v[50:51], v3 offset:8704
    s_waitcnt lgkmcnt(6)
    v_mfma_f32_16x16x32_bf16 v[32:35], v[104:107], v[68:71], v[32:35]
    ds_read_b64_tr_b16 v[52:53], v3 offset:12288
    v_mfma_f32_16x16x32_bf16 v[36:39], v[108:111], v[68:71], v[36:39]
    ds_read_b64_tr_b16 v[54:55], v3 offset:12800
    s_waitcnt lgkmcnt(6)
    v_mfma_f32_16x16x32_bf16 v[8:11], v[112:115], v[40:43], v[8:11]
    ds_read_b64_tr_b16 v[56:57], v3 offset:1024
    v_mfma_f32_16x16x32_bf16 v[12:15], v[116:119], v[40:43], v[12:15]
    ds_read_b64_tr_b16 v[58:59], v3 offset:1536
    s_waitcnt lgkmcnt(6)
    v_mfma_f32_16x16x32_bf16 v[16:19], v[112:115], v[44:47], v[16:19]
    ds_read_b64_tr_b16 v[60:61], v3 offset:5120
    v_mfma_f32_16x16x32_bf16 v[20:23], v[116:119], v[44:47], v[20:23]
    ds_read_b64_tr_b16 v[62:63], v3 offset:5632
    s_waitcnt lgkmcnt(6)
    v_mfma_f32_16x16x32_bf16 v[24:27], v[112:115], v[48:51], v[24:27]
    ds_read_b64_tr_b16 v[64:65], v3 offset:9216
    v_mfma_f32_16x16x32_bf16 v[28:31], v[116:119], v[48:51], v[28:31]
    ds_read_b64_tr_b16 v[66:67], v3 offset:9728
    s_waitcnt lgkmcnt(6)
    v_mfma_f32_16x16x32_bf16 v[32:35], v[112:115], v[52:55], v[32:35]
    ds_read_b64_tr_b16 v[68:69], v3 offset:13312
    v_mfma_f32_16x16x32_bf16 v[36:39], v[116:119], v[52:55], v[36:39]
    ds_read_b64_tr_b16 v[70:71], v3 offset:13824
    v_mov_b32 v202, s20
    v_mov_b32 v203, s20
    s_waitcnt lgkmcnt(6)
    v_mfma_f32_16x16x32_bf16 v[8:11], v[120:123], v[56:59], v[8:11]
    s_barrier
    ds_read_b64_tr_b16 v[40:41], v4 offset:16384
    v_mfma_f32_16x16x32_bf16 v[12:15], v[124:127], v[56:59], v[12:15]
    ds_read_b64_tr_b16 v[42:43], v4 offset:16896
    s_waitcnt lgkmcnt(6)
    v_mfma_f32_16x16x32_bf16 v[16:19], v[120:123], v[60:63], v[16:19]
    ds_read_b64_tr_b16 v[44:45], v4 offset:20480
    v_mfma_f32_16x16x32_bf16 v[20:23], v[124:127], v[60:63], v[20:23]
    ds_read_b64_tr_b16 v[46:47], v4 offset:20992
    s_waitcnt lgkmcnt(6)
    v_mfma_f32_16x16x32_bf16 v[24:27], v[120:123], v[64:67], v[24:27]
    ds_read_b64_tr_b16 v[48:49], v4 offset:24576
    v_mfma_f32_16x16x32_bf16 v[28:31], v[124:127], v[64:67], v[28:31]
    ds_read_b64_tr_b16 v[50:51], v4 offset:25088
    s_waitcnt lgkmcnt(6)
    v_mfma_f32_16x16x32_bf16 v[32:35], v[120:123], v[68:71], v[32:35]
    ds_read_b64_tr_b16 v[52:53], v4 offset:28672
    v_mfma_f32_16x16x32_bf16 v[36:39], v[124:127], v[68:71], v[36:39]
    ds_read_b64_tr_b16 v[54:55], v4 offset:29184
    s_waitcnt lgkmcnt(6)
    v_mfma_f32_16x16x32_bf16 v[8:11], v[128:131], v[40:43], v[8:11]
    ds_read_b64_tr_b16 v[56:57], v4 offset:17408
    v_mfma_f32_16x16x32_bf16 v[12:15], v[132:135], v[40:43], v[12:15]
    ds_read_b64_tr_b16 v[58:59], v4 offset:17920
    s_waitcnt lgkmcnt(6)
    v_mfma_f32_16x16x32_bf16 v[16:19], v[128:131], v[44:47], v[16:19]
    ds_read_b64_tr_b16 v[60:61], v4 offset:21504
    v_mfma_f32_16x16x32_bf16 v[20:23], v[132:135], v[44:47], v[20:23]
    ds_read_b64_tr_b16 v[62:63], v4 offset:22016
    s_waitcnt lgkmcnt(6)
    v_mfma_f32_16x16x32_bf16 v[24:27], v[128:131], v[48:51], v[24:27]
    ds_read_b64_tr_b16 v[64:65], v4 offset:25600
    v_mfma_f32_16x16x32_bf16 v[28:31], v[132:135], v[48:51], v[28:31]
    ds_read_b64_tr_b16 v[66:67], v4 offset:26112
    s_waitcnt lgkmcnt(6)
    v_mfma_f32_16x16x32_bf16 v[32:35], v[128:131], v[52:55], v[32:35]
    ds_read_b64_tr_b16 v[68:69], v4 offset:29696
    v_mfma_f32_16x16x32_bf16 v[36:39], v[132:135], v[52:55], v[36:39]
    ds_read_b64_tr_b16 v[70:71], v4 offset:30208
    s_cmp_eq_u32 s57, 0
    s_setprio 3
    s_waitcnt lgkmcnt(0)
    s_cbranch_scc1 L_dk0
    v_mfma_f32_16x16x32_bf16 v[8:11], v[136:139], v[56:59], v[8:11]
    v_mfma_f32_16x16x32_bf16 v[12:15], v[140:143], v[56:59], v[12:15]
    v_mfma_f32_16x16x32_bf16 v[16:19], v[136:139], v[60:63], v[16:19]
    v_mfma_f32_16x16x32_bf16 v[20:23], v[140:143], v[60:63], v[20:23]
    v_mfma_f32_16x16x32_bf16 v[24:27], v[136:139], v[64:67], v[24:27]
    v_mfma_f32_16x16x32_bf16 v[28:31], v[140:143], v[64:67], v[28:31]
    v_mfma_f32_16x16x32_bf16 v[32:35], v[136:139], v[68:71], v[32:35]
    v_mfma_f32_16x16x32_bf16 v[36:39], v[140:143], v[68:71], v[36:39]
    s_nop 0
    ds_write_b128 v200, v[8:11] offset:0
    ds_write_b128 v200, v[12:15] offset:1024
    ds_write_b128 v200, v[16:19] offset:2048
    ds_write_b128 v200, v[20:23] offset:3072
L_dx1:
    s_waitcnt lgkmcnt(0)
    s_barrier
    ds_read_b128 v[40:43], v201 offset:0
    ds_read_b128 v[44:47], v201 offset:1024
    ds_read_b128 v[48:51], v201 offset:2048
    ds_read_b128 v[52:55], v201 offset:3072
    v_lshlrev_b32 v204, 2, v1
    v_mov_b32 v205, s55
    s_mov_b32 exec_hi, 0
    buffer_store_dword v205, v204, s[12:15], s72 offen sc0 sc1
    s_mov_b32 exec_hi, -1
    s_waitcnt lgkmcnt(3)
    v_pk_add_f32 v[208:209], v[24:25], v[40:41]
    v_pk_add_f32 v[210:211], v[26:27], v[42:43]
    s_waitcnt lgkmcnt(2)
    v_pk_add_f32 v[212:213], v[28:29], v[44:45]
    v_pk_add_f32 v[214:215], v[30:31], v[46:47]
    s_waitcnt lgkmcnt(1)
    v_pk_add_f32 v[216:217], v[32:33], v[48:49]
    v_pk_add_f32 v[218:219], v[34:35], v[50:51]
    s_waitcnt lgkmcnt(0)
    v_pk_add_f32 v[220:221], v[36:37], v[52:53]
    v_pk_add_f32 v[222:223], v[38:39], v[54:55]
    s_branch L_dkd
L_dk0:
    v_mfma_f32_16x16x32_bf16 v[24:27], v[136:139], v[64:67], v[24:27]
    v_mfma_f32_16x16x32_bf16 v[28:31], v[140:143], v[64:67], v[28:31]
    v_mfma_f32_16x16x32_bf16 v[32:35], v[136:139], v[68:71], v[32:35]
    v_mfma_f32_16x16x32_bf16 v[36:39], v[140:143], v[68:71], v[36:39]
    v_mfma_f32_16x16x32_bf16 v[8:11], v[136:139], v[56:59], v[8:11]
    v_mfma_f32_16x16x32_bf16 v[12:15], v[140:143], v[56:59], v[12:15]
    v_mfma_f32_16x16x32_bf16 v[16:19], v[136:139], v[60:63], v[16:19]
    v_mfma_f32_16x16x32_bf16 v[20:23], v[140:143], v[60:63], v[20:23]
    s_nop 0
    ds_write_b128 v200, v[24:27] offset:0
    ds_write_b128 v200, v[28:31] offset:1024
    ds_write_b128 v200, v[32:35] offset:2048
    ds_write_b128 v200, v[36:39] offset:3072
L_dx0:
    s_waitcnt lgkmcnt(0)
    s_barrier
    ds_read_b128 v[40:43], v201 offset:0
    ds_read_b128 v[44:47], v201 offset:1024
    ds_read_b128 v[48:51], v201 offset:2048
    ds_read_b128 v[52:55], v201 offset:3072
    v_lshlrev_b32 v204, 2, v1
    v_mov_b32 v205, s55
    s_mov_b32 exec_hi, 0
    buffer_store_dword v205, v204, s[12:15], s72 offen sc0 sc1
    s_mov_b32 exec_hi, -1
    s_waitcnt lgkmcnt(3)
    v_pk_add_f32 v[208:209], v[8:9], v[40:41]
    v_pk_add_f32 v[210:211], v[10:11], v[42:43]
    s_waitcnt lgkmcnt(2)
    v_pk_add_f32 v[212:213], v[12:13], v[44:45]
    v_pk_add_f32 v[214:215], v[14:15], v[46:47]
    s_waitcnt lgkmcnt(1)
    v_pk_add_f32 v[216:217], v[16:17], v[48:49]
    v_pk_add_f32 v[218:219], v[18:19], v[50:51]
    s_waitcnt lgkmcnt(0)
    v_pk_add_f32 v[220:221], v[20:21], v[52:53]
    v_pk_add_f32 v[222:223], v[22:23], v[54:55]
L_dkd:
    v_pk_mul_f32 v[224:225], v[208:209], v[208:209]
    v_pk_mul_f32 v[226:227], v[210:211], v[210:211]
    v_pk_mul_f32 v[228:229], v[212:213], v[212:213]
    v_pk_mul_f32 v[230:231], v[214:215], v[214:215]
    v_pk_fma_f32 v[224:225], v[224:225], s[22:23], v[202:203]
    v_pk_fma_f32 v[226:227], v[226:227], s[22:23], v[202:203]
    v_pk_fma_f32 v[228:229], v[228:229], s[22:23], v[202:203]
    v_pk_fma_f32 v[230:231], v[230:231], s[22:23], v[202:203]
    v_pk_mul_f32 v[224:225], v[224:225], v[208:209]
    v_pk_mul_f32 v[226:227], v[226:227], v[210:211]
    v_pk_mul_f32 v[228:229], v[228:229], v[212:213]
    v_pk_mul_f32 v[230:231], v[230:231], v[214:215]
    v_exp_f32 v224, v224
    v_exp_f32 v225, v225
    v_exp_f32 v226, v226
    v_exp_f32 v227, v227
    v_exp_f32 v228, v228
    v_exp_f32 v229, v229
    v_exp_f32 v230, v230
    v_exp_f32 v231, v231
    v_pk_add_f32 v[224:225], v[224:225], 1.0 op_sel_hi:[1,0]
    v_pk_add_f32 v[226:227], v[226:227], 1.0 op_sel_hi:[1,0]
    v_pk_add_f32 v[228:229], v[228:229], 1.0 op_sel_hi:[1,0]
    v_pk_add_f32 v[230:231], v[230:231], 1.0 op_sel_hi:[1,0]
    v_rcp_f32 v224, v224
    v_rcp_f32 v225, v225
    v_rcp_f32 v226, v226
    v_rcp_f32 v227, v227
    v_rcp_f32 v228, v228
    v_rcp_f32 v229, v229
    v_rcp_f32 v230, v230
    v_rcp_f32 v231, v231
    v_pk_mul_f32 v[224:225], v[224:225], v[208:209]
    v_pk_mul_f32 v[226:227], v[226:227], v[210:211]
    v_pk_mul_f32 v[228:229], v[228:229], v[212:213]
    v_pk_mul_f32 v[230:231], v[230:231], v[214:215]
    v_cvt_pk_bf16_f32 v60, v224, v225
    v_cvt_pk_bf16_f32 v61, v226, v227
    v_cvt_pk_bf16_f32 v62, v228, v229
    v_cvt_pk_bf16_f32 v63, v230, v231
    buffer_store_dwordx4 v[60:63], v2, s[12:15], s70 offen sc0 sc1
    v_pk_mul_f32 v[232:233], v[216:217], v[216:217]
    v_pk_mul_f32 v[234:235], v[218:219], v[218:219]
    v_pk_mul_f32 v[236:237], v[220:221], v[220:221]
    v_pk_mul_f32 v[238:239], v[222:223], v[222:223]
    v_pk_fma_f32 v[232:233], v[232:233], s[22:23], v[202:203]
    v_pk_fma_f32 v[234:235], v[234:235], s[22:23], v[202:203]
    v_pk_fma_f32 v[236:237], v[236:237], s[22:23], v[202:203]
    v_pk_fma_f32 v[238:239], v[238:239], s[22:23], v[202:203]
    v_pk_mul_f32 v[232:233], v[232:233], v[216:217]
    v_pk_mul_f32 v[234:235], v[234:235], v[218:219]
    v_pk_mul_f32 v[236:237], v[236:237], v[220:221]
    v_pk_mul_f32 v[238:239], v[238:239], v[222:223]
    v_exp_f32 v232, v232
    v_exp_f32 v233, v233
    v_exp_f32 v234, v234
    v_exp_f32 v235, v235
    v_exp_f32 v236, v236
    v_exp_f32 v237, v237
    v_exp_f32 v238, v238
    v_exp_f32 v239, v239
    v_pk_add_f32 v[232:233], v[232:233], 1.0 op_sel_hi:[1,0]
    v_pk_add_f32 v[234:235], v[234:235], 1.0 op_sel_hi:[1,0]
    v_pk_add_f32 v[236:237], v[236:237], 1.0 op_sel_hi:[1,0]
    v_pk_add_f32 v[238:239], v[238:239], 1.0 op_sel_hi:[1,0]
    v_rcp_f32 v232, v232
    v_rcp_f32 v233, v233
    v_rcp_f32 v234, v234
    v_rcp_f32 v235, v235
    v_rcp_f32 v236, v236
    v_rcp_f32 v237, v237
    v_rcp_f32 v238, v238
    v_rcp_f32 v239, v239
    v_pk_mul_f32 v[232:233], v[232:233], v[216:217]
    v_pk_mul_f32 v[234:235], v[234:235], v[218:219]
    v_pk_mul_f32 v[236:237], v[236:237], v[220:221]
    v_pk_mul_f32 v[238:239], v[238:239], v[222:223]
    v_cvt_pk_bf16_f32 v64, v232, v233
    v_cvt_pk_bf16_f32 v65, v234, v235
    v_cvt_pk_bf16_f32 v66, v236, v237
    v_cvt_pk_bf16_f32 v67, v238, v239
    buffer_store_dwordx4 v[64:67], v2, s[12:15], s71 offen sc0 sc1
L_Xe:
    s_cmp_lg_u32 s18, 0
    s_cbranch_scc1 L_Xnp
    s_mul_i32 s27, s17, 5
    s_lshr_b32 s27, s27, 2
    s_mul_i32 s27, s27, 3072
    s_add_u32 s27, s27, 16777216
    v_min_u32 v3, 47, v1
    v_lshlrev_b32 v3, 7, v3
    v_add_u32 v3, s27, v3
    s_sleep 6
    s_mov_b32 s33, 32768
L_pl5:
    buffer_load_dword v4, v3, s[12:15], 0 offen sc1
    s_sub_u32 s33, s33, 1
    s_waitcnt vmcnt(0)
    v_cmp_ne_u32 vcc, s55, v4
    s_cbranch_vccz L_pg5
    s_cmp_lt_i32 s33, 1
    s_cbranch_scc1 L_pg5
    s_sleep 3
    s_branch L_pl5
L_pg5:
L_Xnp:
    s_mul_i32 s29, s17, 245760
    s_add_u32 s29, s29, 13107200
    s_lshl_b32 s27, s18, 10
    s_add_u32 s30, s29, s27
    s_add_u32 s30, s30, 196608
    s_add_u32 s28, s27, 16384
    s_mul_i32 s27, s18, 49152
    s_add_u32 s29, s29, s27
    s_lshl_b32 s27, s18, 12
    s_mov_b32 s70, s68
    s_add_u32 s71, s70, 12288
    s_cmp_eq_u32 s71, 49152
    s_cselect_b32 s71, 0, s71
    s_add_u32 s72, s71, 12288
    s_cmp_eq_u32 s72, 49152
    s_cselect_b32 s72, 0, s72
    s_add_u32 s73, s72, 12288
    s_cmp_eq_u32 s73, 49152
    s_cselect_b32 s73, 0, s73
    v_bfe_u32 v42, v1, 1, 4
    v_lshlrev_b32 v42, 2, v42
    v_lshl_add_u32 v44, v1, 6, v42
    v_and_b32 v47, 1023, v44
    v_add_u32 v44, s27, v44
    v_add_u32 v45, 61440, v44
    v_add_u32 v46, 122880, v44
    v_add_u32 v47, s28, v47
    v_add_u32 v48, 61440, v47
    v_add_u32 v49, 122880, v47
    s_barrier
    s_mov_b32 s33, 32768
L_lers:
    s_add_u32 m0, s27, 0
    s_add_u32 s32, s29, 0
    buffer_load_dwordx4 v2, s[12:15], s32 offen offset:0 sc1 lds
    buffer_load_dwordx4 v2, s[12:15], s32 offen offset:1024 sc1 lds
    buffer_load_dwordx4 v2, s[12:15], s32 offen offset:2048 sc1 lds
    buffer_load_dwordx4 v2, s[12:15], s32 offen offset:3072 sc1 lds
    s_add_u32 m0, s28, 0
    s_add_u32 s32, s30, 0
    buffer_load_dwordx4 v2, s[12:15], s32 offen sc1 lds
    s_add_u32 m0, s27, 20480
    s_add_u32 s32, s29, 4096
    buffer_load_dwordx4 v2, s[12:15], s32 offen offset:0 sc1 lds
    buffer_load_dwordx4 v2, s[12:15], s32 offen offset:1024 sc1 lds
    buffer_load_dwordx4 v2, s[12:15], s32 offen offset:2048 sc1 lds
    buffer_load_dwordx4 v2, s[12:15], s32 offen offset:3072 sc1 lds
    s_add_u32 m0, s28, 20480
    s_add_u32 s32, s30, 4096
    buffer_load_dwordx4 v2, s[12:15], s32 offen sc1 lds
    s_add_u32 m0, s27, 40960
    s_add_u32 s32, s29, 8192
    buffer_load_dwordx4 v2, s[12:15], s32 offen offset:0 sc1 lds
    buffer_load_dwordx4 v2, s[12:15], s32 offen offset:1024 sc1 lds
    buffer_load_dwordx4 v2, s[12:15], s32 offen offset:2048 sc1 lds
    buffer_load_dwordx4 v2, s[12:15], s32 offen offset:3072 sc1 lds
    s_add_u32 m0, s28, 40960
    s_add_u32 s32, s30, 8192
    buffer_load_dwordx4 v2, s[12:15], s32 offen sc1 lds
    s_add_u32 m0, s27, 61440
    s_add_u32 s32, s29, 12288
    buffer_load_dwordx4 v2, s[12:15], s32 offen offset:0 sc1 lds
    buffer_load_dwordx4 v2, s[12:15], s32 offen offset:1024 sc1 lds
    buffer_load_dwordx4 v2, s[12:15], s32 offen offset:2048 sc1 lds
    buffer_load_dwordx4 v2, s[12:15], s32 offen offset:3072 sc1 lds
    s_add_u32 m0, s28, 61440
    s_add_u32 s32, s30, 12288
    buffer_load_dwordx4 v2, s[12:15], s32 offen sc1 lds
    s_waitcnt vmcnt(15)
    ds_read_b32 v40, v44 offset:0
    ds_read_b32 v41, v47 offset:0
L_lec0:
    s_waitcnt lgkmcnt(0)
    v_max_u32 v40, v40, v41
    v_cmp_eq_u32 vcc, -1, v40
    s_cbranch_vccnz L_ler0
L_lek0:
    s_barrier
    s_waitcnt vmcnt(10)
    ds_read_b32 v40, v44 offset:20480
    ds_read_b32 v41, v47 offset:20480
    s_add_u32 m0, s27, 81920
    s_add_u32 s32, s29, 16384
    buffer_load_dwordx4 v2, s[12:15], s32 offen offset:0 sc1 lds
    buffer_load_dwordx4 v2, s[12:15], s32 offen offset:1024 sc1 lds
    buffer_load_dwordx4 v2, s[12:15], s32 offen offset:2048 sc1 lds
    buffer_load_dwordx4 v2, s[12:15], s32 offen offset:3072 sc1 lds
    s_add_u32 m0, s28, 81920
    s_add_u32 s32, s30, 16384
    buffer_load_dwordx4 v2, s[12:15], s32 offen sc1 lds
L_lec1:
    s_waitcnt lgkmcnt(0)
    v_max_u32 v40, v40, v41
    v_cmp_eq_u32 vcc, -1, v40
    s_cbranch_vccnz L_ler1
L_lek1:
    s_barrier
    s_waitcnt vmcnt(10)
    ds_read_b32 v40, v44 offset:40960
    ds_read_b32 v41, v47 offset:40960
    s_add_u32 m0, s27, 143360
    s_add_u32 s32, s29, 20480
    buffer_load_dwordx4 v2, s[12:15], s32 offen offset:0 sc1 lds
    buffer_load_dwordx4 v2, s[12:15], s32 offen offset:1024 sc1 lds
    buffer_load_dwordx4 v2, s[12:15], s32 offen offset:2048 sc1 lds
    buffer_load_dwordx4 v2, s[12:15], s32 offen offset:3072 sc1 lds
    s_add_u32 m0, s28, 143360
    s_add_u32 s32, s30, 20480
    buffer_load_dwordx4 v2, s[12:15], s32 offen sc1 lds
L_lec2:
    s_waitcnt lgkmcnt(0)
    v_max_u32 v40, v40, v41
    v_cmp_eq_u32 vcc, -1, v40
    s_cbranch_vccnz L_ler2
L_lek2:
    s_barrier
    s_waitcnt vmcnt(10)
    ds_read_b32 v40, v45 offset:0
    ds_read_b32 v41, v48 offset:0
    s_add_u32 m0, s27, 0
    s_add_u32 s32, s29, 24576
    buffer_load_dwordx4 v2, s[12:15], s32 offen offset:0 sc1 lds
    buffer_load_dwordx4 v2, s[12:15], s32 offen offset:1024 sc1 lds
    buffer_load_dwordx4 v2, s[12:15], s32 offen offset:2048 sc1 lds
    buffer_load_dwordx4 v2, s[12:15], s32 offen offset:3072 sc1 lds
    s_add_u32 m0, s28, 0
    s_add_u32 s32, s30, 24576
    buffer_load_dwordx4 v2, s[12:15], s32 offen sc1 lds
L_lec3:
    s_waitcnt lgkmcnt(0)
    v_max_u32 v40, v40, v41
    v_cmp_eq_u32 vcc, -1, v40
    s_cbranch_vccnz L_ler3
L_lek3:
    s_barrier
    s_waitcnt vmcnt(10)
    ds_read_b32 v40, v45 offset:20480
    ds_read_b32 v41, v48 offset:20480
    s_add_u32 m0, s27, 20480
    s_add_u32 s32, s29, 28672
    buffer_load_dwordx4 v2, s[12:15], s32 offen offset:0 sc1 lds
    buffer_load_dwordx4 v2, s[12:15], s32 offen offset:1024 sc1 lds
    buffer_load_dwordx4 v2, s[12:15], s32 offen offset:2048 sc1 lds
    buffer_load_dwordx4 v2, s[12:15], s32 offen offset:3072 sc1 lds
    s_add_u32 m0, s28, 20480
    s_add_u32 s32, s30, 28672
    buffer_load_dwordx4 v2, s[12:15], s32 offen sc1 lds
L_lec4:
    s_waitcnt lgkmcnt(0)
    v_max_u32 v40, v40, v41
    v_cmp_eq_u32 vcc, -1, v40
    s_cbranch_vccnz L_ler4
L_lek4:
    s_barrier
    s_waitcnt vmcnt(10)
    ds_read_b32 v40, v46 offset:20480
    ds_read_b32 v41, v49 offset:20480
    s_add_u32 m0, s27, 40960
    s_add_u32 s32, s29, 32768
    buffer_load_dwordx4 v2, s[12:15], s32 offen offset:0 sc1 lds
    buffer_load_dwordx4 v2, s[12:15], s32 offen offset:1024 sc1 lds
    buffer_load_dwordx4 v2, s[12:15], s32 offen offset:2048 sc1 lds
    buffer_load_dwordx4 v2, s[12:15], s32 offen offset:3072 sc1 lds
    s_add_u32 m0, s28, 40960
    s_add_u32 s32, s30, 32768
    buffer_load_dwordx4 v2, s[12:15], s32 offen sc1 lds
L_lec5:
    s_waitcnt lgkmcnt(0)
    v_max_u32 v40, v40, v41
    v_cmp_eq_u32 vcc, -1, v40
    s_cbranch_vccnz L_ler5
L_lek5:
    s_barrier
    s_waitcnt vmcnt(10)
    ds_read_b32 v40, v44 offset:0
    ds_read_b32 v41, v47 offset:0
    s_add_u32 m0, s27, 102400
    s_add_u32 s32, s29, 36864
    buffer_load_dwordx4 v2, s[12:15], s32 offen offset:0 sc1 lds
    buffer_load_dwordx4 v2, s[12:15], s32 offen offset:1024 sc1 lds
    buffer_load_dwordx4 v2, s[12:15], s32 offen offset:2048 sc1 lds
    buffer_load_dwordx4 v2, s[12:15], s32 offen offset:3072 sc1 lds
    s_add_u32 m0, s28, 102400
    s_add_u32 s32, s30, 36864
    buffer_load_dwordx4 v2, s[12:15], s32 offen sc1 lds
L_lec6:
    s_waitcnt lgkmcnt(0)
    v_max_u32 v40, v40, v41
    v_cmp_eq_u32 vcc, -1, v40
    s_cbranch_vccnz L_ler6
L_lek6:
    s_barrier
    s_waitcnt vmcnt(10)
    ds_read_b32 v40, v44 offset:20480
    ds_read_b32 v41, v47 offset:20480
    s_add_u32 m0, s27, 122880
    s_add_u32 s32, s29, 40960
    buffer_load_dwordx4 v2, s[12:15], s32 offen offset:0 sc1 lds
    buffer_load_dwordx4 v2, s[12:15], s32 offen offset:1024 sc1 lds
    buffer_load_dwordx4 v2, s[12:15], s32 offen offset:2048 sc1 lds
    buffer_load_dwordx4 v2, s[12:15], s32 offen offset:3072 sc1 lds
    s_add_u32 m0, s28, 122880
    s_add_u32 s32, s30, 40960
    buffer_load_dwordx4 v2, s[12:15], s32 offen sc1 lds
L_lec7:
    s_waitcnt lgkmcnt(0)
    v_max_u32 v40, v40, v41
    v_cmp_eq_u32 vcc, -1, v40
    s_cbranch_vccnz L_ler7
L_lek7:
    s_barrier
    s_waitcnt vmcnt(10)
    ds_read_b32 v40, v44 offset:40960
    ds_read_b32 v41, v47 offset:40960
    s_add_u32 m0, s27, 61440
    s_add_u32 s32, s29, 45056
    buffer_load_dwordx4 v2, s[12:15], s32 offen offset:0 sc1 lds
    buffer_load_dwordx4 v2, s[12:15], s32 offen offset:1024 sc1 lds
    buffer_load_dwordx4 v2, s[12:15], s32 offen offset:2048 sc1 lds
    buffer_load_dwordx4 v2, s[12:15], s32 offen offset:3072 sc1 lds
    s_add_u32 m0, s28, 61440
    s_add_u32 s32, s30, 45056
    buffer_load_dwordx4 v2, s[12:15], s32 offen sc1 lds
L_lec8:
    s_waitcnt lgkmcnt(0)
    v_max_u32 v40, v40, v41
    v_cmp_eq_u32 vcc, -1, v40
    s_cbranch_vccnz L_ler8
L_lek8:
    s_barrier
    s_waitcnt vmcnt(10)
    ds_read_b32 v40, v45 offset:40960
    ds_read_b32 v41, v48 offset:40960
L_lec9:
    s_waitcnt lgkmcnt(0)
    v_max_u32 v40, v40, v41
    v_cmp_eq_u32 vcc, -1, v40
    s_cbranch_vccnz L_ler9
L_lek9:
    s_barrier
    s_waitcnt vmcnt(5)
    ds_read_b32 v40, v46 offset:0
    ds_read_b32 v41, v49 offset:0
L_lec10:
    s_waitcnt lgkmcnt(0)
    v_max_u32 v40, v40, v41
    v_cmp_eq_u32 vcc, -1, v40
    s_cbranch_vccnz L_ler10
L_lek10:
    s_barrier
    s_waitcnt vmcnt(0)
    ds_read_b32 v40, v45 offset:0
    ds_read_b32 v41, v48 offset:0
L_lec11:
    s_waitcnt lgkmcnt(0)
    v_max_u32 v40, v40, v41
    v_cmp_eq_u32 vcc, -1, v40
    s_cbranch_vccnz L_ler11
L_lek11:
    s_barrier
    s_endpgm
L_Y:
    v_lshlrev_b32 v104, 16, v172
    v_and_b32 v105, 0xffff0000, v172
    v_lshlrev_b32 v106, 16, v173
    v_and_b32 v107, 0xffff0000, v173
    v_lshlrev_b32 v108, 16, v174
    v_and_b32 v109, 0xffff0000, v174
    v_lshlrev_b32 v110, 16, v175
    v_and_b32 v111, 0xffff0000, v175
    v_lshlrev_b32 v112, 16, v176
    v_and_b32 v113, 0xffff0000, v176
    v_lshlrev_b32 v114, 16, v177
    v_and_b32 v115, 0xffff0000, v177
    v_lshlrev_b32 v116, 16, v178
    v_and_b32 v117, 0xffff0000, v178
    v_lshlrev_b32 v118, 16, v179
    v_and_b32 v119, 0xffff0000, v179
    v_lshlrev_b32 v120, 16, v180
    v_and_b32 v121, 0xffff0000, v180
    v_lshlrev_b32 v122, 16, v181
    v_and_b32 v123, 0xffff0000, v181
    v_add_u32 v3, 61440, v2
    v_add_u32 v4, 129024, v2
    v_lshlrev_b32 v5, 3, v1
    v_mov_b32 v8, 163776
    s_mov_b32 s33, 32768
    s_bfe_u32 s27, s2, 0x20001
    s_add_u32 s27, s27, 1
    s_and_b32 s27, s27, 3
    s_mul_i32 s59, s27, 5120
    s_add_u32 s59, s59, s30
    s_add_u32 s27, s27, 1
    s_and_b32 s27, s27, 3
    s_mul_i32 s60, s27, 5120
    s_add_u32 s60, s60, s30
    s_add_u32 s27, s27, 1
    s_and_b32 s27, s27, 3
    s_mul_i32 s61, s27, 5120
    s_add_u32 s61, s61, s30
    s_add_u32 s27, s27, 1
    s_and_b32 s27, s27, 3
    s_mul_i32 s62, s27, 5120
    s_add_u32 s62, s62, s30
    v_add_u32 v5, 4096, v5
    s_lshl_b32 s74, s19, 11
    s_add_u32 s74, s74, 15990784
    s_lshl_b32 s75, s17, 8
    s_add_u32 s75, s75, s74
    s_add_u32 s38, s75, 13500416
    s_add_u32 s39, s74, 13500416
    v_lshlrev_b32 v12, 4, v6
    v_mov_b32 v18, s55
    v_mov_b32 v19, s55
    s_mov_b32 s65, 15
    s_mov_b32 s33, 524288
    s_setprio 3
L_oround:
    ds_read_b32 v10, v8
    s_sub_u32 s33, s33, 1
    s_cmp_lt_i32 s33, 1
    s_cbranch_scc1 L_odone
    s_waitcnt lgkmcnt(0)
    v_readfirstlane_b32 s32, v10
    s_nop 0
    s_and_b32 s67, s32, s65
    s_cbranch_scc0 L_oround
    s_bitcmp1_b32 s67, 0
    s_cbranch_scc0 L_oi0
    buffer_load_dwordx4 v[24:27], v2, s[12:15], s59 offen offset:0 sc1
    buffer_load_dwordx4 v[28:31], v2, s[12:15], s59 offen offset:1024 sc1
    buffer_load_dwordx4 v[32:35], v2, s[12:15], s59 offen offset:2048 sc1
    buffer_load_dwordx4 v[36:39], v2, s[12:15], s59 offen offset:3072 sc1
    buffer_load_dwordx2 v[40:41], v5, s[12:15], s59 offen offset:0 sc1
    buffer_load_dwordx2 v[42:43], v5, s[12:15], s59 offen offset:512 sc1
L_oi0:
    s_setprio 2
    s_bitcmp1_b32 s67, 1
    s_cbranch_scc0 L_oi1
    buffer_load_dwordx4 v[44:47], v2, s[12:15], s60 offen offset:0 sc1
    buffer_load_dwordx4 v[48:51], v2, s[12:15], s60 offen offset:1024 sc1
    buffer_load_dwordx4 v[52:55], v2, s[12:15], s60 offen offset:2048 sc1
    buffer_load_dwordx4 v[56:59], v2, s[12:15], s60 offen offset:3072 sc1
    buffer_load_dwordx2 v[60:61], v5, s[12:15], s60 offen offset:0 sc1
    buffer_load_dwordx2 v[62:63], v5, s[12:15], s60 offen offset:512 sc1
L_oi1:
    s_setprio 1
    s_bitcmp1_b32 s67, 2
    s_cbranch_scc0 L_oi2
    buffer_load_dwordx4 v[64:67], v2, s[12:15], s61 offen offset:0 sc1
    buffer_load_dwordx4 v[68:71], v2, s[12:15], s61 offen offset:1024 sc1
    buffer_load_dwordx4 v[72:75], v2, s[12:15], s61 offen offset:2048 sc1
    buffer_load_dwordx4 v[76:79], v2, s[12:15], s61 offen offset:3072 sc1
    buffer_load_dwordx2 v[80:81], v5, s[12:15], s61 offen offset:0 sc1
    buffer_load_dwordx2 v[82:83], v5, s[12:15], s61 offen offset:512 sc1
L_oi2:
    ds_read_b32 v10, v8
    s_waitcnt lgkmcnt(0)
    v_readfirstlane_b32 s32, v10
    s_and_b32 s34, s65, 8
    s_and_b32 s32, s32, s34
    s_or_b32 s67, s67, s32
    s_bitcmp1_b32 s67, 3
    s_cbranch_scc0 L_oi3
    buffer_load_dwordx4 v[84:87], v2, s[12:15], s62 offen offset:0 sc1
    buffer_load_dwordx4 v[88:91], v2, s[12:15], s62 offen offset:1024 sc1
    buffer_load_dwordx4 v[92:95], v2, s[12:15], s62 offen offset:2048 sc1
    buffer_load_dwordx4 v[96:99], v2, s[12:15], s62 offen offset:3072 sc1
    buffer_load_dwordx2 v[100:101], v5, s[12:15], s62 offen offset:0 sc1
    buffer_load_dwordx2 v[102:103], v5, s[12:15], s62 offen offset:512 sc1
L_oi3:
    s_setprio 3
    s_andn2_b32 s34, s65, s67
    s_cselect_b32 s34, 0, 1
    v_mov_b32 v9, s34
    s_mov_b64 exec, 1
    ds_add_u32 v8, v9 offset:4
    s_mov_b64 exec, -1
L_oa0:
    s_bitcmp1_b32 s67, 0
    s_cbranch_scc0 L_oa1
    s_waitcnt lgkmcnt(0)
    ds_read_b128 v[124:127], v2 offset:0
    ds_read_b128 v[128:131], v2 offset:1024
    ds_read_b128 v[132:135], v2 offset:2048
    ds_read_b128 v[136:139], v2 offset:3072
    ds_read_b128 v[140:143], v2 offset:4096
    ds_read_b128 v[144:147], v2 offset:5120
    ds_read_b128 v[148:151], v2 offset:6144
    ds_read_b128 v[152:155], v2 offset:7168
    ds_read_b128 v[156:159], v2 offset:8192
    ds_read_b128 v[160:163], v2 offset:9216
L_ob0:
    s_lshr_b32 s34, s67, 1
    s_bcnt1_i32_b32 s34, s34
    s_cmp_eq_u32 s34, 3
    s_cbranch_scc1 L_ow0_3
    s_cmp_eq_u32 s34, 2
    s_cbranch_scc1 L_ow0_2
    s_cmp_eq_u32 s34, 1
    s_cbranch_scc1 L_ow0_1
    s_waitcnt vmcnt(0)
L_ow0_1:
    s_waitcnt vmcnt(6)
L_ow0_2:
    s_waitcnt vmcnt(12)
L_ow0_3:
    s_waitcnt vmcnt(18)
    v_max3_u32 v9, v24, v28, v32
    v_max3_u32 v10, v36, v40, v42
    v_max_u32 v9, v9, v10
    v_cmp_eq_u32 vcc, -1, v9
    s_cbranch_vccnz L_oa1
    s_bitset0_b32 s65, 0
    s_waitcnt lgkmcnt(5)
    v_mfma_f32_16x16x32_bf16 v[104:107], v[124:127], v[24:27], v[104:107]
    ds_read_b128 v[164:167], v2 offset:10240
    v_mfma_f32_16x16x32_bf16 v[108:111], v[128:131], v[24:27], v[108:111]
    ds_read_b128 v[168:171], v2 offset:11264
    v_mfma_f32_16x16x32_bf16 v[112:115], v[132:135], v[24:27], v[112:115]
    ds_read_b128 v[172:175], v2 offset:12288
    v_mfma_f32_16x16x32_bf16 v[116:119], v[136:139], v[24:27], v[116:119]
    ds_read_b128 v[176:179], v2 offset:13312
    v_mfma_f32_16x16x32_bf16 v[120:123], v[140:143], v[24:27], v[120:123]
    ds_read_b128 v[180:183], v2 offset:14336
    s_waitcnt lgkmcnt(5)
    v_mfma_f32_16x16x32_bf16 v[104:107], v[144:147], v[28:31], v[104:107]
    ds_read_b128 v[124:127], v2 offset:15360
    v_mfma_f32_16x16x32_bf16 v[108:111], v[148:151], v[28:31], v[108:111]
    ds_read_b128 v[128:131], v2 offset:16384
    v_mfma_f32_16x16x32_bf16 v[112:115], v[152:155], v[28:31], v[112:115]
    ds_read_b128 v[132:135], v2 offset:17408
    v_mfma_f32_16x16x32_bf16 v[116:119], v[156:159], v[28:31], v[116:119]
    ds_read_b128 v[136:139], v2 offset:18432
    v_mfma_f32_16x16x32_bf16 v[120:123], v[160:163], v[28:31], v[120:123]
    ds_read_b128 v[140:143], v2 offset:19456
    s_waitcnt lgkmcnt(5)
    v_mfma_f32_16x16x32_bf16 v[104:107], v[164:167], v[32:35], v[104:107]
    ds_read_b128 v[144:147], v2 offset:20480
    v_mfma_f32_16x16x32_bf16 v[108:111], v[168:171], v[32:35], v[108:111]
    ds_read_b128 v[148:151], v2 offset:21504
    v_mfma_f32_16x16x32_bf16 v[112:115], v[172:175], v[32:35], v[112:115]
    ds_read_b128 v[152:155], v2 offset:22528
    v_mfma_f32_16x16x32_bf16 v[116:119], v[176:179], v[32:35], v[116:119]
    ds_read_b128 v[156:159], v2 offset:23552
    v_mfma_f32_16x16x32_bf16 v[120:123], v[180:183], v[32:35], v[120:123]
    ds_read_b128 v[160:163], v2 offset:24576
    s_waitcnt lgkmcnt(5)
    v_mfma_f32_16x16x32_bf16 v[104:107], v[124:127], v[36:39], v[104:107]
    ds_read_b128 v[164:167], v2 offset:25600
    v_mfma_f32_16x16x32_bf16 v[108:111], v[128:131], v[36:39], v[108:111]
    ds_read_b128 v[168:171], v2 offset:26624
    v_mfma_f32_16x16x32_bf16 v[112:115], v[132:135], v[36:39], v[112:115]
    ds_read_b128 v[172:175], v2 offset:27648
    v_mfma_f32_16x16x32_bf16 v[116:119], v[136:139], v[36:39], v[116:119]
    ds_read_b128 v[176:179], v2 offset:28672
    v_mfma_f32_16x16x32_bf16 v[120:123], v[140:143], v[36:39], v[120:123]
    ds_read_b128 v[180:183], v2 offset:29696
    s_waitcnt lgkmcnt(5)
    v_mfma_f32_16x16x32_bf16 v[104:107], v[144:147], v[40:43], v[104:107]
    ds_read_b128 v[124:127], v2 offset:30720
    v_mfma_f32_16x16x32_bf16 v[108:111], v[148:151], v[40:43], v[108:111]
    ds_read_b128 v[128:131], v2 offset:31744
    v_mfma_f32_16x16x32_bf16 v[112:115], v[152:155], v[40:43], v[112:115]
    ds_read_b128 v[132:135], v2 offset:32768
    v_mfma_f32_16x16x32_bf16 v[116:119], v[156:159], v[40:43], v[116:119]
    ds_read_b128 v[136:139], v2 offset:33792
    v_mfma_f32_16x16x32_bf16 v[120:123], v[160:163], v[40:43], v[120:123]
    ds_read_b128 v[140:143], v2 offset:34816
    s_bitcmp1_b32 s67, 1
    s_cbranch_scc1 L_ob1
L_oa1:
    s_bitcmp1_b32 s67, 1
    s_cbranch_scc0 L_oa2
    s_waitcnt lgkmcnt(0)
    ds_read_b128 v[164:167], v2 offset:25600
    ds_read_b128 v[168:171], v2 offset:26624
    ds_read_b128 v[172:175], v2 offset:27648
    ds_read_b128 v[176:179], v2 offset:28672
    ds_read_b128 v[180:183], v2 offset:29696
    ds_read_b128 v[124:127], v2 offset:30720
    ds_read_b128 v[128:131], v2 offset:31744
    ds_read_b128 v[132:135], v2 offset:32768
    ds_read_b128 v[136:139], v2 offset:33792
    ds_read_b128 v[140:143], v2 offset:34816
L_ob1:
    s_lshr_b32 s34, s67, 2
    s_bcnt1_i32_b32 s34, s34
    s_cmp_eq_u32 s34, 2
    s_cbranch_scc1 L_ow1_2
    s_cmp_eq_u32 s34, 1
    s_cbranch_scc1 L_ow1_1
    s_waitcnt vmcnt(0)
L_ow1_1:
    s_waitcnt vmcnt(6)
L_ow1_2:
    s_waitcnt vmcnt(12)
    v_max3_u32 v9, v44, v48, v52
    v_max3_u32 v10, v56, v60, v62
    v_max_u32 v9, v9, v10
    v_cmp_eq_u32 vcc, -1, v9
    s_cbranch_vccnz L_oa2
    s_bitset0_b32 s65, 1
    s_waitcnt lgkmcnt(5)
    v_mfma_f32_16x16x32_bf16 v[104:107], v[164:167], v[44:47], v[104:107]
    ds_read_b128 v[144:147], v2 offset:35840
    v_mfma_f32_16x16x32_bf16 v[108:111], v[168:171], v[44:47], v[108:111]
    ds_read_b128 v[148:151], v2 offset:36864
    v_mfma_f32_16x16x32_bf16 v[112:115], v[172:175], v[44:47], v[112:115]
    ds_read_b128 v[152:155], v2 offset:37888
    v_mfma_f32_16x16x32_bf16 v[116:119], v[176:179], v[44:47], v[116:119]
    ds_read_b128 v[156:159], v2 offset:38912
    v_mfma_f32_16x16x32_bf16 v[120:123], v[180:183], v[44:47], v[120:123]
    ds_read_b128 v[160:163], v2 offset:39936
    s_waitcnt lgkmcnt(5)
    v_mfma_f32_16x16x32_bf16 v[104:107], v[124:127], v[48:51], v[104:107]
    ds_read_b128 v[164:167], v2 offset:40960
    v_mfma_f32_16x16x32_bf16 v[108:111], v[128:131], v[48:51], v[108:111]
    ds_read_b128 v[168:171], v2 offset:41984
    v_mfma_f32_16x16x32_bf16 v[112:115], v[132:135], v[48:51], v[112:115]
    ds_read_b128 v[172:175], v2 offset:43008
    v_mfma_f32_16x16x32_bf16 v[116:119], v[136:139], v[48:51], v[116:119]
    ds_read_b128 v[176:179], v2 offset:44032
    v_mfma_f32_16x16x32_bf16 v[120:123], v[140:143], v[48:51], v[120:123]
    ds_read_b128 v[180:183], v2 offset:45056
    s_waitcnt lgkmcnt(5)
    v_mfma_f32_16x16x32_bf16 v[104:107], v[144:147], v[52:55], v[104:107]
    ds_read_b128 v[124:127], v2 offset:46080
    v_mfma_f32_16x16x32_bf16 v[108:111], v[148:151], v[52:55], v[108:111]
    ds_read_b128 v[128:131], v2 offset:47104
    v_mfma_f32_16x16x32_bf16 v[112:115], v[152:155], v[52:55], v[112:115]
    ds_read_b128 v[132:135], v2 offset:48128
    v_mfma_f32_16x16x32_bf16 v[116:119], v[156:159], v[52:55], v[116:119]
    ds_read_b128 v[136:139], v2 offset:49152
    v_mfma_f32_16x16x32_bf16 v[120:123], v[160:163], v[52:55], v[120:123]
    ds_read_b128 v[140:143], v2 offset:50176
    s_waitcnt lgkmcnt(5)
    v_mfma_f32_16x16x32_bf16 v[104:107], v[164:167], v[56:59], v[104:107]
    ds_read_b128 v[144:147], v2 offset:51200
    v_mfma_f32_16x16x32_bf16 v[108:111], v[168:171], v[56:59], v[108:111]
    ds_read_b128 v[148:151], v2 offset:52224
    v_mfma_f32_16x16x32_bf16 v[112:115], v[172:175], v[56:59], v[112:115]
    ds_read_b128 v[152:155], v2 offset:53248
    v_mfma_f32_16x16x32_bf16 v[116:119], v[176:179], v[56:59], v[116:119]
    ds_read_b128 v[156:159], v2 offset:54272
    v_mfma_f32_16x16x32_bf16 v[120:123], v[180:183], v[56:59], v[120:123]
    ds_read_b128 v[160:163], v2 offset:55296
    s_waitcnt lgkmcnt(5)
    v_mfma_f32_16x16x32_bf16 v[104:107], v[124:127], v[60:63], v[104:107]
    ds_read_b128 v[164:167], v2 offset:56320
    v_mfma_f32_16x16x32_bf16 v[108:111], v[128:131], v[60:63], v[108:111]
    ds_read_b128 v[168:171], v2 offset:57344
    v_mfma_f32_16x16x32_bf16 v[112:115], v[132:135], v[60:63], v[112:115]
    ds_read_b128 v[172:175], v2 offset:58368
    v_mfma_f32_16x16x32_bf16 v[116:119], v[136:139], v[60:63], v[116:119]
    ds_read_b128 v[176:179], v2 offset:59392
    v_mfma_f32_16x16x32_bf16 v[120:123], v[140:143], v[60:63], v[120:123]
    ds_read_b128 v[180:183], v2 offset:60416
    s_bitcmp1_b32 s67, 2
    s_cbranch_scc1 L_ob2
L_oa2:
    s_bitcmp1_b32 s67, 2
    s_cbranch_scc0 L_oa3
    s_waitcnt lgkmcnt(0)
    ds_read_b128 v[144:147], v2 offset:51200
    ds_read_b128 v[148:151], v2 offset:52224
    ds_read_b128 v[152:155], v2 offset:53248
    ds_read_b128 v[156:159], v2 offset:54272
    ds_read_b128 v[160:163], v2 offset:55296
    ds_read_b128 v[164:167], v2 offset:56320
    ds_read_b128 v[168:171], v2 offset:57344
    ds_read_b128 v[172:175], v2 offset:58368
    ds_read_b128 v[176:179], v2 offset:59392
    ds_read_b128 v[180:183], v2 offset:60416
L_ob2:
    s_lshr_b32 s34, s67, 3
    s_bcnt1_i32_b32 s34, s34
    s_cmp_eq_u32 s34, 1
    s_cbranch_scc1 L_ow2_1
    s_waitcnt vmcnt(0)
L_ow2_1:
    s_waitcnt vmcnt(6)
    v_max3_u32 v9, v64, v68, v72
    v_max3_u32 v10, v76, v80, v82
    v_max_u32 v9, v9, v10
    v_cmp_eq_u32 vcc, -1, v9
    s_cbranch_vccnz L_oa3
    s_bitset0_b32 s65, 2
    s_waitcnt lgkmcnt(5)
    v_mfma_f32_16x16x32_bf16 v[104:107], v[144:147], v[64:67], v[104:107]
    ds_read_b128 v[124:127], v3 offset:0
    v_mfma_f32_16x16x32_bf16 v[108:111], v[148:151], v[64:67], v[108:111]
    ds_read_b128 v[128:131], v3 offset:1024
    v_mfma_f32_16x16x32_bf16 v[112:115], v[152:155], v[64:67], v[112:115]
    ds_read_b128 v[132:135], v3 offset:2048
    v_mfma_f32_16x16x32_bf16 v[116:119], v[156:159], v[64:67], v[116:119]
    ds_read_b128 v[136:139], v3 offset:3072
    v_mfma_f32_16x16x32_bf16 v[120:123], v[160:163], v[64:67], v[120:123]
    ds_read_b128 v[140:143], v3 offset:4096
    s_waitcnt lgkmcnt(5)
    v_mfma_f32_16x16x32_bf16 v[104:107], v[164:167], v[68:71], v[104:107]
    ds_read_b128 v[144:147], v3 offset:5120
    v_mfma_f32_16x16x32_bf16 v[108:111], v[168:171], v[68:71], v[108:111]
    ds_read_b128 v[148:151], v3 offset:6144
    v_mfma_f32_16x16x32_bf16 v[112:115], v[172:175], v[68:71], v[112:115]
    ds_read_b128 v[152:155], v3 offset:7168
    v_mfma_f32_16x16x32_bf16 v[116:119], v[176:179], v[68:71], v[116:119]
    ds_read_b128 v[156:159], v3 offset:8192
    v_mfma_f32_16x16x32_bf16 v[120:123], v[180:183], v[68:71], v[120:123]
    ds_read_b128 v[160:163], v3 offset:9216
    s_waitcnt lgkmcnt(5)
    v_mfma_f32_16x16x32_bf16 v[104:107], v[124:127], v[72:75], v[104:107]
    ds_read_b128 v[164:167], v3 offset:10240
    v_mfma_f32_16x16x32_bf16 v[108:111], v[128:131], v[72:75], v[108:111]
    ds_read_b128 v[168:171], v3 offset:11264
    v_mfma_f32_16x16x32_bf16 v[112:115], v[132:135], v[72:75], v[112:115]
    ds_read_b128 v[172:175], v4 offset:0
    v_mfma_f32_16x16x32_bf16 v[116:119], v[136:139], v[72:75], v[116:119]
    ds_read_b128 v[176:179], v4 offset:1024
    v_mfma_f32_16x16x32_bf16 v[120:123], v[140:143], v[72:75], v[120:123]
    ds_read_b128 v[180:183], v4 offset:2048
    s_waitcnt lgkmcnt(5)
    v_mfma_f32_16x16x32_bf16 v[104:107], v[144:147], v[76:79], v[104:107]
    ds_read_b128 v[124:127], v4 offset:3072
    v_mfma_f32_16x16x32_bf16 v[108:111], v[148:151], v[76:79], v[108:111]
    ds_read_b128 v[128:131], v4 offset:4096
    v_mfma_f32_16x16x32_bf16 v[112:115], v[152:155], v[76:79], v[112:115]
    ds_read_b128 v[132:135], v4 offset:5120
    v_mfma_f32_16x16x32_bf16 v[116:119], v[156:159], v[76:79], v[116:119]
    ds_read_b128 v[136:139], v4 offset:6144
    v_mfma_f32_16x16x32_bf16 v[120:123], v[160:163], v[76:79], v[120:123]
    ds_read_b128 v[140:143], v4 offset:7168
    s_waitcnt lgkmcnt(5)
    v_mfma_f32_16x16x32_bf16 v[104:107], v[164:167], v[80:83], v[104:107]
    ds_read_b128 v[144:147], v4 offset:8192
    v_mfma_f32_16x16x32_bf16 v[108:111], v[168:171], v[80:83], v[108:111]
    ds_read_b128 v[148:151], v4 offset:9216
    v_mfma_f32_16x16x32_bf16 v[112:115], v[172:175], v[80:83], v[112:115]
    ds_read_b128 v[152:155], v4 offset:10240
    v_mfma_f32_16x16x32_bf16 v[116:119], v[176:179], v[80:83], v[116:119]
    ds_read_b128 v[156:159], v4 offset:11264
    v_mfma_f32_16x16x32_bf16 v[120:123], v[180:183], v[80:83], v[120:123]
    ds_read_b128 v[160:163], v4 offset:12288
    s_bitcmp1_b32 s67, 3
    s_cbranch_scc1 L_ob3
L_oa3:
    s_bitcmp1_b32 s67, 3
    s_cbranch_scc0 L_oa4
    s_waitcnt lgkmcnt(0)
    ds_read_b128 v[124:127], v4 offset:3072
    ds_read_b128 v[128:131], v4 offset:4096
    ds_read_b128 v[132:135], v4 offset:5120
    ds_read_b128 v[136:139], v4 offset:6144
    ds_read_b128 v[140:143], v4 offset:7168
    ds_read_b128 v[144:147], v4 offset:8192
    ds_read_b128 v[148:151], v4 offset:9216
    ds_read_b128 v[152:155], v4 offset:10240
    ds_read_b128 v[156:159], v4 offset:11264
    ds_read_b128 v[160:163], v4 offset:12288
L_ob3:
    s_waitcnt vmcnt(0)
    v_max3_u32 v9, v84, v88, v92
    v_max3_u32 v10, v96, v100, v102
    v_max_u32 v9, v9, v10
    v_cmp_eq_u32 vcc, -1, v9
    s_cbranch_vccnz L_oa4
    s_bitset0_b32 s65, 3
    s_waitcnt lgkmcnt(5)
    v_mfma_f32_16x16x32_bf16 v[104:107], v[124:127], v[84:87], v[104:107]
    ds_read_b128 v[164:167], v4 offset:13312
    v_mfma_f32_16x16x32_bf16 v[108:111], v[128:131], v[84:87], v[108:111]
    ds_read_b128 v[168:171], v4 offset:14336
    v_mfma_f32_16x16x32_bf16 v[112:115], v[132:135], v[84:87], v[112:115]
    ds_read_b128 v[172:175], v4 offset:15360
    v_mfma_f32_16x16x32_bf16 v[116:119], v[136:139], v[84:87], v[116:119]
    ds_read_b128 v[176:179], v4 offset:16384
    v_mfma_f32_16x16x32_bf16 v[120:123], v[140:143], v[84:87], v[120:123]
    ds_read_b128 v[180:183], v4 offset:17408
    s_waitcnt lgkmcnt(5)
    v_mfma_f32_16x16x32_bf16 v[104:107], v[144:147], v[88:91], v[104:107]
    ds_read_b128 v[124:127], v4 offset:18432
    v_mfma_f32_16x16x32_bf16 v[108:111], v[148:151], v[88:91], v[108:111]
    ds_read_b128 v[128:131], v4 offset:19456
    v_mfma_f32_16x16x32_bf16 v[112:115], v[152:155], v[88:91], v[112:115]
    ds_read_b128 v[132:135], v4 offset:20480
    v_mfma_f32_16x16x32_bf16 v[116:119], v[156:159], v[88:91], v[116:119]
    ds_read_b128 v[136:139], v4 offset:21504
    v_mfma_f32_16x16x32_bf16 v[120:123], v[160:163], v[88:91], v[120:123]
    ds_read_b128 v[140:143], v4 offset:22528
    s_waitcnt lgkmcnt(5)
    v_mfma_f32_16x16x32_bf16 v[104:107], v[164:167], v[92:95], v[104:107]
    ds_read_b128 v[144:147], v4 offset:23552
    v_mfma_f32_16x16x32_bf16 v[108:111], v[168:171], v[92:95], v[108:111]
    ds_read_b128 v[148:151], v4 offset:24576
    v_mfma_f32_16x16x32_bf16 v[112:115], v[172:175], v[92:95], v[112:115]
    ds_read_b128 v[152:155], v4 offset:25600
    v_mfma_f32_16x16x32_bf16 v[116:119], v[176:179], v[92:95], v[116:119]
    ds_read_b128 v[156:159], v4 offset:26624
    v_mfma_f32_16x16x32_bf16 v[120:123], v[180:183], v[92:95], v[120:123]
    ds_read_b128 v[160:163], v4 offset:27648
    s_waitcnt lgkmcnt(5)
    v_mfma_f32_16x16x32_bf16 v[104:107], v[124:127], v[96:99], v[104:107]
    v_mfma_f32_16x16x32_bf16 v[108:111], v[128:131], v[96:99], v[108:111]
    v_mfma_f32_16x16x32_bf16 v[112:115], v[132:135], v[96:99], v[112:115]
    v_mfma_f32_16x16x32_bf16 v[116:119], v[136:139], v[96:99], v[116:119]
    v_mfma_f32_16x16x32_bf16 v[120:123], v[140:143], v[96:99], v[120:123]
    s_waitcnt lgkmcnt(0)
    v_mfma_f32_16x16x32_bf16 v[104:107], v[144:147], v[100:103], v[104:107]
    v_mfma_f32_16x16x32_bf16 v[108:111], v[148:151], v[100:103], v[108:111]
    v_mfma_f32_16x16x32_bf16 v[112:115], v[152:155], v[100:103], v[112:115]
    v_mfma_f32_16x16x32_bf16 v[116:119], v[156:159], v[100:103], v[116:119]
    v_mfma_f32_16x16x32_bf16 v[120:123], v[160:163], v[100:103], v[120:123]
L_oa4:
    s_cmp_lg_u32 s65, 0
    s_cbranch_scc1 L_oretry
L_odone:
    v_mov_b32 v28, 1
    s_mov_b64 exec, 1
    ds_add_u32 v8, v28 offset:8
    s_mov_b64 exec, -1
    v_pk_add_f32 v[24:25], v[104:105], v[106:107]
    v_pk_mul_f32 v[26:27], v[104:105], v[104:105]
    v_pk_fma_f32 v[26:27], v[106:107], v[106:107], v[26:27]
    v_pk_add_f32 v[24:25], v[24:25], v[108:109]
    v_pk_fma_f32 v[26:27], v[108:109], v[108:109], v[26:27]
    v_pk_add_f32 v[24:25], v[24:25], v[110:111]
    v_pk_fma_f32 v[26:27], v[110:111], v[110:111], v[26:27]
    v_pk_add_f32 v[24:25], v[24:25], v[112:113]
    v_pk_fma_f32 v[26:27], v[112:113], v[112:113], v[26:27]
    v_pk_add_f32 v[24:25], v[24:25], v[114:115]
    v_pk_fma_f32 v[26:27], v[114:115], v[114:115], v[26:27]
    v_pk_add_f32 v[24:25], v[24:25], v[116:117]
    v_pk_fma_f32 v[26:27], v[116:117], v[116:117], v[26:27]
    v_pk_add_f32 v[24:25], v[24:25], v[118:119]
    v_pk_fma_f32 v[26:27], v[118:119], v[118:119], v[26:27]
    v_pk_add_f32 v[24:25], v[24:25], v[120:121]
    v_pk_fma_f32 v[26:27], v[120:121], v[120:121], v[26:27]
    v_pk_add_f32 v[24:25], v[24:25], v[122:123]
    v_pk_fma_f32 v[26:27], v[122:123], v[122:123], v[26:27]
    v_add_f32 v16, v24, v25
    v_add_f32 v17, v26, v27
    v_mov_b32 v24, v16
    v_mov_b32 v25, v17
    s_nop 1
    v_permlane32_swap_b32 v16, v24
    v_permlane32_swap_b32 v17, v25
    s_nop 1
    v_pk_add_f32 v[16:17], v[16:17], v[24:25]
    v_mov_b32 v24, v16
    v_mov_b32 v25, v17
    s_nop 1
    v_permlane16_swap_b32 v16, v24
    v_permlane16_swap_b32 v17, v25
    s_nop 1
    v_pk_add_f32 v[16:17], v[16:17], v[24:25]
    s_mov_b64 exec, 0xffff
    buffer_store_dwordx4 v[16:19], v12, s[12:15], s38 offen
    s_mov_b64 exec, -1
    v_mov_b32 v52, v16
    v_mov_b32 v53, v17
    v_mov_b32 v54, v18
    v_mov_b32 v55, v19
    v_lshl_add_u32 v13, v7, 9, v12
    s_mov_b32 s33, 32768
    s_mul_i32 s31, s17, 327680
    s_lshl_b32 s32, s19, 9
    s_add_u32 s31, s31, s32
    s_add_u32 s31, s31, 10485760
    s_add_u32 s32, s31, 131072
    s_add_u32 s35, s31, 262144
    v_bfe_u32 v26, v1, 3, 1
    v_lshlrev_b32 v9, 8, v26
    v_and_b32 v26, 7, v1
    v_lshl_add_u32 v9, v26, 4, v9
    v_lshrrev_b32 v26, 1, v7
    v_lshl_add_u32 v9, v26, 7, v9
    v_and_b32 v26, 1, v7
    v_mul_u32_u24 v26, 65536, v26
    v_add_u32 v48, v26, v9
    s_lshl_b32 s76, s17, 5
    s_add_u32 s76, s76, s16
    s_lshl_b32 s76, s76, 7
    s_add_u32 s76, s76, 16744448
    s_mov_b32 s20, 0x3f800054
    v_mov_b32 v49, 0x2edbe6ff
    v_mov_b32 v11, 1
    v_cvt_pk_bf16_f32 v14, v104, v105
    v_cvt_pk_bf16_f32 v15, v106, v107
    v_cvt_pk_bf16_f32 v16, v108, v109
    v_cvt_pk_bf16_f32 v17, v110, v111
    v_cvt_pk_bf16_f32 v18, v112, v113
    v_cvt_pk_bf16_f32 v19, v114, v115
    v_cvt_pk_bf16_f32 v20, v116, v117
    v_cvt_pk_bf16_f32 v21, v118, v119
    v_cvt_pk_bf16_f32 v22, v120, v121
    v_cvt_pk_bf16_f32 v23, v122, v123
    s_mov_b32 s27, 8
    s_sleep 3
L_lpoll:
    buffer_load_dwordx4 v[32:35], v13, s[12:15], s39 offen sc1
    buffer_load_dwordx4 v[36:39], v13, s[12:15], s39 offen offset:256 sc1
    s_sub_u32 s27, s27, 1
    s_waitcnt vmcnt(0)
    v_cmp_ne_u32 vcc, s55, v34
    v_cmp_ne_u32 s[36:37], s55, v38
    s_nop 1
    s_or_b64 vcc, vcc, s[36:37]
    s_cbranch_scc0 L_sgot
    s_sleep 1
    s_cmp_lg_u32 s27, 0
    s_cbranch_scc1 L_lpoll
    s_mov_b64 exec, 0xffff
    buffer_store_dwordx4 v[52:55], v12, s[12:15], s75 offen sc0 sc1
    s_mov_b64 exec, -1
L_spoll:
    buffer_load_dwordx4 v[32:35], v13, s[12:15], s74 offen sc1
    buffer_load_dwordx4 v[36:39], v13, s[12:15], s74 offen offset:256 sc1
    s_sub_u32 s33, s33, 1
    s_waitcnt vmcnt(0)
    v_cmp_ne_u32 vcc, s55, v34
    v_cmp_ne_u32 s[36:37], s55, v38
    s_cmp_eq_u32 s33, 0
    s_cbranch_scc1 L_sgot
    s_or_b64 vcc, vcc, s[36:37]
    s_cbranch_scc0 L_sgot
    s_sleep 8
    s_branch L_spoll
L_sgot:
    v_pk_add_f32 v[28:29], v[32:33], v[36:37]
    s_mov_b64 exec, 1
    ds_add_rtn_u32 v11, v8, v11 offset:12
    s_mov_b64 exec, -1
    v_mov_b32 v24, v28
    v_mov_b32 v25, v29
    s_nop 1
    v_permlane32_swap_b32 v28, v24
    v_permlane32_swap_b32 v29, v25
    s_nop 1
    v_pk_add_f32 v[28:29], v[28:29], v[24:25]
    v_mov_b32 v24, v28
    v_mov_b32 v25, v29
    s_nop 1
    v_permlane16_swap_b32 v28, v24
    v_permlane16_swap_b32 v29, v25
    s_nop 1
    v_pk_add_f32 v[28:29], v[28:29], v[24:25]
    v_mul_f32 v28, 0xbacccccd, v28
    v_mul_f32 v29, 0x3acccccd, v29
    v_fma_f32 v29, -v28, v28, v29
    v_max_f32 v29, 0, v29
    v_fma_f32 v29, v29, s20, v49
    v_rsq_f32 v24, v29
    s_waitcnt lgkmcnt(0)
    v_mul_f32 v25, v24, v28
    v_readfirstlane_b32 s66, v11
    s_nop 1
    s_cmp_eq_u32 s66, 3
    s_cselect_b32 s27, s76, 0x80000000
    v_lshlrev_b32 v50, 2, v1
    v_mov_b32 v51, s55
    s_mov_b32 exec_hi, 0
    buffer_store_dword v51, v50, s[12:15], s27 offen sc0 sc1
    s_mov_b32 exec_hi, -1
    v_pk_fma_f32 v[104:105], v[104:105], v[24:25], v[24:25] op_sel:[0,0,1] op_sel_hi:[1,0,1]
    v_pk_fma_f32 v[106:107], v[106:107], v[24:25], v[24:25] op_sel:[0,0,1] op_sel_hi:[1,0,1]
    v_cvt_pk_bf16_f32 v124, v104, v105
    v_cvt_pk_bf16_f32 v125, v106, v107
    v_pk_fma_f32 v[108:109], v[108:109], v[24:25], v[24:25] op_sel:[0,0,1] op_sel_hi:[1,0,1]
    v_pk_fma_f32 v[110:111], v[110:111], v[24:25], v[24:25] op_sel:[0,0,1] op_sel_hi:[1,0,1]
    v_cvt_pk_bf16_f32 v126, v108, v109
    v_cvt_pk_bf16_f32 v127, v110, v111
    v_pk_fma_f32 v[112:113], v[112:113], v[24:25], v[24:25] op_sel:[0,0,1] op_sel_hi:[1,0,1]
    v_pk_fma_f32 v[114:115], v[114:115], v[24:25], v[24:25] op_sel:[0,0,1] op_sel_hi:[1,0,1]
    v_cvt_pk_bf16_f32 v128, v112, v113
    v_cvt_pk_bf16_f32 v129, v114, v115
    v_pk_fma_f32 v[116:117], v[116:117], v[24:25], v[24:25] op_sel:[0,0,1] op_sel_hi:[1,0,1]
    v_pk_fma_f32 v[118:119], v[118:119], v[24:25], v[24:25] op_sel:[0,0,1] op_sel_hi:[1,0,1]
    v_cvt_pk_bf16_f32 v130, v116, v117
    v_cvt_pk_bf16_f32 v131, v118, v119
    v_pk_fma_f32 v[120:121], v[120:121], v[24:25], v[24:25] op_sel:[0,0,1] op_sel_hi:[1,0,1]
    v_pk_fma_f32 v[122:123], v[122:123], v[24:25], v[24:25] op_sel:[0,0,1] op_sel_hi:[1,0,1]
    v_cvt_pk_bf16_f32 v132, v120, v121
    v_cvt_pk_bf16_f32 v133, v122, v123
    v_mov_b32 v134, v132
    v_mov_b32 v135, v133
    v_permlane16_swap_b32 v124, v126
    v_permlane16_swap_b32 v125, v127
    buffer_store_dwordx4 v[124:127], v48, s[12:15], s31 offen sc0 sc1
    v_permlane16_swap_b32 v128, v130
    v_permlane16_swap_b32 v129, v131
    buffer_store_dwordx4 v[128:131], v48, s[12:15], s32 offen sc0 sc1
    v_permlane16_swap_b32 v132, v134
    v_permlane16_swap_b32 v133, v135
    v_readfirstlane_b32 s66, v11
    s_mov_b32 exec_lo, 0xffff
    s_mov_b32 exec_hi, 0xffff
    buffer_store_dwordx4 v[132:135], v9, s[12:15], s35 offen sc0 sc1
    s_mov_b64 exec, -1
    s_cmp_eq_u32 s66, 3
    s_cselect_b32 s27, s76, 0x80000000
    s_mov_b64 exec, 0xffff
    buffer_store_dwordx4 v[52:55], v12, s[12:15], s75 offen sc0 sc1
    s_mov_b64 exec, -1
    s_lshl_b32 s62, s16, 2
    s_lshl_b32 s63, s57, 1
    s_add_u32 s62, s62, s63
    s_mul_i32 s62, s62, 49152
    s_lshl_b32 s63, s56, 11
    s_add_u32 s62, s62, s63
    s_add_u32 s69, s62, 23199744
    s_mul_i32 s63, s56, 49152
    s_sub_u32 s62, 49152, s63
    s_add_u32 s62, s62, s69
    s_add_u32 s63, s63, s69
    s_mul_i32 s64, s25, 10240
    s_add_u32 s64, s64, 102400
    v_mov_b32 v3, 163784
    s_mov_b32 s33, 524288
L_wf6:
    ds_read_b32 v4, v3
    s_sub_u32 s33, s33, 1
    s_waitcnt lgkmcnt(0)
    v_readfirstlane_b32 s32, v4
    s_cmp_eq_u32 s33, 0
    s_cbranch_scc1 L_wd6
    s_cmp_lt_u32 s32, 8
    s_cbranch_scc1 L_wf6
L_wd6:
    s_cmp_eq_u32 s54, 0
    s_cbranch_scc1 L_nyw
    s_lshl_b32 s27, s25, 11
    s_add_u32 s27, s27, 81920
    v_add_u32 v3, s27, v2
    v_add_u32 v4, 57344, v3
    ds_write_b128 v3, v[184:187] offset:0
    ds_write_b128 v3, v[188:191] offset:1024
    buffer_load_dwordx4 v[104:107], v2, s[12:15], s62 offen offset:0
    buffer_load_dwordx4 v[108:111], v2, s[12:15], s63 offen offset:0
    ds_write_b128 v3, v[192:195] offset:8192
    ds_write_b128 v3, v[196:199] offset:9216
    buffer_load_dwordx4 v[112:115], v2, s[12:15], s62 offen offset:1024
    buffer_load_dwordx4 v[116:119], v2, s[12:15], s63 offen offset:1024
    s_add_u32 s62, s62, 4096
    s_add_u32 s63, s63, 4096
    ds_write_b128 v3, v[200:203] offset:16384
    ds_write_b128 v3, v[204:207] offset:17408
    buffer_load_dwordx4 v[120:123], v2, s[12:15], s62 offen offset:0
    buffer_load_dwordx4 v[124:127], v2, s[12:15], s63 offen offset:0
    ds_write_b128 v3, v[208:211] offset:24576
    ds_write_b128 v3, v[212:215] offset:25600
    buffer_load_dwordx4 v[128:131], v2, s[12:15], s62 offen offset:1024
    buffer_load_dwordx4 v[132:135], v2, s[12:15], s63 offen offset:1024
    s_add_u32 s62, s62, 4096
    s_add_u32 s63, s63, 4096
    ds_write_b128 v3, v[216:219] offset:32768
    ds_write_b128 v3, v[220:223] offset:33792
    buffer_load_dwordx4 v[136:139], v2, s[12:15], s62 offen offset:0
    buffer_load_dwordx4 v[140:143], v2, s[12:15], s63 offen offset:0
    ds_write_b128 v3, v[224:227] offset:40960
    ds_write_b128 v3, v[228:231] offset:41984
    buffer_load_dwordx4 v[144:147], v2, s[12:15], s62 offen offset:1024
    buffer_load_dwordx4 v[148:151], v2, s[12:15], s63 offen offset:1024
    s_add_u32 s62, s62, 4096
    s_add_u32 s63, s63, 4096
    ds_write_b128 v3, v[232:235] offset:49152
    ds_write_b128 v3, v[236:239] offset:50176
    ds_write_b128 v4, v[240:243] offset:0
    ds_write_b128 v4, v[244:247] offset:1024
    ds_write_b128 v4, v[248:251] offset:8192
    ds_write_b128 v4, v[252:255] offset:9216
L_nyw:
    s_cmp_eq_u32 s54, 0
    s_cbranch_scc1 L_Yskip
    s_mul_i32 s29, s52, 262144
    s_mul_i32 s27, s25, 65536
    s_add_u32 s29, s29, s27
    s_add_u32 s29, s29, 10485760
    s_lshl_b32 s27, s25, 12
    v_bfe_u32 v42, v1, 1, 4
    v_lshlrev_b32 v42, 2, v42
    v_lshl_add_u32 v44, v1, 6, v42
    v_add_u32 v44, s27, v44
    v_add_u32 v45, 65536, v44
    v_add_u32 v46, 131072, v44
    s_cmp_lg_u32 s66, 3
    s_cbranch_scc1 L_hw
    v_lshrrev_b32 v3, 5, v1
    v_mul_u32_u24 v3, 3, v3
    s_lshl_b32 s32, s52, 2
    v_add_u32 v3, s32, v3
    v_mul_u32_u24 v3, 52, v3
    v_lshrrev_b32 v3, 8, v3
    v_and_b32 v4, 31, v1
    v_lshl_add_u32 v3, v3, 5, v4
    v_lshlrev_b32 v3, 7, v3
    v_add_u32 v3, 16744448, v3
    s_mov_b32 s33, 32768
L_pl7:
    buffer_load_dword v4, v3, s[12:15], 0 offen sc1
    s_sub_u32 s33, s33, 1
    s_waitcnt vmcnt(0)
    v_cmp_ne_u32 vcc, s55, v4
    s_cbranch_vccz L_pg7
    s_cmp_lt_i32 s33, 1
    s_cbranch_scc1 L_pg7
    s_sleep 3
    s_branch L_pl7
L_pg7:
    v_mov_b32 v3, 163776
    v_mov_b32 v4, 1
    s_mov_b64 exec, 1
    ds_add_u32 v3, v4 offset:16
    s_mov_b64 exec, -1
    s_branch L_hg
L_hw:
    v_mov_b32 v3, 163792
    s_mov_b32 s33, 524288
L_wf8:
    ds_read_b32 v4, v3
    s_sub_u32 s33, s33, 1
    s_waitcnt lgkmcnt(0)
    v_readfirstlane_b32 s32, v4
    s_cmp_eq_u32 s33, 0
    s_cbranch_scc1 L_wd8
    s_cmp_lt_u32 s32, 1
    s_cbranch_scc1 L_wf8
L_wd8:
L_hg:
    s_mov_b32 s33, 32768
L_ldrs:
    s_add_u32 m0, s27, 0
    s_add_u32 s32, s29, 0
    buffer_load_dwordx4 v2, s[12:15], s32 offen offset:0 sc1 lds
    buffer_load_dwordx4 v2, s[12:15], s32 offen offset:1024 sc1 lds
    buffer_load_dwordx4 v2, s[12:15], s32 offen offset:2048 sc1 lds
    buffer_load_dwordx4 v2, s[12:15], s32 offen offset:3072 sc1 lds
    s_add_u32 m0, s27, 16384
    s_add_u32 s32, s29, 4096
    buffer_load_dwordx4 v2, s[12:15], s32 offen offset:0 sc1 lds
    buffer_load_dwordx4 v2, s[12:15], s32 offen offset:1024 sc1 lds
    buffer_load_dwordx4 v2, s[12:15], s32 offen offset:2048 sc1 lds
    buffer_load_dwordx4 v2, s[12:15], s32 offen offset:3072 sc1 lds
    s_add_u32 m0, s27, 32768
    s_add_u32 s32, s29, 8192
    buffer_load_dwordx4 v2, s[12:15], s32 offen offset:0 sc1 lds
    buffer_load_dwordx4 v2, s[12:15], s32 offen offset:1024 sc1 lds
    buffer_load_dwordx4 v2, s[12:15], s32 offen offset:2048 sc1 lds
    buffer_load_dwordx4 v2, s[12:15], s32 offen offset:3072 sc1 lds
    s_add_u32 m0, s27, 49152
    s_add_u32 s32, s29, 12288
    buffer_load_dwordx4 v2, s[12:15], s32 offen offset:0 sc1 lds
    buffer_load_dwordx4 v2, s[12:15], s32 offen offset:1024 sc1 lds
    buffer_load_dwordx4 v2, s[12:15], s32 offen offset:2048 sc1 lds
    buffer_load_dwordx4 v2, s[12:15], s32 offen offset:3072 sc1 lds
    s_waitcnt vmcnt(12)
    ds_read_b32 v40, v44 offset:0
L_ldc0:
    s_waitcnt lgkmcnt(0)
    v_cmp_eq_u32 vcc, -1, v40
    s_cbranch_vccnz L_ldr0
L_ldk0:
    s_barrier
    s_waitcnt vmcnt(8)
    ds_read_b32 v40, v44 offset:16384
    s_add_u32 m0, s27, 65536
    s_add_u32 s32, s29, 16384
    buffer_load_dwordx4 v2, s[12:15], s32 offen offset:0 sc1 lds
    buffer_load_dwordx4 v2, s[12:15], s32 offen offset:1024 sc1 lds
    buffer_load_dwordx4 v2, s[12:15], s32 offen offset:2048 sc1 lds
    buffer_load_dwordx4 v2, s[12:15], s32 offen offset:3072 sc1 lds
L_ldc1:
    s_waitcnt lgkmcnt(0)
    v_cmp_eq_u32 vcc, -1, v40
    s_cbranch_vccnz L_ldr1
L_ldk1:
    s_barrier
    s_waitcnt vmcnt(8)
    ds_read_b32 v40, v44 offset:32768
L_ldc2:
    s_waitcnt lgkmcnt(0)
    v_cmp_eq_u32 vcc, -1, v40
    s_cbranch_vccnz L_ldr2
L_ldk2:
    s_barrier
    s_waitcnt vmcnt(4)
    ds_read_b32 v40, v44 offset:49152
    s_add_u32 m0, s27, 0
    s_add_u32 s32, s29, 20480
    buffer_load_dwordx4 v2, s[12:15], s32 offen offset:0 sc1 lds
    buffer_load_dwordx4 v2, s[12:15], s32 offen offset:1024 sc1 lds
    buffer_load_dwordx4 v2, s[12:15], s32 offen offset:2048 sc1 lds
    buffer_load_dwordx4 v2, s[12:15], s32 offen offset:3072 sc1 lds
    s_add_u32 m0, s27, 81920
    s_add_u32 s32, s29, 24576
    buffer_load_dwordx4 v2, s[12:15], s32 offen offset:0 sc1 lds
    buffer_load_dwordx4 v2, s[12:15], s32 offen offset:1024 sc1 lds
    buffer_load_dwordx4 v2, s[12:15], s32 offen offset:2048 sc1 lds
    buffer_load_dwordx4 v2, s[12:15], s32 offen offset:3072 sc1 lds
L_ldc3:
    s_waitcnt lgkmcnt(0)
    v_cmp_eq_u32 vcc, -1, v40
    s_cbranch_vccnz L_ldr3
L_ldk3:
    s_barrier
    s_waitcnt vmcnt(8)
    ds_read_b32 v40, v45 offset:0
    s_add_u32 m0, s27, 16384
    s_add_u32 s32, s29, 28672
    buffer_load_dwordx4 v2, s[12:15], s32 offen offset:0 sc1 lds
    buffer_load_dwordx4 v2, s[12:15], s32 offen offset:1024 sc1 lds
    buffer_load_dwordx4 v2, s[12:15], s32 offen offset:2048 sc1 lds
    buffer_load_dwordx4 v2, s[12:15], s32 offen offset:3072 sc1 lds
L_ldc4:
    s_waitcnt lgkmcnt(0)
    v_cmp_eq_u32 vcc, -1, v40
    s_cbranch_vccnz L_ldr4
L_ldk4:
    s_barrier
    s_waitcnt vmcnt(8)
    ds_read_b32 v40, v44 offset:0
    s_add_u32 m0, s27, 98304
    s_add_u32 s32, s29, 32768
    buffer_load_dwordx4 v2, s[12:15], s32 offen offset:0 sc1 lds
    buffer_load_dwordx4 v2, s[12:15], s32 offen offset:1024 sc1 lds
    buffer_load_dwordx4 v2, s[12:15], s32 offen offset:2048 sc1 lds
    buffer_load_dwordx4 v2, s[12:15], s32 offen offset:3072 sc1 lds
L_ldc5:
    s_waitcnt lgkmcnt(0)
    v_cmp_eq_u32 vcc, -1, v40
    s_cbranch_vccnz L_ldr5
L_ldk5:
    s_barrier
    s_waitcnt vmcnt(8)
    ds_read_b32 v40, v45 offset:16384
    s_add_u32 m0, s27, 32768
    s_add_u32 s32, s29, 36864
    buffer_load_dwordx4 v2, s[12:15], s32 offen offset:0 sc1 lds
    buffer_load_dwordx4 v2, s[12:15], s32 offen offset:1024 sc1 lds
    buffer_load_dwordx4 v2, s[12:15], s32 offen offset:2048 sc1 lds
    buffer_load_dwordx4 v2, s[12:15], s32 offen offset:3072 sc1 lds
L_ldc6:
    s_waitcnt lgkmcnt(0)
    v_cmp_eq_u32 vcc, -1, v40
    s_cbranch_vccnz L_ldr6
L_ldk6:
    s_barrier
    s_waitcnt vmcnt(8)
    ds_read_b32 v40, v44 offset:16384
    s_add_u32 m0, s27, 114688
    s_add_u32 s32, s29, 40960
    buffer_load_dwordx4 v2, s[12:15], s32 offen offset:0 sc1 lds
    buffer_load_dwordx4 v2, s[12:15], s32 offen offset:1024 sc1 lds
    buffer_load_dwordx4 v2, s[12:15], s32 offen offset:2048 sc1 lds
    buffer_load_dwordx4 v2, s[12:15], s32 offen offset:3072 sc1 lds
L_ldc7:
    s_waitcnt lgkmcnt(0)
    v_cmp_eq_u32 vcc, -1, v40
    s_cbranch_vccnz L_ldr7
L_ldk7:
    s_barrier
    s_waitcnt vmcnt(8)
    ds_read_b32 v40, v45 offset:32768
    s_add_u32 m0, s27, 49152
    s_add_u32 s32, s29, 45056
    buffer_load_dwordx4 v2, s[12:15], s32 offen offset:0 sc1 lds
    buffer_load_dwordx4 v2, s[12:15], s32 offen offset:1024 sc1 lds
    buffer_load_dwordx4 v2, s[12:15], s32 offen offset:2048 sc1 lds
    buffer_load_dwordx4 v2, s[12:15], s32 offen offset:3072 sc1 lds
L_ldc8:
    s_waitcnt lgkmcnt(0)
    v_cmp_eq_u32 vcc, -1, v40
    s_cbranch_vccnz L_ldr8
L_ldk8:
    s_barrier
    s_waitcnt vmcnt(8)
    ds_read_b32 v40, v44 offset:32768
    s_add_u32 m0, s27, 131072
    s_add_u32 s32, s29, 49152
    buffer_load_dwordx4 v2, s[12:15], s32 offen offset:0 sc1 lds
    buffer_load_dwordx4 v2, s[12:15], s32 offen offset:1024 sc1 lds
    buffer_load_dwordx4 v2, s[12:15], s32 offen offset:2048 sc1 lds
    buffer_load_dwordx4 v2, s[12:15], s32 offen offset:3072 sc1 lds
L_ldc9:
    s_waitcnt lgkmcnt(0)
    v_cmp_eq_u32 vcc, -1, v40
    s_cbranch_vccnz L_ldr9
L_ldk9:
    s_barrier
    s_waitcnt vmcnt(8)
    ds_read_b32 v40, v45 offset:49152
    s_add_u32 m0, s27, 65536
    s_add_u32 s32, s29, 53248
    buffer_load_dwordx4 v2, s[12:15], s32 offen offset:0 sc1 lds
    buffer_load_dwordx4 v2, s[12:15], s32 offen offset:1024 sc1 lds
    buffer_load_dwordx4 v2, s[12:15], s32 offen offset:2048 sc1 lds
    buffer_load_dwordx4 v2, s[12:15], s32 offen offset:3072 sc1 lds
L_ldc10:
    s_waitcnt lgkmcnt(0)
    v_cmp_eq_u32 vcc, -1, v40
    s_cbranch_vccnz L_ldr10
L_ldk10:
    s_barrier
    s_waitcnt vmcnt(8)
    ds_read_b32 v40, v44 offset:49152
    s_add_u32 m0, s27, 0
    s_add_u32 s32, s29, 57344
    buffer_load_dwordx4 v2, s[12:15], s32 offen offset:0 sc1 lds
    buffer_load_dwordx4 v2, s[12:15], s32 offen offset:1024 sc1 lds
    buffer_load_dwordx4 v2, s[12:15], s32 offen offset:2048 sc1 lds
    buffer_load_dwordx4 v2, s[12:15], s32 offen offset:3072 sc1 lds
L_ldc11:
    s_waitcnt lgkmcnt(0)
    v_cmp_eq_u32 vcc, -1, v40
    s_cbranch_vccnz L_ldr11
L_ldk11:
    s_barrier
    s_waitcnt vmcnt(8)
    ds_read_b32 v40, v46 offset:0
    s_add_u32 m0, s27, 81920
    s_add_u32 s32, s29, 61440
    buffer_load_dwordx4 v2, s[12:15], s32 offen offset:0 sc1 lds
    buffer_load_dwordx4 v2, s[12:15], s32 offen offset:1024 sc1 lds
    buffer_load_dwordx4 v2, s[12:15], s32 offen offset:2048 sc1 lds
    buffer_load_dwordx4 v2, s[12:15], s32 offen offset:3072 sc1 lds
L_ldc12:
    s_waitcnt lgkmcnt(0)
    v_cmp_eq_u32 vcc, -1, v40
    s_cbranch_vccnz L_ldr12
L_ldk12:
    s_barrier
    s_waitcnt vmcnt(8)
    ds_read_b32 v40, v45 offset:0
    buffer_load_dwordx4 v[152:155], v2, s[12:15], s62 offen offset:0
    buffer_load_dwordx4 v[156:159], v2, s[12:15], s63 offen offset:0
    buffer_load_dwordx4 v[160:163], v2, s[12:15], s62 offen offset:1024
    buffer_load_dwordx4 v[164:167], v2, s[12:15], s63 offen offset:1024
    s_add_u32 s62, s62, 4096
    s_add_u32 s63, s63, 4096
L_ldc13:
    s_waitcnt lgkmcnt(0)
    v_cmp_eq_u32 vcc, -1, v40
    s_cbranch_vccnz L_ldr13
L_ldk13:
    s_barrier
    s_waitcnt vmcnt(8)
    ds_read_b32 v40, v44 offset:0
    buffer_load_dwordx4 v[168:171], v2, s[12:15], s62 offen offset:0
    buffer_load_dwordx4 v[172:175], v2, s[12:15], s63 offen offset:0
    buffer_load_dwordx4 v[176:179], v2, s[12:15], s62 offen offset:1024
    buffer_load_dwordx4 v[180:183], v2, s[12:15], s63 offen offset:1024
    s_add_u32 s62, s62, 4096
    s_add_u32 s63, s63, 4096
L_ldc14:
    s_waitcnt lgkmcnt(0)
    v_cmp_eq_u32 vcc, -1, v40
    s_cbranch_vccnz L_ldr14
L_ldk14:
    s_barrier
    s_waitcnt vmcnt(8)
    ds_read_b32 v40, v45 offset:16384
    buffer_load_dwordx4 v[184:187], v2, s[12:15], s62 offen offset:0
    buffer_load_dwordx4 v[188:191], v2, s[12:15], s63 offen offset:0
    buffer_load_dwordx4 v[192:195], v2, s[12:15], s62 offen offset:1024
    buffer_load_dwordx4 v[196:199], v2, s[12:15], s63 offen offset:1024
    s_add_u32 s62, s62, 4096
    s_add_u32 s63, s63, 4096
L_ldc15:
    s_waitcnt lgkmcnt(0)
    v_cmp_eq_u32 vcc, -1, v40
    s_cbranch_vccnz L_ldr15
L_ldk15:
    s_barrier
    s_setprio 0
    buffer_load_dwordx4 v[200:203], v2, s[12:15], s62 offen offset:0
    buffer_load_dwordx4 v[204:207], v2, s[12:15], s63 offen offset:0
    buffer_load_dwordx4 v[208:211], v2, s[12:15], s62 offen offset:1024
    buffer_load_dwordx4 v[212:215], v2, s[12:15], s63 offen offset:1024
    s_add_u32 s62, s62, 4096
    s_add_u32 s63, s63, 4096
    buffer_load_dwordx4 v[216:219], v2, s[12:15], s62 offen offset:0
    buffer_load_dwordx4 v[220:223], v2, s[12:15], s63 offen offset:0
    buffer_load_dwordx4 v[224:227], v2, s[12:15], s62 offen offset:1024
    buffer_load_dwordx4 v[228:231], v2, s[12:15], s63 offen offset:1024
    s_add_u32 s62, s62, 4096
    s_add_u32 s63, s63, 4096
    s_barrier
    s_branch L_Yw2
L_Yskip:
    s_setprio 0
    buffer_load_dwordx4 v[104:107], v2, s[12:15], s62 offen offset:0
    buffer_load_dwordx4 v[108:111], v2, s[12:15], s63 offen offset:0
    buffer_load_dwordx4 v[112:115], v2, s[12:15], s62 offen offset:1024
    buffer_load_dwordx4 v[116:119], v2, s[12:15], s63 offen offset:1024
    s_add_u32 s62, s62, 4096
    s_add_u32 s63, s63, 4096
    buffer_load_dwordx4 v[120:123], v2, s[12:15], s62 offen offset:0
    buffer_load_dwordx4 v[124:127], v2, s[12:15], s63 offen offset:0
    buffer_load_dwordx4 v[128:131], v2, s[12:15], s62 offen offset:1024
    buffer_load_dwordx4 v[132:135], v2, s[12:15], s63 offen offset:1024
    s_add_u32 s62, s62, 4096
    s_add_u32 s63, s63, 4096
    buffer_load_dwordx4 v[136:139], v2, s[12:15], s62 offen offset:0
    buffer_load_dwordx4 v[140:143], v2, s[12:15], s63 offen offset:0
    buffer_load_dwordx4 v[144:147], v2, s[12:15], s62 offen offset:1024
    buffer_load_dwordx4 v[148:151], v2, s[12:15], s63 offen offset:1024
    s_add_u32 s62, s62, 4096
    s_add_u32 s63, s63, 4096
    buffer_load_dwordx4 v[152:155], v2, s[12:15], s62 offen offset:0
    buffer_load_dwordx4 v[156:159], v2, s[12:15], s63 offen offset:0
    buffer_load_dwordx4 v[160:163], v2, s[12:15], s62 offen offset:1024
    buffer_load_dwordx4 v[164:167], v2, s[12:15], s63 offen offset:1024
    s_add_u32 s62, s62, 4096
    s_add_u32 s63, s63, 4096
    buffer_load_dwordx4 v[168:171], v2, s[12:15], s62 offen offset:0
    buffer_load_dwordx4 v[172:175], v2, s[12:15], s63 offen offset:0
    buffer_load_dwordx4 v[176:179], v2, s[12:15], s62 offen offset:1024
    buffer_load_dwordx4 v[180:183], v2, s[12:15], s63 offen offset:1024
    s_add_u32 s62, s62, 4096
    s_add_u32 s63, s63, 4096
    buffer_load_dwordx4 v[184:187], v2, s[12:15], s62 offen offset:0
    buffer_load_dwordx4 v[188:191], v2, s[12:15], s63 offen offset:0
    buffer_load_dwordx4 v[192:195], v2, s[12:15], s62 offen offset:1024
    buffer_load_dwordx4 v[196:199], v2, s[12:15], s63 offen offset:1024
    s_add_u32 s62, s62, 4096
    s_add_u32 s63, s63, 4096
    buffer_load_dwordx4 v[200:203], v2, s[12:15], s62 offen offset:0
    buffer_load_dwordx4 v[204:207], v2, s[12:15], s63 offen offset:0
    buffer_load_dwordx4 v[208:211], v2, s[12:15], s62 offen offset:1024
    buffer_load_dwordx4 v[212:215], v2, s[12:15], s63 offen offset:1024
    s_add_u32 s62, s62, 4096
    s_add_u32 s63, s63, 4096
    buffer_load_dwordx4 v[216:219], v2, s[12:15], s62 offen offset:0
    buffer_load_dwordx4 v[220:223], v2, s[12:15], s63 offen offset:0
    buffer_load_dwordx4 v[224:227], v2, s[12:15], s62 offen offset:1024
    buffer_load_dwordx4 v[228:231], v2, s[12:15], s63 offen offset:1024
    s_add_u32 s62, s62, 4096
    s_add_u32 s63, s63, 4096
L_Yw2:
    buffer_load_dwordx4 v[232:235], v2, s[12:15], s62 offen offset:0
    buffer_load_dwordx4 v[236:239], v2, s[12:15], s63 offen offset:0
    s_waitcnt vmcnt(24)
    buffer_load_dwordx4 v[240:243], v2, s[12:15], s62 offen offset:1024
    buffer_load_dwordx4 v[244:247], v2, s[12:15], s63 offen offset:1024
    s_add_u32 s62, s62, 4096
    s_add_u32 s63, s63, 4096
    s_waitcnt vmcnt(24)
    buffer_load_dwordx4 v[248:251], v2, s[12:15], s62 offen offset:0
    buffer_load_dwordx4 v[252:255], v2, s[12:15], s63 offen offset:0
    s_waitcnt vmcnt(24)
    s_sub_u32 m0, s64, 1024
    s_nop 0
    buffer_load_dwordx4 v2, s[12:15], s62 offen offset:1024 lds
    s_add_u32 m0, s64, 0
    s_nop 0
    buffer_load_dwordx4 v2, s[12:15], s63 offen offset:1024 lds
    s_add_u32 s62, s62, 4096
    s_add_u32 s63, s63, 4096
    s_waitcnt vmcnt(24)
    s_add_u32 m0, s64, 2048
    s_nop 0
    buffer_load_dwordx4 v2, s[12:15], s62 offen offset:0 lds
    s_add_u32 m0, s64, 3072
    s_nop 0
    buffer_load_dwordx4 v2, s[12:15], s63 offen offset:0 lds
    s_waitcnt vmcnt(24)
    s_add_u32 m0, s64, 3072
    s_nop 0
    buffer_load_dwordx4 v2, s[12:15], s62 offen offset:1024 lds
    s_add_u32 m0, s64, 4096
    s_nop 0
    buffer_load_dwordx4 v2, s[12:15], s63 offen offset:1024 lds
    s_add_u32 s62, s62, 4096
    s_add_u32 s63, s63, 4096
    s_waitcnt vmcnt(24)
    s_add_u32 m0, s64, 6144
    s_nop 0
    buffer_load_dwordx4 v2, s[12:15], s62 offen offset:0 lds
    s_add_u32 m0, s64, 7168
    s_nop 0
    buffer_load_dwordx4 v2, s[12:15], s63 offen offset:0 lds
    s_waitcnt vmcnt(24)
    s_add_u32 m0, s64, 7168
    s_nop 0
    buffer_load_dwordx4 v2, s[12:15], s62 offen offset:1024 lds
    s_add_u32 m0, s64, 8192
    s_nop 0
    buffer_load_dwordx4 v2, s[12:15], s63 offen offset:1024 lds
    s_add_u32 s62, s62, 4096
    s_add_u32 s63, s63, 4096
    s_waitcnt vmcnt(24)
    s_mov_b32 s44, s42
    s_mov_b32 s45, s43
    s_mov_b32 s42, 4096
    s_mov_b32 s43, 0x00020000
    s_mov_b32 s46, 2621440
    s_mov_b32 s47, 0x00020000
    s_lshl_b32 s27, s19, 4
    v_add_u32 v8, s27, v6
    v_mul_u32_u24 v9, 1280, v8
    v_lshl_add_u32 v9, v7, 3, v9
    s_mul_i32 s27, s17, 160
    v_add_u32 v9, s27, v9
    v_lshlrev_b32 v8, 1, v8
    buffer_load_ushort v12, v8, s[40:43], 0 offen
    s_lshl_b32 s27, s56, 11
    v_add_u32 v3, s27, v2
    v_add_u32 v4, 61440, v3
    v_add_u32 v10, 122880, v3
    v_add_u32 v5, s64, v2
    s_barrier
    s_mul_i32 s28, s25, 5120
    s_add_u32 s28, s28, 81920
    v_add_u32 v11, s28, v2
    s_xor_b32 s28, s25, 1
    s_mul_i32 s28, s28, 5120
    s_add_u32 s28, s28, 81920
    v_add_u32 v6, s28, v2
    v_and_b32 v8, 1, v7
    v_mul_u32_u24 v8, 24, v8
    v_add_u32 v8, v9, v8
    v_lshlrev_b32 v44, 16, v14
    v_and_b32 v45, 0xffff0000, v14
    v_lshlrev_b32 v46, 16, v15
    v_and_b32 v47, 0xffff0000, v15
    v_lshlrev_b32 v48, 16, v16
    v_and_b32 v49, 0xffff0000, v16
    v_lshlrev_b32 v50, 16, v17
    v_and_b32 v51, 0xffff0000, v17
    v_lshlrev_b32 v52, 16, v18
    v_and_b32 v53, 0xffff0000, v18
    v_lshlrev_b32 v54, 16, v19
    v_and_b32 v55, 0xffff0000, v19
    v_lshlrev_b32 v56, 16, v20
    v_and_b32 v57, 0xffff0000, v20
    v_lshlrev_b32 v58, 16, v21
    v_and_b32 v59, 0xffff0000, v21
    v_lshlrev_b32 v60, 16, v22
    v_and_b32 v61, 0xffff0000, v22
    v_lshlrev_b32 v62, 16, v23
    v_and_b32 v63, 0xffff0000, v23
    s_waitcnt vmcnt(0)
    v_lshlrev_b32 v12, 16, v12
    v_pk_add_f32 v[44:45], v[44:45], v[12:13] op_sel_hi:[1,0]
    v_pk_add_f32 v[46:47], v[46:47], v[12:13] op_sel_hi:[1,0]
    v_pk_add_f32 v[48:49], v[48:49], v[12:13] op_sel_hi:[1,0]
    v_pk_add_f32 v[50:51], v[50:51], v[12:13] op_sel_hi:[1,0]
    v_pk_add_f32 v[52:53], v[52:53], v[12:13] op_sel_hi:[1,0]
    v_pk_add_f32 v[54:55], v[54:55], v[12:13] op_sel_hi:[1,0]
    v_pk_add_f32 v[56:57], v[56:57], v[12:13] op_sel_hi:[1,0]
    v_pk_add_f32 v[58:59], v[58:59], v[12:13] op_sel_hi:[1,0]
    v_pk_add_f32 v[60:61], v[60:61], v[12:13] op_sel_hi:[1,0]
    v_pk_add_f32 v[62:63], v[62:63], v[12:13] op_sel_hi:[1,0]
    s_barrier
    ds_read_b128 v[64:67], v3 offset:0
    ds_read_b128 v[68:71], v3 offset:4096
    ds_read_b128 v[72:75], v3 offset:8192
    ds_read_b128 v[76:79], v3 offset:12288
    ds_read_b128 v[80:83], v3 offset:16384
    s_setprio 3
    s_waitcnt lgkmcnt(4)
    v_mfma_f32_16x16x32_bf16 v[24:27], v[64:67], v[104:107], 0
    ds_read_b128 v[84:87], v3 offset:1024
    v_mfma_f32_16x16x32_bf16 v[44:47], v[64:67], v[108:111], v[44:47]
    s_waitcnt lgkmcnt(4)
    v_mfma_f32_16x16x32_bf16 v[28:31], v[68:71], v[104:107], 0
    ds_read_b128 v[88:91], v3 offset:5120
    v_mfma_f32_16x16x32_bf16 v[48:51], v[68:71], v[108:111], v[48:51]
    s_waitcnt lgkmcnt(4)
    v_mfma_f32_16x16x32_bf16 v[32:35], v[72:75], v[104:107], 0
    ds_read_b128 v[92:95], v3 offset:9216
    v_mfma_f32_16x16x32_bf16 v[52:55], v[72:75], v[108:111], v[52:55]
    s_waitcnt lgkmcnt(4)
    v_mfma_f32_16x16x32_bf16 v[36:39], v[76:79], v[104:107], 0
    ds_read_b128 v[96:99], v3 offset:13312
    v_mfma_f32_16x16x32_bf16 v[56:59], v[76:79], v[108:111], v[56:59]
    s_waitcnt lgkmcnt(4)
    v_mfma_f32_16x16x32_bf16 v[40:43], v[80:83], v[104:107], 0
    ds_read_b128 v[100:103], v3 offset:17408
    v_mfma_f32_16x16x32_bf16 v[60:63], v[80:83], v[108:111], v[60:63]
    ds_read_b128 v[104:107], v5 offset:0
    ds_read_b128 v[108:111], v5 offset:1024
    s_waitcnt lgkmcnt(6)
    v_mfma_f32_16x16x32_bf16 v[24:27], v[84:87], v[112:115], v[24:27]
    s_barrier
    ds_read_b128 v[64:67], v3 offset:20480
    v_mfma_f32_16x16x32_bf16 v[44:47], v[84:87], v[116:119], v[44:47]
    s_waitcnt lgkmcnt(6)
    v_mfma_f32_16x16x32_bf16 v[28:31], v[88:91], v[112:115], v[28:31]
    ds_read_b128 v[68:71], v3 offset:24576
    v_mfma_f32_16x16x32_bf16 v[48:51], v[88:91], v[116:119], v[48:51]
    s_waitcnt lgkmcnt(6)
    v_mfma_f32_16x16x32_bf16 v[32:35], v[92:95], v[112:115], v[32:35]
    ds_read_b128 v[72:75], v3 offset:28672
    v_mfma_f32_16x16x32_bf16 v[52:55], v[92:95], v[116:119], v[52:55]
    s_waitcnt lgkmcnt(6)
    v_mfma_f32_16x16x32_bf16 v[36:39], v[96:99], v[112:115], v[36:39]
    ds_read_b128 v[76:79], v3 offset:32768
    v_mfma_f32_16x16x32_bf16 v[56:59], v[96:99], v[116:119], v[56:59]
    s_waitcnt lgkmcnt(6)
    v_mfma_f32_16x16x32_bf16 v[40:43], v[100:103], v[112:115], v[40:43]
    ds_read_b128 v[80:83], v3 offset:36864
    v_mfma_f32_16x16x32_bf16 v[60:63], v[100:103], v[116:119], v[60:63]
    ds_read_b128 v[112:115], v5 offset:2048
    ds_read_b128 v[116:119], v5 offset:3072
    s_waitcnt lgkmcnt(6)
    v_mfma_f32_16x16x32_bf16 v[24:27], v[64:67], v[120:123], v[24:27]
    ds_read_b128 v[84:87], v3 offset:21504
    v_mfma_f32_16x16x32_bf16 v[44:47], v[64:67], v[124:127], v[44:47]
    s_waitcnt lgkmcnt(6)
    v_mfma_f32_16x16x32_bf16 v[28:31], v[68:71], v[120:123], v[28:31]
    ds_read_b128 v[88:91], v3 offset:25600
    v_mfma_f32_16x16x32_bf16 v[48:51], v[68:71], v[124:127], v[48:51]
    s_waitcnt lgkmcnt(6)
    v_mfma_f32_16x16x32_bf16 v[32:35], v[72:75], v[120:123], v[32:35]
    ds_read_b128 v[92:95], v3 offset:29696
    v_mfma_f32_16x16x32_bf16 v[52:55], v[72:75], v[124:127], v[52:55]
    s_waitcnt lgkmcnt(6)
    v_mfma_f32_16x16x32_bf16 v[36:39], v[76:79], v[120:123], v[36:39]
    ds_read_b128 v[96:99], v3 offset:33792
    v_mfma_f32_16x16x32_bf16 v[56:59], v[76:79], v[124:127], v[56:59]
    s_waitcnt lgkmcnt(6)
    v_mfma_f32_16x16x32_bf16 v[40:43], v[80:83], v[120:123], v[40:43]
    ds_read_b128 v[100:103], v3 offset:37888
    v_mfma_f32_16x16x32_bf16 v[60:63], v[80:83], v[124:127], v[60:63]
    ds_read_b128 v[120:123], v5 offset:4096
    ds_read_b128 v[124:127], v5 offset:5120
    s_waitcnt lgkmcnt(6)
    v_mfma_f32_16x16x32_bf16 v[24:27], v[84:87], v[128:131], v[24:27]
    s_barrier
    ds_read_b128 v[64:67], v3 offset:40960
    v_mfma_f32_16x16x32_bf16 v[44:47], v[84:87], v[132:135], v[44:47]
    s_waitcnt lgkmcnt(6)
    v_mfma_f32_16x16x32_bf16 v[28:31], v[88:91], v[128:131], v[28:31]
    ds_read_b128 v[68:71], v3 offset:45056
    v_mfma_f32_16x16x32_bf16 v[48:51], v[88:91], v[132:135], v[48:51]
    s_waitcnt lgkmcnt(6)
    v_mfma_f32_16x16x32_bf16 v[32:35], v[92:95], v[128:131], v[32:35]
    ds_read_b128 v[72:75], v3 offset:49152
    v_mfma_f32_16x16x32_bf16 v[52:55], v[92:95], v[132:135], v[52:55]
    s_waitcnt lgkmcnt(6)
    v_mfma_f32_16x16x32_bf16 v[36:39], v[96:99], v[128:131], v[36:39]
    ds_read_b128 v[76:79], v3 offset:53248
    v_mfma_f32_16x16x32_bf16 v[56:59], v[96:99], v[132:135], v[56:59]
    s_waitcnt lgkmcnt(6)
    v_mfma_f32_16x16x32_bf16 v[40:43], v[100:103], v[128:131], v[40:43]
    ds_read_b128 v[80:83], v3 offset:57344
    v_mfma_f32_16x16x32_bf16 v[60:63], v[100:103], v[132:135], v[60:63]
    ds_read_b128 v[128:131], v5 offset:6144
    ds_read_b128 v[132:135], v5 offset:7168
    s_waitcnt lgkmcnt(6)
    v_mfma_f32_16x16x32_bf16 v[24:27], v[64:67], v[136:139], v[24:27]
    ds_read_b128 v[84:87], v3 offset:41984
    v_mfma_f32_16x16x32_bf16 v[44:47], v[64:67], v[140:143], v[44:47]
    s_waitcnt lgkmcnt(6)
    v_mfma_f32_16x16x32_bf16 v[28:31], v[68:71], v[136:139], v[28:31]
    ds_read_b128 v[88:91], v3 offset:46080
    v_mfma_f32_16x16x32_bf16 v[48:51], v[68:71], v[140:143], v[48:51]
    s_waitcnt lgkmcnt(6)
    v_mfma_f32_16x16x32_bf16 v[32:35], v[72:75], v[136:139], v[32:35]
    ds_read_b128 v[92:95], v3 offset:50176
    v_mfma_f32_16x16x32_bf16 v[52:55], v[72:75], v[140:143], v[52:55]
    s_waitcnt lgkmcnt(6)
    v_mfma_f32_16x16x32_bf16 v[36:39], v[76:79], v[136:139], v[36:39]
    ds_read_b128 v[96:99], v3 offset:54272
    v_mfma_f32_16x16x32_bf16 v[56:59], v[76:79], v[140:143], v[56:59]
    s_waitcnt lgkmcnt(6)
    v_mfma_f32_16x16x32_bf16 v[40:43], v[80:83], v[136:139], v[40:43]
    ds_read_b128 v[100:103], v3 offset:58368
    v_mfma_f32_16x16x32_bf16 v[60:63], v[80:83], v[140:143], v[60:63]
    ds_read_b128 v[136:139], v5 offset:8192
    ds_read_b128 v[140:143], v5 offset:9216
    s_waitcnt lgkmcnt(6)
    v_mfma_f32_16x16x32_bf16 v[24:27], v[84:87], v[144:147], v[24:27]
    s_barrier
    ds_read_b128 v[64:67], v4 offset:0
    v_mfma_f32_16x16x32_bf16 v[44:47], v[84:87], v[148:151], v[44:47]
    s_waitcnt lgkmcnt(6)
    v_mfma_f32_16x16x32_bf16 v[28:31], v[88:91], v[144:147], v[28:31]
    ds_read_b128 v[68:71], v4 offset:4096
    v_mfma_f32_16x16x32_bf16 v[48:51], v[88:91], v[148:151], v[48:51]
    s_waitcnt lgkmcnt(6)
    v_mfma_f32_16x16x32_bf16 v[32:35], v[92:95], v[144:147], v[32:35]
    ds_read_b128 v[72:75], v4 offset:8192
    v_mfma_f32_16x16x32_bf16 v[52:55], v[92:95], v[148:151], v[52:55]
    s_waitcnt lgkmcnt(6)
    v_mfma_f32_16x16x32_bf16 v[36:39], v[96:99], v[144:147], v[36:39]
    ds_read_b128 v[76:79], v4 offset:12288
    v_mfma_f32_16x16x32_bf16 v[56:59], v[96:99], v[148:151], v[56:59]
    s_waitcnt lgkmcnt(6)
    v_mfma_f32_16x16x32_bf16 v[40:43], v[100:103], v[144:147], v[40:43]
    ds_read_b128 v[80:83], v4 offset:16384
    v_mfma_f32_16x16x32_bf16 v[60:63], v[100:103], v[148:151], v[60:63]
    s_waitcnt lgkmcnt(4)
    v_mfma_f32_16x16x32_bf16 v[24:27], v[64:67], v[152:155], v[24:27]
    ds_read_b128 v[84:87], v4 offset:1024
    v_mfma_f32_16x16x32_bf16 v[44:47], v[64:67], v[156:159], v[44:47]
    s_waitcnt lgkmcnt(4)
    v_mfma_f32_16x16x32_bf16 v[28:31], v[68:71], v[152:155], v[28:31]
    ds_read_b128 v[88:91], v4 offset:5120
    v_mfma_f32_16x16x32_bf16 v[48:51], v[68:71], v[156:159], v[48:51]
    s_waitcnt lgkmcnt(4)
    v_mfma_f32_16x16x32_bf16 v[32:35], v[72:75], v[152:155], v[32:35]
    ds_read_b128 v[92:95], v4 offset:9216
    v_mfma_f32_16x16x32_bf16 v[52:55], v[72:75], v[156:159], v[52:55]
    s_waitcnt lgkmcnt(4)
    v_mfma_f32_16x16x32_bf16 v[36:39], v[76:79], v[152:155], v[36:39]
    ds_read_b128 v[96:99], v4 offset:13312
    v_mfma_f32_16x16x32_bf16 v[56:59], v[76:79], v[156:159], v[56:59]
    s_waitcnt lgkmcnt(4)
    v_mfma_f32_16x16x32_bf16 v[40:43], v[80:83], v[152:155], v[40:43]
    ds_read_b128 v[100:103], v4 offset:17408
    v_mfma_f32_16x16x32_bf16 v[60:63], v[80:83], v[156:159], v[60:63]
    s_waitcnt lgkmcnt(4)
    v_mfma_f32_16x16x32_bf16 v[24:27], v[84:87], v[160:163], v[24:27]
    s_barrier
    ds_read_b128 v[64:67], v4 offset:20480
    v_mfma_f32_16x16x32_bf16 v[44:47], v[84:87], v[164:167], v[44:47]
    s_waitcnt lgkmcnt(4)
    v_mfma_f32_16x16x32_bf16 v[28:31], v[88:91], v[160:163], v[28:31]
    ds_read_b128 v[68:71], v4 offset:24576
    v_mfma_f32_16x16x32_bf16 v[48:51], v[88:91], v[164:167], v[48:51]
    s_waitcnt lgkmcnt(4)
    v_mfma_f32_16x16x32_bf16 v[32:35], v[92:95], v[160:163], v[32:35]
    ds_read_b128 v[72:75], v4 offset:28672
    v_mfma_f32_16x16x32_bf16 v[52:55], v[92:95], v[164:167], v[52:55]
    s_waitcnt lgkmcnt(4)
    v_mfma_f32_16x16x32_bf16 v[36:39], v[96:99], v[160:163], v[36:39]
    ds_read_b128 v[76:79], v4 offset:32768
    v_mfma_f32_16x16x32_bf16 v[56:59], v[96:99], v[164:167], v[56:59]
    s_waitcnt lgkmcnt(4)
    v_mfma_f32_16x16x32_bf16 v[40:43], v[100:103], v[160:163], v[40:43]
    ds_read_b128 v[80:83], v4 offset:36864
    v_mfma_f32_16x16x32_bf16 v[60:63], v[100:103], v[164:167], v[60:63]
    s_waitcnt lgkmcnt(4)
    v_mfma_f32_16x16x32_bf16 v[24:27], v[64:67], v[168:171], v[24:27]
    ds_read_b128 v[84:87], v4 offset:21504
    v_mfma_f32_16x16x32_bf16 v[44:47], v[64:67], v[172:175], v[44:47]
    s_waitcnt lgkmcnt(4)
    v_mfma_f32_16x16x32_bf16 v[28:31], v[68:71], v[168:171], v[28:31]
    ds_read_b128 v[88:91], v4 offset:25600
    v_mfma_f32_16x16x32_bf16 v[48:51], v[68:71], v[172:175], v[48:51]
    s_waitcnt lgkmcnt(4)
    v_mfma_f32_16x16x32_bf16 v[32:35], v[72:75], v[168:171], v[32:35]
    ds_read_b128 v[92:95], v4 offset:29696
    v_mfma_f32_16x16x32_bf16 v[52:55], v[72:75], v[172:175], v[52:55]
    s_waitcnt lgkmcnt(4)
    v_mfma_f32_16x16x32_bf16 v[36:39], v[76:79], v[168:171], v[36:39]
    ds_read_b128 v[96:99], v4 offset:33792
    v_mfma_f32_16x16x32_bf16 v[56:59], v[76:79], v[172:175], v[56:59]
    s_waitcnt lgkmcnt(4)
    v_mfma_f32_16x16x32_bf16 v[40:43], v[80:83], v[168:171], v[40:43]
    ds_read_b128 v[100:103], v4 offset:37888
    v_mfma_f32_16x16x32_bf16 v[60:63], v[80:83], v[172:175], v[60:63]
    s_waitcnt lgkmcnt(4)
    v_mfma_f32_16x16x32_bf16 v[24:27], v[84:87], v[176:179], v[24:27]
    s_barrier
    ds_read_b128 v[64:67], v10 offset:20480
    v_mfma_f32_16x16x32_bf16 v[44:47], v[84:87], v[180:183], v[44:47]
    s_waitcnt lgkmcnt(4)
    v_mfma_f32_16x16x32_bf16 v[28:31], v[88:91], v[176:179], v[28:31]
    ds_read_b128 v[68:71], v10 offset:24576
    v_mfma_f32_16x16x32_bf16 v[48:51], v[88:91], v[180:183], v[48:51]
    s_waitcnt lgkmcnt(4)
    v_mfma_f32_16x16x32_bf16 v[32:35], v[92:95], v[176:179], v[32:35]
    ds_read_b128 v[72:75], v10 offset:28672
    v_mfma_f32_16x16x32_bf16 v[52:55], v[92:95], v[180:183], v[52:55]
    s_waitcnt lgkmcnt(4)
    v_mfma_f32_16x16x32_bf16 v[36:39], v[96:99], v[176:179], v[36:39]
    ds_read_b128 v[76:79], v10 offset:32768
    v_mfma_f32_16x16x32_bf16 v[56:59], v[96:99], v[180:183], v[56:59]
    s_waitcnt lgkmcnt(4)
    v_mfma_f32_16x16x32_bf16 v[40:43], v[100:103], v[176:179], v[40:43]
    ds_read_b128 v[80:83], v10 offset:36864
    v_mfma_f32_16x16x32_bf16 v[60:63], v[100:103], v[180:183], v[60:63]
    s_waitcnt lgkmcnt(4)
    v_mfma_f32_16x16x32_bf16 v[24:27], v[64:67], v[184:187], v[24:27]
    ds_read_b128 v[84:87], v10 offset:21504
    v_mfma_f32_16x16x32_bf16 v[44:47], v[64:67], v[188:191], v[44:47]
    s_waitcnt lgkmcnt(4)
    v_mfma_f32_16x16x32_bf16 v[28:31], v[68:71], v[184:187], v[28:31]
    ds_read_b128 v[88:91], v10 offset:25600
    v_mfma_f32_16x16x32_bf16 v[48:51], v[68:71], v[188:191], v[48:51]
    s_waitcnt lgkmcnt(4)
    v_mfma_f32_16x16x32_bf16 v[32:35], v[72:75], v[184:187], v[32:35]
    ds_read_b128 v[92:95], v10 offset:29696
    v_mfma_f32_16x16x32_bf16 v[52:55], v[72:75], v[188:191], v[52:55]
    s_waitcnt lgkmcnt(4)
    v_mfma_f32_16x16x32_bf16 v[36:39], v[76:79], v[184:187], v[36:39]
    ds_read_b128 v[96:99], v10 offset:33792
    v_mfma_f32_16x16x32_bf16 v[56:59], v[76:79], v[188:191], v[56:59]
    s_waitcnt lgkmcnt(4)
    v_mfma_f32_16x16x32_bf16 v[40:43], v[80:83], v[184:187], v[40:43]
    ds_read_b128 v[100:103], v10 offset:37888
    v_mfma_f32_16x16x32_bf16 v[60:63], v[80:83], v[188:191], v[60:63]
    s_waitcnt lgkmcnt(4)
    v_mfma_f32_16x16x32_bf16 v[24:27], v[84:87], v[192:195], v[24:27]
    s_barrier
    ds_read_b128 v[64:67], v3 offset:0
    v_mfma_f32_16x16x32_bf16 v[44:47], v[84:87], v[196:199], v[44:47]
    s_waitcnt lgkmcnt(4)
    v_mfma_f32_16x16x32_bf16 v[28:31], v[88:91], v[192:195], v[28:31]
    ds_read_b128 v[68:71], v3 offset:4096
    v_mfma_f32_16x16x32_bf16 v[48:51], v[88:91], v[196:199], v[48:51]
    s_waitcnt lgkmcnt(4)
    v_mfma_f32_16x16x32_bf16 v[32:35], v[92:95], v[192:195], v[32:35]
    ds_read_b128 v[72:75], v3 offset:8192
    v_mfma_f32_16x16x32_bf16 v[52:55], v[92:95], v[196:199], v[52:55]
    s_waitcnt lgkmcnt(4)
    v_mfma_f32_16x16x32_bf16 v[36:39], v[96:99], v[192:195], v[36:39]
    ds_read_b128 v[76:79], v3 offset:12288
    v_mfma_f32_16x16x32_bf16 v[56:59], v[96:99], v[196:199], v[56:59]
    s_waitcnt lgkmcnt(4)
    v_mfma_f32_16x16x32_bf16 v[40:43], v[100:103], v[192:195], v[40:43]
    ds_read_b128 v[80:83], v3 offset:16384
    v_mfma_f32_16x16x32_bf16 v[60:63], v[100:103], v[196:199], v[60:63]
    s_waitcnt lgkmcnt(4)
    v_mfma_f32_16x16x32_bf16 v[24:27], v[64:67], v[200:203], v[24:27]
    ds_read_b128 v[84:87], v3 offset:1024
    v_mfma_f32_16x16x32_bf16 v[44:47], v[64:67], v[204:207], v[44:47]
    s_waitcnt lgkmcnt(4)
    v_mfma_f32_16x16x32_bf16 v[28:31], v[68:71], v[200:203], v[28:31]
    ds_read_b128 v[88:91], v3 offset:5120
    v_mfma_f32_16x16x32_bf16 v[48:51], v[68:71], v[204:207], v[48:51]
    s_waitcnt lgkmcnt(4)
    v_mfma_f32_16x16x32_bf16 v[32:35], v[72:75], v[200:203], v[32:35]
    ds_read_b128 v[92:95], v3 offset:9216
    v_mfma_f32_16x16x32_bf16 v[52:55], v[72:75], v[204:207], v[52:55]
    s_waitcnt lgkmcnt(4)
    v_mfma_f32_16x16x32_bf16 v[36:39], v[76:79], v[200:203], v[36:39]
    ds_read_b128 v[96:99], v3 offset:13312
    v_mfma_f32_16x16x32_bf16 v[56:59], v[76:79], v[204:207], v[56:59]
    s_waitcnt lgkmcnt(4)
    v_mfma_f32_16x16x32_bf16 v[40:43], v[80:83], v[200:203], v[40:43]
    ds_read_b128 v[100:103], v3 offset:17408
    v_mfma_f32_16x16x32_bf16 v[60:63], v[80:83], v[204:207], v[60:63]
    s_waitcnt lgkmcnt(4)
    v_mfma_f32_16x16x32_bf16 v[24:27], v[84:87], v[208:211], v[24:27]
    s_barrier
    ds_read_b128 v[64:67], v3 offset:20480
    v_mfma_f32_16x16x32_bf16 v[44:47], v[84:87], v[212:215], v[44:47]
    s_waitcnt lgkmcnt(4)
    v_mfma_f32_16x16x32_bf16 v[28:31], v[88:91], v[208:211], v[28:31]
    ds_read_b128 v[68:71], v3 offset:24576
    v_mfma_f32_16x16x32_bf16 v[48:51], v[88:91], v[212:215], v[48:51]
    s_waitcnt lgkmcnt(4)
    v_mfma_f32_16x16x32_bf16 v[32:35], v[92:95], v[208:211], v[32:35]
    ds_read_b128 v[72:75], v3 offset:28672
    v_mfma_f32_16x16x32_bf16 v[52:55], v[92:95], v[212:215], v[52:55]
    s_waitcnt lgkmcnt(4)
    v_mfma_f32_16x16x32_bf16 v[36:39], v[96:99], v[208:211], v[36:39]
    ds_read_b128 v[76:79], v3 offset:32768
    v_mfma_f32_16x16x32_bf16 v[56:59], v[96:99], v[212:215], v[56:59]
    s_waitcnt lgkmcnt(4)
    v_mfma_f32_16x16x32_bf16 v[40:43], v[100:103], v[208:211], v[40:43]
    ds_read_b128 v[80:83], v3 offset:36864
    v_mfma_f32_16x16x32_bf16 v[60:63], v[100:103], v[212:215], v[60:63]
    s_waitcnt lgkmcnt(4)
    v_mfma_f32_16x16x32_bf16 v[24:27], v[64:67], v[216:219], v[24:27]
    ds_read_b128 v[84:87], v3 offset:21504
    v_mfma_f32_16x16x32_bf16 v[44:47], v[64:67], v[220:223], v[44:47]
    s_waitcnt lgkmcnt(4)
    v_mfma_f32_16x16x32_bf16 v[28:31], v[68:71], v[216:219], v[28:31]
    ds_read_b128 v[88:91], v3 offset:25600
    v_mfma_f32_16x16x32_bf16 v[48:51], v[68:71], v[220:223], v[48:51]
    s_waitcnt lgkmcnt(4)
    v_mfma_f32_16x16x32_bf16 v[32:35], v[72:75], v[216:219], v[32:35]
    ds_read_b128 v[92:95], v3 offset:29696
    v_mfma_f32_16x16x32_bf16 v[52:55], v[72:75], v[220:223], v[52:55]
    s_waitcnt lgkmcnt(4)
    v_mfma_f32_16x16x32_bf16 v[36:39], v[76:79], v[216:219], v[36:39]
    ds_read_b128 v[96:99], v3 offset:33792
    v_mfma_f32_16x16x32_bf16 v[56:59], v[76:79], v[220:223], v[56:59]
    s_waitcnt lgkmcnt(4)
    v_mfma_f32_16x16x32_bf16 v[40:43], v[80:83], v[216:219], v[40:43]
    ds_read_b128 v[100:103], v3 offset:37888
    v_mfma_f32_16x16x32_bf16 v[60:63], v[80:83], v[220:223], v[60:63]
    s_waitcnt lgkmcnt(4)
    v_mfma_f32_16x16x32_bf16 v[24:27], v[84:87], v[224:227], v[24:27]
    s_barrier
    ds_read_b128 v[64:67], v3 offset:40960
    v_mfma_f32_16x16x32_bf16 v[44:47], v[84:87], v[228:231], v[44:47]
    s_waitcnt lgkmcnt(4)
    v_mfma_f32_16x16x32_bf16 v[28:31], v[88:91], v[224:227], v[28:31]
    ds_read_b128 v[68:71], v3 offset:45056
    v_mfma_f32_16x16x32_bf16 v[48:51], v[88:91], v[228:231], v[48:51]
    s_waitcnt lgkmcnt(4)
    v_mfma_f32_16x16x32_bf16 v[32:35], v[92:95], v[224:227], v[32:35]
    ds_read_b128 v[72:75], v3 offset:49152
    v_mfma_f32_16x16x32_bf16 v[52:55], v[92:95], v[228:231], v[52:55]
    s_waitcnt lgkmcnt(4)
    v_mfma_f32_16x16x32_bf16 v[36:39], v[96:99], v[224:227], v[36:39]
    ds_read_b128 v[76:79], v3 offset:53248
    v_mfma_f32_16x16x32_bf16 v[56:59], v[96:99], v[228:231], v[56:59]
    s_waitcnt lgkmcnt(4)
    v_mfma_f32_16x16x32_bf16 v[40:43], v[100:103], v[224:227], v[40:43]
    ds_read_b128 v[80:83], v3 offset:57344
    v_mfma_f32_16x16x32_bf16 v[60:63], v[100:103], v[228:231], v[60:63]
    s_waitcnt lgkmcnt(4)
    v_mfma_f32_16x16x32_bf16 v[24:27], v[64:67], v[232:235], v[24:27]
    ds_read_b128 v[84:87], v3 offset:41984
    v_mfma_f32_16x16x32_bf16 v[44:47], v[64:67], v[236:239], v[44:47]
    s_waitcnt lgkmcnt(4)
    v_mfma_f32_16x16x32_bf16 v[28:31], v[68:71], v[232:235], v[28:31]
    ds_read_b128 v[88:91], v3 offset:46080
    v_mfma_f32_16x16x32_bf16 v[48:51], v[68:71], v[236:239], v[48:51]
    s_waitcnt lgkmcnt(4)
    v_mfma_f32_16x16x32_bf16 v[32:35], v[72:75], v[232:235], v[32:35]
    ds_read_b128 v[92:95], v3 offset:50176
    v_mfma_f32_16x16x32_bf16 v[52:55], v[72:75], v[236:239], v[52:55]
    s_waitcnt lgkmcnt(4)
    v_mfma_f32_16x16x32_bf16 v[36:39], v[76:79], v[232:235], v[36:39]
    ds_read_b128 v[96:99], v3 offset:54272
    v_mfma_f32_16x16x32_bf16 v[56:59], v[76:79], v[236:239], v[56:59]
    s_waitcnt lgkmcnt(4)
    v_mfma_f32_16x16x32_bf16 v[40:43], v[80:83], v[232:235], v[40:43]
    ds_read_b128 v[100:103], v3 offset:58368
    v_mfma_f32_16x16x32_bf16 v[60:63], v[80:83], v[236:239], v[60:63]
    s_waitcnt lgkmcnt(4)
    v_mfma_f32_16x16x32_bf16 v[24:27], v[84:87], v[240:243], v[24:27]
    s_barrier
    ds_read_b128 v[64:67], v4 offset:40960
    v_mfma_f32_16x16x32_bf16 v[44:47], v[84:87], v[244:247], v[44:47]
    s_waitcnt lgkmcnt(4)
    v_mfma_f32_16x16x32_bf16 v[28:31], v[88:91], v[240:243], v[28:31]
    ds_read_b128 v[68:71], v4 offset:45056
    v_mfma_f32_16x16x32_bf16 v[48:51], v[88:91], v[244:247], v[48:51]
    s_waitcnt lgkmcnt(4)
    v_mfma_f32_16x16x32_bf16 v[32:35], v[92:95], v[240:243], v[32:35]
    ds_read_b128 v[72:75], v4 offset:49152
    v_mfma_f32_16x16x32_bf16 v[52:55], v[92:95], v[244:247], v[52:55]
    s_waitcnt lgkmcnt(4)
    v_mfma_f32_16x16x32_bf16 v[36:39], v[96:99], v[240:243], v[36:39]
    ds_read_b128 v[76:79], v4 offset:53248
    v_mfma_f32_16x16x32_bf16 v[56:59], v[96:99], v[244:247], v[56:59]
    s_waitcnt lgkmcnt(4)
    v_mfma_f32_16x16x32_bf16 v[40:43], v[100:103], v[240:243], v[40:43]
    ds_read_b128 v[80:83], v4 offset:57344
    v_mfma_f32_16x16x32_bf16 v[60:63], v[100:103], v[244:247], v[60:63]
    s_waitcnt lgkmcnt(4)
    v_mfma_f32_16x16x32_bf16 v[24:27], v[64:67], v[248:251], v[24:27]
    ds_read_b128 v[84:87], v4 offset:41984
    v_mfma_f32_16x16x32_bf16 v[44:47], v[64:67], v[252:255], v[44:47]
    s_waitcnt lgkmcnt(4)
    v_mfma_f32_16x16x32_bf16 v[28:31], v[68:71], v[248:251], v[28:31]
    ds_read_b128 v[88:91], v4 offset:46080
    v_mfma_f32_16x16x32_bf16 v[48:51], v[68:71], v[252:255], v[48:51]
    s_waitcnt lgkmcnt(4)
    v_mfma_f32_16x16x32_bf16 v[32:35], v[72:75], v[248:251], v[32:35]
    ds_read_b128 v[92:95], v4 offset:50176
    v_mfma_f32_16x16x32_bf16 v[52:55], v[72:75], v[252:255], v[52:55]
    s_waitcnt lgkmcnt(4)
    v_mfma_f32_16x16x32_bf16 v[36:39], v[76:79], v[248:251], v[36:39]
    ds_read_b128 v[96:99], v4 offset:54272
    v_mfma_f32_16x16x32_bf16 v[56:59], v[76:79], v[252:255], v[56:59]
    s_waitcnt lgkmcnt(4)
    v_mfma_f32_16x16x32_bf16 v[40:43], v[80:83], v[248:251], v[40:43]
    ds_read_b128 v[100:103], v4 offset:58368
    v_mfma_f32_16x16x32_bf16 v[60:63], v[80:83], v[252:255], v[60:63]
    s_waitcnt lgkmcnt(4)
    v_mfma_f32_16x16x32_bf16 v[24:27], v[84:87], v[104:107], v[24:27]
    s_barrier
    ds_read_b128 v[64:67], v10 offset:0
    v_mfma_f32_16x16x32_bf16 v[44:47], v[84:87], v[108:111], v[44:47]
    s_waitcnt lgkmcnt(4)
    v_mfma_f32_16x16x32_bf16 v[28:31], v[88:91], v[104:107], v[28:31]
    ds_read_b128 v[68:71], v10 offset:4096
    v_mfma_f32_16x16x32_bf16 v[48:51], v[88:91], v[108:111], v[48:51]
    s_waitcnt lgkmcnt(4)
    v_mfma_f32_16x16x32_bf16 v[32:35], v[92:95], v[104:107], v[32:35]
    ds_read_b128 v[72:75], v10 offset:8192
    v_mfma_f32_16x16x32_bf16 v[52:55], v[92:95], v[108:111], v[52:55]
    s_waitcnt lgkmcnt(4)
    v_mfma_f32_16x16x32_bf16 v[36:39], v[96:99], v[104:107], v[36:39]
    ds_read_b128 v[76:79], v10 offset:12288
    v_mfma_f32_16x16x32_bf16 v[56:59], v[96:99], v[108:111], v[56:59]
    s_waitcnt lgkmcnt(4)
    v_mfma_f32_16x16x32_bf16 v[40:43], v[100:103], v[104:107], v[40:43]
    ds_read_b128 v[80:83], v10 offset:16384
    v_mfma_f32_16x16x32_bf16 v[60:63], v[100:103], v[108:111], v[60:63]
    s_waitcnt lgkmcnt(4)
    v_mfma_f32_16x16x32_bf16 v[24:27], v[64:67], v[112:115], v[24:27]
    ds_read_b128 v[84:87], v10 offset:1024
    v_mfma_f32_16x16x32_bf16 v[44:47], v[64:67], v[116:119], v[44:47]
    s_waitcnt lgkmcnt(4)
    v_mfma_f32_16x16x32_bf16 v[28:31], v[68:71], v[112:115], v[28:31]
    ds_read_b128 v[88:91], v10 offset:5120
    v_mfma_f32_16x16x32_bf16 v[48:51], v[68:71], v[116:119], v[48:51]
    s_waitcnt lgkmcnt(4)
    v_mfma_f32_16x16x32_bf16 v[32:35], v[72:75], v[112:115], v[32:35]
    ds_read_b128 v[92:95], v10 offset:9216
    v_mfma_f32_16x16x32_bf16 v[52:55], v[72:75], v[116:119], v[52:55]
    s_waitcnt lgkmcnt(4)
    v_mfma_f32_16x16x32_bf16 v[36:39], v[76:79], v[112:115], v[36:39]
    ds_read_b128 v[96:99], v10 offset:13312
    v_mfma_f32_16x16x32_bf16 v[56:59], v[76:79], v[116:119], v[56:59]
    s_waitcnt lgkmcnt(4)
    v_mfma_f32_16x16x32_bf16 v[40:43], v[80:83], v[112:115], v[40:43]
    ds_read_b128 v[100:103], v10 offset:17408
    v_mfma_f32_16x16x32_bf16 v[60:63], v[80:83], v[116:119], v[60:63]
    s_waitcnt lgkmcnt(4)
    v_mfma_f32_16x16x32_bf16 v[24:27], v[84:87], v[120:123], v[24:27]
    s_barrier
    ds_read_b128 v[64:67], v4 offset:0
    v_mfma_f32_16x16x32_bf16 v[44:47], v[84:87], v[124:127], v[44:47]
    s_waitcnt lgkmcnt(4)
    v_mfma_f32_16x16x32_bf16 v[28:31], v[88:91], v[120:123], v[28:31]
    ds_read_b128 v[68:71], v4 offset:4096
    v_mfma_f32_16x16x32_bf16 v[48:51], v[88:91], v[124:127], v[48:51]
    s_waitcnt lgkmcnt(4)
    v_mfma_f32_16x16x32_bf16 v[32:35], v[92:95], v[120:123], v[32:35]
    ds_read_b128 v[72:75], v4 offset:8192
    v_mfma_f32_16x16x32_bf16 v[52:55], v[92:95], v[124:127], v[52:55]
    s_waitcnt lgkmcnt(4)
    v_mfma_f32_16x16x32_bf16 v[36:39], v[96:99], v[120:123], v[36:39]
    ds_read_b128 v[76:79], v4 offset:12288
    v_mfma_f32_16x16x32_bf16 v[56:59], v[96:99], v[124:127], v[56:59]
    s_waitcnt lgkmcnt(4)
    v_mfma_f32_16x16x32_bf16 v[40:43], v[100:103], v[120:123], v[40:43]
    ds_read_b128 v[80:83], v4 offset:16384
    v_mfma_f32_16x16x32_bf16 v[60:63], v[100:103], v[124:127], v[60:63]
    s_waitcnt lgkmcnt(4)
    v_mfma_f32_16x16x32_bf16 v[24:27], v[64:67], v[128:131], v[24:27]
    ds_read_b128 v[84:87], v4 offset:1024
    v_mfma_f32_16x16x32_bf16 v[44:47], v[64:67], v[132:135], v[44:47]
    s_waitcnt lgkmcnt(4)
    v_mfma_f32_16x16x32_bf16 v[28:31], v[68:71], v[128:131], v[28:31]
    ds_read_b128 v[88:91], v4 offset:5120
    v_mfma_f32_16x16x32_bf16 v[48:51], v[68:71], v[132:135], v[48:51]
    s_waitcnt lgkmcnt(4)
    v_mfma_f32_16x16x32_bf16 v[32:35], v[72:75], v[128:131], v[32:35]
    ds_read_b128 v[92:95], v4 offset:9216
    v_mfma_f32_16x16x32_bf16 v[52:55], v[72:75], v[132:135], v[52:55]
    s_waitcnt lgkmcnt(4)
    v_mfma_f32_16x16x32_bf16 v[36:39], v[76:79], v[128:131], v[36:39]
    ds_read_b128 v[96:99], v4 offset:13312
    v_mfma_f32_16x16x32_bf16 v[56:59], v[76:79], v[132:135], v[56:59]
    s_waitcnt lgkmcnt(4)
    v_mfma_f32_16x16x32_bf16 v[40:43], v[80:83], v[128:131], v[40:43]
    ds_read_b128 v[100:103], v4 offset:17408
    v_mfma_f32_16x16x32_bf16 v[60:63], v[80:83], v[132:135], v[60:63]
    s_waitcnt lgkmcnt(4)
    v_mfma_f32_16x16x32_bf16 v[24:27], v[84:87], v[136:139], v[24:27]
    s_waitcnt lgkmcnt(3)
    v_mfma_f32_16x16x32_bf16 v[28:31], v[88:91], v[136:139], v[28:31]
    s_waitcnt lgkmcnt(2)
    v_mfma_f32_16x16x32_bf16 v[32:35], v[92:95], v[136:139], v[32:35]
    s_waitcnt lgkmcnt(1)
    v_mfma_f32_16x16x32_bf16 v[36:39], v[96:99], v[136:139], v[36:39]
    s_waitcnt lgkmcnt(0)
    v_mfma_f32_16x16x32_bf16 v[40:43], v[100:103], v[136:139], v[40:43]
    v_mfma_f32_16x16x32_bf16 v[44:47], v[84:87], v[140:143], v[44:47]
    ds_write_b128 v11, v[24:27] offset:0
    v_mfma_f32_16x16x32_bf16 v[48:51], v[88:91], v[140:143], v[48:51]
    ds_write_b128 v11, v[28:31] offset:1024
    v_mfma_f32_16x16x32_bf16 v[52:55], v[92:95], v[140:143], v[52:55]
    ds_write_b128 v11, v[32:35] offset:2048
    v_mfma_f32_16x16x32_bf16 v[56:59], v[96:99], v[140:143], v[56:59]
    ds_write_b128 v11, v[36:39] offset:3072
    v_mfma_f32_16x16x32_bf16 v[60:63], v[100:103], v[140:143], v[60:63]
    ds_write_b128 v11, v[40:43] offset:4096
    s_waitcnt lgkmcnt(0)
    s_barrier
    ds_read_b128 v[180:183], v6 offset:0
    ds_read_b128 v[184:187], v6 offset:1024
    ds_read_b128 v[188:191], v6 offset:2048
    ds_read_b128 v[192:195], v6 offset:3072
    ds_read_b128 v[196:199], v6 offset:4096
    s_waitcnt lgkmcnt(4)
    v_pk_add_f32 v[180:181], v[44:45], v[180:181]
    v_pk_add_f32 v[182:183], v[46:47], v[182:183]
    v_cvt_pk_bf16_f32 v200, v180, v181
    v_cvt_pk_bf16_f32 v201, v182, v183
    s_waitcnt lgkmcnt(3)
    v_pk_add_f32 v[184:185], v[48:49], v[184:185]
    v_pk_add_f32 v[186:187], v[50:51], v[186:187]
    v_cvt_pk_bf16_f32 v202, v184, v185
    v_cvt_pk_bf16_f32 v203, v186, v187
    s_waitcnt lgkmcnt(2)
    v_pk_add_f32 v[188:189], v[52:53], v[188:189]
    v_pk_add_f32 v[190:191], v[54:55], v[190:191]
    v_cvt_pk_bf16_f32 v204, v188, v189
    v_cvt_pk_bf16_f32 v205, v190, v191
    v_permlane16_swap_b32 v200, v202
    v_permlane16_swap_b32 v201, v203
    buffer_store_dwordx4 v[200:203], v8, s[44:47], 0 offen
    s_waitcnt lgkmcnt(1)
    v_pk_add_f32 v[192:193], v[56:57], v[192:193]
    v_pk_add_f32 v[194:195], v[58:59], v[194:195]
    v_cvt_pk_bf16_f32 v206, v192, v193
    v_cvt_pk_bf16_f32 v207, v194, v195
    s_waitcnt lgkmcnt(0)
    v_pk_add_f32 v[196:197], v[60:61], v[196:197]
    v_pk_add_f32 v[198:199], v[62:63], v[198:199]
    v_cvt_pk_bf16_f32 v208, v196, v197
    v_cvt_pk_bf16_f32 v209, v198, v199
    v_permlane16_swap_b32 v204, v206
    v_permlane16_swap_b32 v205, v207
    buffer_store_dwordx4 v[204:207], v8, s[44:47], 0 offen offset:64
    buffer_store_dwordx2 v[208:209], v9, s[44:47], 0 offen offset:128
    s_endpgm
L_ler0:
    s_sub_u32 s33, s33, 1
    s_cmp_lt_i32 s33, 1
    s_cbranch_scc1 L_lek0
    s_waitcnt vmcnt(0)
    s_sleep 4
    s_branch L_lers
L_ler1:
    s_sub_u32 s33, s33, 1
    s_cmp_lt_i32 s33, 1
    s_cbranch_scc1 L_lek1
    s_waitcnt vmcnt(0)
    s_sleep 4
    s_add_u32 m0, s27, 20480
    s_add_u32 s32, s29, 4096
    buffer_load_dwordx4 v2, s[12:15], s32 offen offset:0 sc1 lds
    buffer_load_dwordx4 v2, s[12:15], s32 offen offset:1024 sc1 lds
    buffer_load_dwordx4 v2, s[12:15], s32 offen offset:2048 sc1 lds
    buffer_load_dwordx4 v2, s[12:15], s32 offen offset:3072 sc1 lds
    s_add_u32 m0, s28, 20480
    s_add_u32 s32, s30, 4096
    buffer_load_dwordx4 v2, s[12:15], s32 offen sc1 lds
    s_waitcnt vmcnt(0)
    ds_read_b32 v40, v44 offset:20480
    ds_read_b32 v41, v47 offset:20480
    s_branch L_lec1
L_ler2:
    s_sub_u32 s33, s33, 1
    s_cmp_lt_i32 s33, 1
    s_cbranch_scc1 L_lek2
    s_waitcnt vmcnt(0)
    s_sleep 4
    s_add_u32 m0, s27, 40960
    s_add_u32 s32, s29, 8192
    buffer_load_dwordx4 v2, s[12:15], s32 offen offset:0 sc1 lds
    buffer_load_dwordx4 v2, s[12:15], s32 offen offset:1024 sc1 lds
    buffer_load_dwordx4 v2, s[12:15], s32 offen offset:2048 sc1 lds
    buffer_load_dwordx4 v2, s[12:15], s32 offen offset:3072 sc1 lds
    s_add_u32 m0, s28, 40960
    s_add_u32 s32, s30, 8192
    buffer_load_dwordx4 v2, s[12:15], s32 offen sc1 lds
    s_waitcnt vmcnt(0)
    ds_read_b32 v40, v44 offset:40960
    ds_read_b32 v41, v47 offset:40960
    s_branch L_lec2
L_ler3:
    s_sub_u32 s33, s33, 1
    s_cmp_lt_i32 s33, 1
    s_cbranch_scc1 L_lek3
    s_waitcnt vmcnt(0)
    s_sleep 4
    s_add_u32 m0, s27, 61440
    s_add_u32 s32, s29, 12288
    buffer_load_dwordx4 v2, s[12:15], s32 offen offset:0 sc1 lds
    buffer_load_dwordx4 v2, s[12:15], s32 offen offset:1024 sc1 lds
    buffer_load_dwordx4 v2, s[12:15], s32 offen offset:2048 sc1 lds
    buffer_load_dwordx4 v2, s[12:15], s32 offen offset:3072 sc1 lds
    s_add_u32 m0, s28, 61440
    s_add_u32 s32, s30, 12288
    buffer_load_dwordx4 v2, s[12:15], s32 offen sc1 lds
    s_waitcnt vmcnt(0)
    ds_read_b32 v40, v45 offset:0
    ds_read_b32 v41, v48 offset:0
    s_branch L_lec3
L_ler4:
    s_sub_u32 s33, s33, 1
    s_cmp_lt_i32 s33, 1
    s_cbranch_scc1 L_lek4
    s_waitcnt vmcnt(0)
    s_sleep 4
    s_add_u32 m0, s27, 81920
    s_add_u32 s32, s29, 16384
    buffer_load_dwordx4 v2, s[12:15], s32 offen offset:0 sc1 lds
    buffer_load_dwordx4 v2, s[12:15], s32 offen offset:1024 sc1 lds
    buffer_load_dwordx4 v2, s[12:15], s32 offen offset:2048 sc1 lds
    buffer_load_dwordx4 v2, s[12:15], s32 offen offset:3072 sc1 lds
    s_add_u32 m0, s28, 81920
    s_add_u32 s32, s30, 16384
    buffer_load_dwordx4 v2, s[12:15], s32 offen sc1 lds
    s_waitcnt vmcnt(0)
    ds_read_b32 v40, v45 offset:20480
    ds_read_b32 v41, v48 offset:20480
    s_branch L_lec4
L_ler5:
    s_sub_u32 s33, s33, 1
    s_cmp_lt_i32 s33, 1
    s_cbranch_scc1 L_lek5
    s_waitcnt vmcnt(0)
    s_sleep 4
    s_add_u32 m0, s27, 143360
    s_add_u32 s32, s29, 20480
    buffer_load_dwordx4 v2, s[12:15], s32 offen offset:0 sc1 lds
    buffer_load_dwordx4 v2, s[12:15], s32 offen offset:1024 sc1 lds
    buffer_load_dwordx4 v2, s[12:15], s32 offen offset:2048 sc1 lds
    buffer_load_dwordx4 v2, s[12:15], s32 offen offset:3072 sc1 lds
    s_add_u32 m0, s28, 143360
    s_add_u32 s32, s30, 20480
    buffer_load_dwordx4 v2, s[12:15], s32 offen sc1 lds
    s_waitcnt vmcnt(0)
    ds_read_b32 v40, v46 offset:20480
    ds_read_b32 v41, v49 offset:20480
    s_branch L_lec5
L_ler6:
    s_sub_u32 s33, s33, 1
    s_cmp_lt_i32 s33, 1
    s_cbranch_scc1 L_lek6
    s_waitcnt vmcnt(0)
    s_sleep 4
    s_add_u32 m0, s27, 0
    s_add_u32 s32, s29, 24576
    buffer_load_dwordx4 v2, s[12:15], s32 offen offset:0 sc1 lds
    buffer_load_dwordx4 v2, s[12:15], s32 offen offset:1024 sc1 lds
    buffer_load_dwordx4 v2, s[12:15], s32 offen offset:2048 sc1 lds
    buffer_load_dwordx4 v2, s[12:15], s32 offen offset:3072 sc1 lds
    s_add_u32 m0, s28, 0
    s_add_u32 s32, s30, 24576
    buffer_load_dwordx4 v2, s[12:15], s32 offen sc1 lds
    s_waitcnt vmcnt(0)
    ds_read_b32 v40, v44 offset:0
    ds_read_b32 v41, v47 offset:0
    s_branch L_lec6
L_ler7:
    s_sub_u32 s33, s33, 1
    s_cmp_lt_i32 s33, 1
    s_cbranch_scc1 L_lek7
    s_waitcnt vmcnt(0)
    s_sleep 4
    s_add_u32 m0, s27, 20480
    s_add_u32 s32, s29, 28672
    buffer_load_dwordx4 v2, s[12:15], s32 offen offset:0 sc1 lds
    buffer_load_dwordx4 v2, s[12:15], s32 offen offset:1024 sc1 lds
    buffer_load_dwordx4 v2, s[12:15], s32 offen offset:2048 sc1 lds
    buffer_load_dwordx4 v2, s[12:15], s32 offen offset:3072 sc1 lds
    s_add_u32 m0, s28, 20480
    s_add_u32 s32, s30, 28672
    buffer_load_dwordx4 v2, s[12:15], s32 offen sc1 lds
    s_waitcnt vmcnt(0)
    ds_read_b32 v40, v44 offset:20480
    ds_read_b32 v41, v47 offset:20480
    s_branch L_lec7
L_ler8:
    s_sub_u32 s33, s33, 1
    s_cmp_lt_i32 s33, 1
    s_cbranch_scc1 L_lek8
    s_waitcnt vmcnt(0)
    s_sleep 4
    s_add_u32 m0, s27, 40960
    s_add_u32 s32, s29, 32768
    buffer_load_dwordx4 v2, s[12:15], s32 offen offset:0 sc1 lds
    buffer_load_dwordx4 v2, s[12:15], s32 offen offset:1024 sc1 lds
    buffer_load_dwordx4 v2, s[12:15], s32 offen offset:2048 sc1 lds
    buffer_load_dwordx4 v2, s[12:15], s32 offen offset:3072 sc1 lds
    s_add_u32 m0, s28, 40960
    s_add_u32 s32, s30, 32768
    buffer_load_dwordx4 v2, s[12:15], s32 offen sc1 lds
    s_waitcnt vmcnt(0)
    ds_read_b32 v40, v44 offset:40960
    ds_read_b32 v41, v47 offset:40960
    s_branch L_lec8
L_ler9:
    s_sub_u32 s33, s33, 1
    s_cmp_lt_i32 s33, 1
    s_cbranch_scc1 L_lek9
    s_waitcnt vmcnt(0)
    s_sleep 4
    s_add_u32 m0, s27, 102400
    s_add_u32 s32, s29, 36864
    buffer_load_dwordx4 v2, s[12:15], s32 offen offset:0 sc1 lds
    buffer_load_dwordx4 v2, s[12:15], s32 offen offset:1024 sc1 lds
    buffer_load_dwordx4 v2, s[12:15], s32 offen offset:2048 sc1 lds
    buffer_load_dwordx4 v2, s[12:15], s32 offen offset:3072 sc1 lds
    s_add_u32 m0, s28, 102400
    s_add_u32 s32, s30, 36864
    buffer_load_dwordx4 v2, s[12:15], s32 offen sc1 lds
    s_waitcnt vmcnt(0)
    ds_read_b32 v40, v45 offset:40960
    ds_read_b32 v41, v48 offset:40960
    s_branch L_lec9
L_ler10:
    s_sub_u32 s33, s33, 1
    s_cmp_lt_i32 s33, 1
    s_cbranch_scc1 L_lek10
    s_waitcnt vmcnt(0)
    s_sleep 4
    s_add_u32 m0, s27, 122880
    s_add_u32 s32, s29, 40960
    buffer_load_dwordx4 v2, s[12:15], s32 offen offset:0 sc1 lds
    buffer_load_dwordx4 v2, s[12:15], s32 offen offset:1024 sc1 lds
    buffer_load_dwordx4 v2, s[12:15], s32 offen offset:2048 sc1 lds
    buffer_load_dwordx4 v2, s[12:15], s32 offen offset:3072 sc1 lds
    s_add_u32 m0, s28, 122880
    s_add_u32 s32, s30, 40960
    buffer_load_dwordx4 v2, s[12:15], s32 offen sc1 lds
    s_waitcnt vmcnt(0)
    ds_read_b32 v40, v46 offset:0
    ds_read_b32 v41, v49 offset:0
    s_branch L_lec10
L_ler11:
    s_sub_u32 s33, s33, 1
    s_cmp_lt_i32 s33, 1
    s_cbranch_scc1 L_lek11
    s_waitcnt vmcnt(0)
    s_sleep 4
    s_add_u32 m0, s27, 61440
    s_add_u32 s32, s29, 45056
    buffer_load_dwordx4 v2, s[12:15], s32 offen offset:0 sc1 lds
    buffer_load_dwordx4 v2, s[12:15], s32 offen offset:1024 sc1 lds
    buffer_load_dwordx4 v2, s[12:15], s32 offen offset:2048 sc1 lds
    buffer_load_dwordx4 v2, s[12:15], s32 offen offset:3072 sc1 lds
    s_add_u32 m0, s28, 61440
    s_add_u32 s32, s30, 45056
    buffer_load_dwordx4 v2, s[12:15], s32 offen sc1 lds
    s_waitcnt vmcnt(0)
    ds_read_b32 v40, v45 offset:0
    ds_read_b32 v41, v48 offset:0
    s_branch L_lec11
L_oretry:
    s_and_b32 s34, s65, s67
    s_cbranch_scc0 L_oround
    s_sub_u32 s33, s33, 15
    s_sleep 4
    s_branch L_oround
L_ldr0:
    s_sub_u32 s33, s33, 1
    s_cmp_lt_i32 s33, 1
    s_cbranch_scc1 L_ldk0
    s_waitcnt vmcnt(0)
    s_sleep 4
    s_branch L_ldrs
L_ldr1:
    s_sub_u32 s33, s33, 1
    s_cmp_lt_i32 s33, 1
    s_cbranch_scc1 L_ldk1
    s_waitcnt vmcnt(0)
    s_sleep 4
    s_add_u32 m0, s27, 16384
    s_add_u32 s32, s29, 4096
    buffer_load_dwordx4 v2, s[12:15], s32 offen offset:0 sc1 lds
    buffer_load_dwordx4 v2, s[12:15], s32 offen offset:1024 sc1 lds
    buffer_load_dwordx4 v2, s[12:15], s32 offen offset:2048 sc1 lds
    buffer_load_dwordx4 v2, s[12:15], s32 offen offset:3072 sc1 lds
    s_waitcnt vmcnt(0)
    ds_read_b32 v40, v44 offset:16384
    s_branch L_ldc1
L_ldr2:
    s_sub_u32 s33, s33, 1
    s_cmp_lt_i32 s33, 1
    s_cbranch_scc1 L_ldk2
    s_waitcnt vmcnt(0)
    s_sleep 4
    s_add_u32 m0, s27, 32768
    s_add_u32 s32, s29, 8192
    buffer_load_dwordx4 v2, s[12:15], s32 offen offset:0 sc1 lds
    buffer_load_dwordx4 v2, s[12:15], s32 offen offset:1024 sc1 lds
    buffer_load_dwordx4 v2, s[12:15], s32 offen offset:2048 sc1 lds
    buffer_load_dwordx4 v2, s[12:15], s32 offen offset:3072 sc1 lds
    s_waitcnt vmcnt(0)
    ds_read_b32 v40, v44 offset:32768
    s_branch L_ldc2
L_ldr3:
    s_sub_u32 s33, s33, 1
    s_cmp_lt_i32 s33, 1
    s_cbranch_scc1 L_ldk3
    s_waitcnt vmcnt(0)
    s_sleep 4
    s_add_u32 m0, s27, 49152
    s_add_u32 s32, s29, 12288
    buffer_load_dwordx4 v2, s[12:15], s32 offen offset:0 sc1 lds
    buffer_load_dwordx4 v2, s[12:15], s32 offen offset:1024 sc1 lds
    buffer_load_dwordx4 v2, s[12:15], s32 offen offset:2048 sc1 lds
    buffer_load_dwordx4 v2, s[12:15], s32 offen offset:3072 sc1 lds
    s_waitcnt vmcnt(0)
    ds_read_b32 v40, v44 offset:49152
    s_branch L_ldc3
L_ldr4:
    s_sub_u32 s33, s33, 1
    s_cmp_lt_i32 s33, 1
    s_cbranch_scc1 L_ldk4
    s_waitcnt vmcnt(0)
    s_sleep 4
    s_add_u32 m0, s27, 65536
    s_add_u32 s32, s29, 16384
    buffer_load_dwordx4 v2, s[12:15], s32 offen offset:0 sc1 lds
    buffer_load_dwordx4 v2, s[12:15], s32 offen offset:1024 sc1 lds
    buffer_load_dwordx4 v2, s[12:15], s32 offen offset:2048 sc1 lds
    buffer_load_dwordx4 v2, s[12:15], s32 offen offset:3072 sc1 lds
    s_waitcnt vmcnt(0)
    ds_read_b32 v40, v45 offset:0
    s_branch L_ldc4
L_ldr5:
    s_sub_u32 s33, s33, 1
    s_cmp_lt_i32 s33, 1
    s_cbranch_scc1 L_ldk5
    s_waitcnt vmcnt(0)
    s_sleep 4
    s_add_u32 m0, s27, 0
    s_add_u32 s32, s29, 20480
    buffer_load_dwordx4 v2, s[12:15], s32 offen offset:0 sc1 lds
    buffer_load_dwordx4 v2, s[12:15], s32 offen offset:1024 sc1 lds
    buffer_load_dwordx4 v2, s[12:15], s32 offen offset:2048 sc1 lds
    buffer_load_dwordx4 v2, s[12:15], s32 offen offset:3072 sc1 lds
    s_waitcnt vmcnt(0)
    ds_read_b32 v40, v44 offset:0
    s_branch L_ldc5
L_ldr6:
    s_sub_u32 s33, s33, 1
    s_cmp_lt_i32 s33, 1
    s_cbranch_scc1 L_ldk6
    s_waitcnt vmcnt(0)
    s_sleep 4
    s_add_u32 m0, s27, 81920
    s_add_u32 s32, s29, 24576
    buffer_load_dwordx4 v2, s[12:15], s32 offen offset:0 sc1 lds
    buffer_load_dwordx4 v2, s[12:15], s32 offen offset:1024 sc1 lds
    buffer_load_dwordx4 v2, s[12:15], s32 offen offset:2048 sc1 lds
    buffer_load_dwordx4 v2, s[12:15], s32 offen offset:3072 sc1 lds
    s_waitcnt vmcnt(0)
    ds_read_b32 v40, v45 offset:16384
    s_branch L_ldc6
L_ldr7:
    s_sub_u32 s33, s33, 1
    s_cmp_lt_i32 s33, 1
    s_cbranch_scc1 L_ldk7
    s_waitcnt vmcnt(0)
    s_sleep 4
    s_add_u32 m0, s27, 16384
    s_add_u32 s32, s29, 28672
    buffer_load_dwordx4 v2, s[12:15], s32 offen offset:0 sc1 lds
    buffer_load_dwordx4 v2, s[12:15], s32 offen offset:1024 sc1 lds
    buffer_load_dwordx4 v2, s[12:15], s32 offen offset:2048 sc1 lds
    buffer_load_dwordx4 v2, s[12:15], s32 offen offset:3072 sc1 lds
    s_waitcnt vmcnt(0)
    ds_read_b32 v40, v44 offset:16384
    s_branch L_ldc7
L_ldr8:
    s_sub_u32 s33, s33, 1
    s_cmp_lt_i32 s33, 1
    s_cbranch_scc1 L_ldk8
    s_waitcnt vmcnt(0)
    s_sleep 4
    s_add_u32 m0, s27, 98304
    s_add_u32 s32, s29, 32768
    buffer_load_dwordx4 v2, s[12:15], s32 offen offset:0 sc1 lds
    buffer_load_dwordx4 v2, s[12:15], s32 offen offset:1024 sc1 lds
    buffer_load_dwordx4 v2, s[12:15], s32 offen offset:2048 sc1 lds
    buffer_load_dwordx4 v2, s[12:15], s32 offen offset:3072 sc1 lds
    s_waitcnt vmcnt(0)
    ds_read_b32 v40, v45 offset:32768
    s_branch L_ldc8
L_ldr9:
    s_sub_u32 s33, s33, 1
    s_cmp_lt_i32 s33, 1
    s_cbranch_scc1 L_ldk9
    s_waitcnt vmcnt(0)
    s_sleep 4
    s_add_u32 m0, s27, 32768
    s_add_u32 s32, s29, 36864
    buffer_load_dwordx4 v2, s[12:15], s32 offen offset:0 sc1 lds
    buffer_load_dwordx4 v2, s[12:15], s32 offen offset:1024 sc1 lds
    buffer_load_dwordx4 v2, s[12:15], s32 offen offset:2048 sc1 lds
    buffer_load_dwordx4 v2, s[12:15], s32 offen offset:3072 sc1 lds
    s_waitcnt vmcnt(0)
    ds_read_b32 v40, v44 offset:32768
    s_branch L_ldc9
L_ldr10:
    s_sub_u32 s33, s33, 1
    s_cmp_lt_i32 s33, 1
    s_cbranch_scc1 L_ldk10
    s_waitcnt vmcnt(0)
    s_sleep 4
    s_add_u32 m0, s27, 114688
    s_add_u32 s32, s29, 40960
    buffer_load_dwordx4 v2, s[12:15], s32 offen offset:0 sc1 lds
    buffer_load_dwordx4 v2, s[12:15], s32 offen offset:1024 sc1 lds
    buffer_load_dwordx4 v2, s[12:15], s32 offen offset:2048 sc1 lds
    buffer_load_dwordx4 v2, s[12:15], s32 offen offset:3072 sc1 lds
    s_waitcnt vmcnt(0)
    ds_read_b32 v40, v45 offset:49152
    s_branch L_ldc10
L_ldr11:
    s_sub_u32 s33, s33, 1
    s_cmp_lt_i32 s33, 1
    s_cbranch_scc1 L_ldk11
    s_waitcnt vmcnt(0)
    s_sleep 4
    s_add_u32 m0, s27, 49152
    s_add_u32 s32, s29, 45056
    buffer_load_dwordx4 v2, s[12:15], s32 offen offset:0 sc1 lds
    buffer_load_dwordx4 v2, s[12:15], s32 offen offset:1024 sc1 lds
    buffer_load_dwordx4 v2, s[12:15], s32 offen offset:2048 sc1 lds
    buffer_load_dwordx4 v2, s[12:15], s32 offen offset:3072 sc1 lds
    s_waitcnt vmcnt(0)
    ds_read_b32 v40, v44 offset:49152
    s_branch L_ldc11
L_ldr12:
    s_sub_u32 s33, s33, 1
    s_cmp_lt_i32 s33, 1
    s_cbranch_scc1 L_ldk12
    s_waitcnt vmcnt(0)
    s_sleep 4
    s_add_u32 m0, s27, 131072
    s_add_u32 s32, s29, 49152
    buffer_load_dwordx4 v2, s[12:15], s32 offen offset:0 sc1 lds
    buffer_load_dwordx4 v2, s[12:15], s32 offen offset:1024 sc1 lds
    buffer_load_dwordx4 v2, s[12:15], s32 offen offset:2048 sc1 lds
    buffer_load_dwordx4 v2, s[12:15], s32 offen offset:3072 sc1 lds
    s_waitcnt vmcnt(0)
    ds_read_b32 v40, v46 offset:0
    s_branch L_ldc12
L_ldr13:
    s_sub_u32 s33, s33, 1
    s_cmp_lt_i32 s33, 1
    s_cbranch_scc1 L_ldk13
    s_waitcnt vmcnt(0)
    s_sleep 4
    s_add_u32 m0, s27, 65536
    s_add_u32 s32, s29, 53248
    buffer_load_dwordx4 v2, s[12:15], s32 offen offset:0 sc1 lds
    buffer_load_dwordx4 v2, s[12:15], s32 offen offset:1024 sc1 lds
    buffer_load_dwordx4 v2, s[12:15], s32 offen offset:2048 sc1 lds
    buffer_load_dwordx4 v2, s[12:15], s32 offen offset:3072 sc1 lds
    s_waitcnt vmcnt(0)
    ds_read_b32 v40, v45 offset:0
    s_branch L_ldc13
L_ldr14:
    s_sub_u32 s33, s33, 1
    s_cmp_lt_i32 s33, 1
    s_cbranch_scc1 L_ldk14
    s_waitcnt vmcnt(0)
    s_sleep 4
    s_add_u32 m0, s27, 0
    s_add_u32 s32, s29, 57344
    buffer_load_dwordx4 v2, s[12:15], s32 offen offset:0 sc1 lds
    buffer_load_dwordx4 v2, s[12:15], s32 offen offset:1024 sc1 lds
    buffer_load_dwordx4 v2, s[12:15], s32 offen offset:2048 sc1 lds
    buffer_load_dwordx4 v2, s[12:15], s32 offen offset:3072 sc1 lds
    s_waitcnt vmcnt(0)
    ds_read_b32 v40, v44 offset:0
    s_branch L_ldc14
L_ldr15:
    s_sub_u32 s33, s33, 1
    s_cmp_lt_i32 s33, 1
    s_cbranch_scc1 L_ldk15
    s_waitcnt vmcnt(0)
    s_sleep 4
    s_add_u32 m0, s27, 81920
    s_add_u32 s32, s29, 61440
    buffer_load_dwordx4 v2, s[12:15], s32 offen offset:0 sc1 lds
    buffer_load_dwordx4 v2, s[12:15], s32 offen offset:1024 sc1 lds
    buffer_load_dwordx4 v2, s[12:15], s32 offen offset:2048 sc1 lds
    buffer_load_dwordx4 v2, s[12:15], s32 offen offset:3072 sc1 lds
    s_waitcnt vmcnt(0)
    ds_read_b32 v40, v45 offset:16384
    s_branch L_ldc15
L_end:
    s_endpgm
L_f1r:
    s_sub_u32 s33, s33, 1
    s_cmp_lt_i32 s33, 1
    s_cbranch_scc1 L_f1d
    s_sleep 8
    buffer_load_dwordx4 v[212:215], v5, s[12:15], s26 offen sc1
    s_waitcnt vmcnt(0)
    s_branch L_f1
L_g2r:
    s_sub_u32 s33, s33, 1
    s_cmp_lt_i32 s33, 1
    s_cbranch_scc1 L_g2d
    s_sleep 8
    buffer_load_dwordx4 v[22:25], v5, s[12:15], s26 offen sc1
    s_waitcnt vmcnt(0)
    s_branch L_g2
L_slow:
    v_mov_b32 v28, 0xff800000
    v_mov_b32 v29, 0xff800000
    s_add_u32 s56, s24, 2621440
    s_add_u32 s57, s25, 2621440
    s_add_u32 s57, s57, s23
    s_mov_b32 s36, 0
L_mloop:
    buffer_load_dwordx4 v[22:25], v34, s[12:15], s56 offen
    buffer_load_dwordx2 v[26:27], v35, s[12:15], s57 offen
    s_add_u32 s56, s56, 512
    s_add_u32 s57, s57, 512
    s_waitcnt vmcnt(0)
    v_mfma_f32_32x32x4_2b_bf16 v[96:127], v[26:27], v[20:21], 0
    s_nop 15
    s_nop 3
    v_mfma_f32_32x32x16_bf16 v[96:111], v[22:25], v[12:15], v[96:111]
    v_mfma_f32_32x32x16_bf16 v[112:127], v[22:25], v[16:19], v[112:127]
    s_nop 11
    v_max3_f32 v28, v96, v97, v28
    v_max3_f32 v28, v98, v99, v28
    v_max3_f32 v28, v100, v101, v28
    v_max3_f32 v28, v102, v103, v28
    v_max3_f32 v28, v104, v105, v28
    v_max3_f32 v28, v106, v107, v28
    v_max3_f32 v28, v108, v109, v28
    v_max3_f32 v28, v110, v111, v28
    v_max3_f32 v29, v112, v113, v29
    v_max3_f32 v29, v114, v115, v29
    v_max3_f32 v29, v116, v117, v29
    v_max3_f32 v29, v118, v119, v29
    v_max3_f32 v29, v120, v121, v29
    v_max3_f32 v29, v122, v123, v29
    v_max3_f32 v29, v124, v125, v29
    v_max3_f32 v29, v126, v127, v29
    s_add_u32 s36, s36, 1
    s_cmp_lt_u32 s36, 64
    s_cbranch_scc1 L_mloop
    v_mov_b32 v30, v28
    v_mov_b32 v31, v29
    s_nop 1
    v_permlane32_swap_b32 v28, v30
    v_permlane32_swap_b32 v29, v31
    s_nop 1
    v_max_f32 v28, v28, v30
    v_max_f32 v29, v29, v31
    v_sub_f32 v128, 0, v28
    v_sub_f32 v129, 0, v28
    v_sub_f32 v130, 0, v28
    v_sub_f32 v131, 0, v28
    v_sub_f32 v132, 0, v28
    v_sub_f32 v133, 0, v28
    v_sub_f32 v134, 0, v28
    v_sub_f32 v135, 0, v28
    v_sub_f32 v136, 0, v28
    v_sub_f32 v137, 0, v28
    v_sub_f32 v138, 0, v28
    v_sub_f32 v139, 0, v28
    v_sub_f32 v140, 0, v28
    v_sub_f32 v141, 0, v28
    v_sub_f32 v142, 0, v28
    v_sub_f32 v143, 0, v28
    v_sub_f32 v144, 0, v29
    v_sub_f32 v145, 0, v29
    v_sub_f32 v146, 0, v29
    v_sub_f32 v147, 0, v29
    v_sub_f32 v148, 0, v29
    v_sub_f32 v149, 0, v29
    v_sub_f32 v150, 0, v29
    v_sub_f32 v151, 0, v29
    v_sub_f32 v152, 0, v29
    v_sub_f32 v153, 0, v29
    v_sub_f32 v154, 0, v29
    v_sub_f32 v155, 0, v29
    v_sub_f32 v156, 0, v29
    v_sub_f32 v157, 0, v29
    v_sub_f32 v158, 0, v29
    v_sub_f32 v159, 0, v29
    v_mov_b32 v64, 0
    v_mov_b32 v65, 0
    v_mov_b32 v66, 0
    v_mov_b32 v67, 0
    v_mov_b32 v68, 0
    v_mov_b32 v69, 0
    v_mov_b32 v70, 0
    v_mov_b32 v71, 0
    v_mov_b32 v72, 0
    v_mov_b32 v73, 0
    v_mov_b32 v74, 0
    v_mov_b32 v75, 0
    v_mov_b32 v76, 0
    v_mov_b32 v77, 0
    v_mov_b32 v78, 0
    v_mov_b32 v79, 0
    v_mov_b32 v80, 0
    v_mov_b32 v81, 0
    v_mov_b32 v82, 0
    v_mov_b32 v83, 0
    v_mov_b32 v84, 0
    v_mov_b32 v85, 0
    v_mov_b32 v86, 0
    v_mov_b32 v87, 0
    v_mov_b32 v88, 0
    v_mov_b32 v89, 0
    v_mov_b32 v90, 0
    v_mov_b32 v91, 0
    v_mov_b32 v92, 0
    v_mov_b32 v93, 0
    v_mov_b32 v94, 0
    v_mov_b32 v95, 0
    v_cmp_eq_u32 vcc, 20, v6
    v_mov_b32 v44, 0x3f803f80
    v_mul_u32_u24 v45, 320, v7
    v_add_u32 v45, v45, v35
    v_cndmask_b32 v36, 0, v44, vcc
    v_cndmask_b32 v37, 0, v44, vcc
    v_cndmask_b32 v38, 0, v44, vcc
    v_cndmask_b32 v39, 0, v44, vcc
    v_cndmask_b32 v40, 0, v44, vcc
    v_cndmask_b32 v41, 0, v44, vcc
    v_cndmask_b32 v42, 0, v44, vcc
    v_cndmask_b32 v43, 0, v44, vcc
    s_add_u32 s56, s24, 2621440
    s_add_u32 s57, s25, 2621440
    s_add_u32 s57, s57, s23
    s_mul_i32 s58, s16, 81920
    s_add_u32 s58, s58, 5242880
    s_mov_b32 s36, 0
L_sloop:
    buffer_load_dwordx4 v[22:25], v34, s[12:15], s56 offen
    buffer_load_dwordx2 v[26:27], v35, s[12:15], s57 offen
    s_mov_b32 exec_lo, 0xfffff
    s_mov_b32 exec_hi, 0xfffff
    buffer_load_dwordx4 v[36:39], v45, s[12:15], s58 offen
    buffer_load_dwordx4 v[40:43], v45, s[12:15], s58 offen offset:640
    s_mov_b64 exec, -1
    s_add_u32 s56, s56, 512
    s_add_u32 s57, s57, 512
    s_add_u32 s58, s58, 1280
    s_waitcnt vmcnt(0)
    v_mfma_f32_32x32x4_2b_bf16 v[96:127], v[26:27], v[20:21], v[128:159]
    s_nop 15
    s_nop 3
    v_mfma_f32_32x32x16_bf16 v[96:111], v[22:25], v[12:15], v[96:111]
    v_mfma_f32_32x32x16_bf16 v[112:127], v[22:25], v[16:19], v[112:127]
    s_nop 11
    v_exp_f32 v96, v96
    v_exp_f32 v97, v97
    v_exp_f32 v98, v98
    v_exp_f32 v99, v99
    v_exp_f32 v100, v100
    v_exp_f32 v101, v101
    v_exp_f32 v102, v102
    v_exp_f32 v103, v103
    v_exp_f32 v104, v104
    v_exp_f32 v105, v105
    v_exp_f32 v106, v106
    v_exp_f32 v107, v107
    v_exp_f32 v108, v108
    v_exp_f32 v109, v109
    v_exp_f32 v110, v110
    v_exp_f32 v111, v111
    v_exp_f32 v112, v112
    v_exp_f32 v113, v113
    v_exp_f32 v114, v114
    v_exp_f32 v115, v115
    v_exp_f32 v116, v116
    v_exp_f32 v117, v117
    v_exp_f32 v118, v118
    v_exp_f32 v119, v119
    v_exp_f32 v120, v120
    v_exp_f32 v121, v121
    v_exp_f32 v122, v122
    v_exp_f32 v123, v123
    v_exp_f32 v124, v124
    v_exp_f32 v125, v125
    v_exp_f32 v126, v126
    v_exp_f32 v127, v127
    s_nop 1
    v_smfmac_f32_32x32x32_bf16 v[64:79], v[36:39], v[96:103], v52
    v_smfmac_f32_32x32x32_bf16 v[64:79], v[40:43], v[104:111], v52
    v_smfmac_f32_32x32x32_bf16 v[80:95], v[36:39], v[112:119], v52
    v_smfmac_f32_32x32x32_bf16 v[80:95], v[40:43], v[120:127], v52
    s_add_u32 s36, s36, 1
    s_cmp_lt_u32 s36, 64
    s_cbranch_scc1 L_sloop
    s_nop 9
    v_mov_b32 v109, v88
    v_mov_b32 v108, v88
    s_nop 1
    v_permlane32_swap_b32 v109, v108
    s_nop 0
    v_rcp_f32 v110, v108
    s_nop 0
    v_pk_mul_f32 v[96:97], v[80:81], v[110:111] op_sel_hi:[1,0]
    v_pk_mul_f32 v[98:99], v[82:83], v[110:111] op_sel_hi:[1,0]
    v_pk_mul_f32 v[100:101], v[84:85], v[110:111] op_sel_hi:[1,0]
    v_pk_mul_f32 v[102:103], v[86:87], v[110:111] op_sel_hi:[1,0]
    v_pk_mul_f32 v[104:105], v[88:89], v[110:111] op_sel_hi:[1,0]
    v_pk_mul_f32 v[106:107], v[90:91], v[110:111] op_sel_hi:[1,0]
    v_cvt_pk_bf16_f32 v120, v96, v97
    v_cvt_pk_bf16_f32 v121, v98, v99
    v_cvt_pk_bf16_f32 v122, v100, v101
    v_cvt_pk_bf16_f32 v123, v102, v103
    v_cvt_pk_bf16_f32 v124, v104, v105
    v_cvt_pk_bf16_f32 v125, v106, v107
    v_min_u32 v120, -2, v120
    v_min_u32 v121, -2, v121
    v_min_u32 v122, -2, v122
    v_min_u32 v123, -2, v123
    v_min_u32 v124, -2, v124
    v_min_u32 v125, -2, v125
    s_branch L_store
L_last:

.section .rodata,"a"
.p2align 6
.amdhsa_kernel sequential_preLN__mha_block__mixer_token_mlp__prompt_kernel
  .amdhsa_next_free_vgpr 256
  .amdhsa_next_free_sgpr 102
  .amdhsa_accum_offset 256
  .amdhsa_group_segment_fixed_size 0
  .amdhsa_kernarg_size 88
  .amdhsa_user_sgpr_count 2
  .amdhsa_user_sgpr_kernarg_segment_ptr 1
  .amdhsa_system_sgpr_workgroup_id_x 1
.end_amdhsa_kernel
```
